```python
import torch

def _softmax(x, axis=-1):
    return torch.softmax(x, dim=axis)
def _gelu(x):
    return torch.nn.functional.gelu(x, approximate="tanh")
def _silu(x):
    return torch.nn.functional.silu(x)
def _sigmoid(x):
    return torch.sigmoid(x)
def _layernorm(x, axis=-1, eps=1e-5):
    m = x.mean(dim=axis, keepdim=True)
    v = x.var(dim=axis, keepdim=True, unbiased=False)
    return (x - m) / torch.sqrt(v + eps)
def _scatter_add(tgt, idx, src, axis=0):
    return tgt.clone().index_add_(axis, idx, src)
def _segment_sum(src, seg, n):
    out = torch.zeros((n,) + src.shape[1:], dtype=src.dtype)
    return out.index_add_(0, seg, src)
def _pad(x, pw):
    flat = tuple(v for pair in reversed(pw) for v in pair)
    return torch.nn.functional.pad(x, flat)

kernel_name = 'recurrent_scan__sliding_block__mixer_s_mlp__prompt'

def setup_inputs():

    _w = (lambda a: (lambda t: t.to(torch.bfloat16) if t.is_floating_point() else t)(torch.as_tensor(a)))
    def _A_setup():
        B, S, D = 1, 2048, 640
        return {
            "x": _w((lambda *s: torch.randn(*s, dtype=torch.bfloat16) * 0.05)(B, S, D)),
            "wqkv": _w((lambda *s: torch.randn(*s, dtype=torch.bfloat16) * 0.05)(D, 3 * D)),
            "wo": _w((lambda *s: torch.randn(*s, dtype=torch.bfloat16) * 0.05)(D, D)),
        }
    _A_in = _A_setup()

    def _B_setup():
        B, S, D, F = 1, 2048, 640, 1728
        return {
            "x":  _w((lambda *s: torch.randn(*s, dtype=torch.bfloat16) * 0.05)(B, S, D)),
            "w1": _w((lambda *s: torch.randn(*s, dtype=torch.bfloat16) * 0.8)(D, D) * (D ** -0.5)),
            "w2": _w((lambda *s: torch.randn(*s, dtype=torch.bfloat16) * 0.8)(D, D) * (D ** -0.5)),
            "w3": _w((lambda *s: torch.randn(*s, dtype=torch.bfloat16) * 0.8)(D, F) * (D ** -0.5)),
            "w4": _w((lambda *s: torch.randn(*s, dtype=torch.bfloat16) * 0.8)(F, D) * (F ** -0.5)),
        }
    _B_in = _B_setup()

    return {
        "A_x": _A_in["x"],
        "A_wqkv": _A_in["wqkv"],
        "A_wo": _A_in["wo"],
        "B_x": _B_in["x"],
        "B_w1": _B_in["w1"],
        "B_w2": _B_in["w2"],
        "B_w3": _B_in["w3"],
        "B_w4": _B_in["w4"],
    }

def reference(A_x, A_wqkv, A_wo, B_x, B_w1, B_w2, B_w3, B_w4):
    def _A_ref(x, wqkv, wo):
        B, S, D = x.shape
        H = 32; Dh = D // H; W = 256
        qkv = (lambda x, *d: x.permute(*d))((x @ wqkv).reshape(B, S, 3, H, Dh), 2, 0, 3, 1, 4)
        q, k, v = qkv[0], qkv[1], qkv[2]
        scores = torch.einsum("bhqd,bhkd->bhqk", q, k) * (Dh ** -0.5)
        idx = torch.arange(S)
        mask = (idx[:, None] - idx[None, :] >= 0) & (idx[:, None] - idx[None, :] < W)
        scores = torch.where(mask[None, None], scores, -1e9)
        p = _softmax(scores, axis=-1)
        o = torch.einsum("bhqk,bhkd->bhqd", p, v)
        return (lambda x, *d: x.permute(*d))(o, 0, 2, 1, 3).reshape(B, S, D) @ wo

    def _B_ref(x, w1, w2, w3, w4):
        B, S, D = x.shape
        h = _gelu(_layernorm(x, axis=-1) @ w1)
        c = D // 4
        g0 = _pad(h[:, :, 0*c:1*c], ((0, 0), (1, 0), (0, 0)))[:, :S, :]
        g1 = _pad(h[:, :, 1*c:2*c], ((0, 0), (0, 1), (0, 0)))[:, 1:, :]
        g2 = _pad(h[:, :, 2*c:3*c], ((0, 0), (2, 0), (0, 0)))[:, :S, :]
        g3 = _pad(h[:, :, 3*c:   ], ((0, 0), (0, 2), (0, 0)))[:, 2:, :]
        hs = torch.concatenate([g0, g1, g2, g3], axis=-1) @ w2
        x1 = x + hs
        h2 = _gelu(_layernorm(x1, axis=-1) @ w3) @ w4
        return x1 + h2

    x = A_x
    xn = _layernorm(x, axis=-1)
    s = _A_ref(xn, A_wqkv, A_wo)
    g = _silu(_B_ref(xn, B_w1, B_w2, B_w3, B_w4))
    return x + s * g
```

```asm
; @launch grid=(256,1,1) block=(512,1,1) lds=163840
.amdgcn_target "amdgcn-amd-amdhsa--gfx950"
.text
.globl recurrent_scan__sliding_block__mixer_s_mlp__prompt_kernel
.p2align 8
.type recurrent_scan__sliding_block__mixer_s_mlp__prompt_kernel,@function
recurrent_scan__sliding_block__mixer_s_mlp__prompt_kernel:
    s_getpc_b64 s[26:27]
L_PC0:
    s_cmp_ge_u32 s2, 256
    s_cbranch_scc1 L_END
    s_load_dwordx16 s[4:19], s[0:1], 0
    s_load_dwordx4 s[20:23], s[0:1], 64
    s_load_dwordx2 s[24:25], s[0:1], 80
    v_lshrrev_b32 v1, 6, v0
    v_and_b32 v234, 63, v0
    v_readfirstlane_b32 s46, v1
    v_lshlrev_b32 v233, 3, v234
    s_and_b32 s49, s2, 1
    s_bfe_u32 s48, s2, 0x20001
    s_lshr_b32 s50, s2, 3
    s_and_b32 s47, s46, 3
    s_lshr_b32 s55, s47, 1
    s_and_b32 s56, s47, 1
    s_and_b32 s65, s2, 7
    s_and_b32 s64, s50, 3
    s_lshl2_add_u32 s63, s65, s64
    s_lshr_b32 s62, s50, 2
    s_and_b32 s65, s50, 7
    s_lshl3_add_u32 s51, s48, s65
    s_lshr_b32 s65, s50, 3
    s_lshl2_add_u32 s52, s49, s65
    s_lshl2_add_u32 s53, s48, s64
    s_cmp_lt_u32 s50, 28
    s_cselect_b32 s61, 1, 0
    s_mov_b32 s58, 0
    s_mov_b32 s98, 0x3f803f80
    s_mov_b32 s30, 2621440
    s_mov_b32 s31, 0x20000
    s_mov_b32 s34, 33554432
    s_mov_b32 s35, 0x20000
    s_mov_b32 s42, 2621440
    s_mov_b32 s43, 0x20000
    s_cmp_lt_u32 s46, 4
    s_cbranch_scc1 L_C0
    s_cmp_ge_u32 s50, 20
    s_cbranch_scc1 L_L1
    s_lshr_b32 s64, s50, 2
    s_mul_i32 s54, s49, 5
    s_add_u32 s54, s54, s64
    v_lshrrev_b32 v1, 3, v234
    s_lshl_b32 s64, s47, 5
    v_add_u32 v1, s64, v1
    v_mul_u32_u24 v1, 1280, v1
    v_and_b32 v2, 7, v234
    v_lshrrev_b32 v3, 4, v234
    v_xor_b32 v2, v2, v3
    v_xor_b32 v3, 4, v2
    v_lshl_add_u32 v226, v2, 4, v1
    v_lshl_add_u32 v227, v3, 4, v1
    v_add_u32 v228, 18432, v226
    v_add_u32 v227, 9216, v227
    v_add_u32 v229, 18432, v227
    s_mul_i32 s70, s53, 163840
    s_lshl_b32 s72, s47, 12
    s_add_u32 s72, s72, 0
    s_mov_b32 s74, 0
    v_lshrrev_b32 v1, 3, v234
    s_lshl_b32 s64, s47, 4
    v_add_u32 v1, s64, v1
    v_mul_u32_u24 v1, 3840, v1
    v_and_b32 v2, 7, v234
    v_bfe_u32 v3, v234, 4, 1
    v_lshlrev_b32 v3, 2, v3
    v_xor_b32 v2, v2, v3
    v_lshrrev_b32 v3, 5, v234
    v_lshlrev_b32 v3, 1, v3
    v_xor_b32 v2, v2, v3
    v_xor_b32 v3, 2, v2
    v_lshl_add_u32 v230, v2, 4, v1
    v_lshl_add_u32 v231, v3, 4, v1
    v_add_u32 v231, 29696, v231
    s_lshl_b32 s71, s54, 7
    s_lshl_b32 s73, s47, 11
    s_add_u32 s73, s73, 16384
    s_mov_b32 s75, 0
    s_waitcnt lgkmcnt(0)
    s_load_dwordx2 s[44:45], s[24:25], 0
    s_mov_b32 s28, s4
    s_mov_b32 s29, s5
    s_mov_b32 s32, s24
    s_mov_b32 s33, s25
    s_mov_b32 s40, s20
    s_mov_b32 s41, s21
    s_mov_b32 s36, s6
    s_mov_b32 s37, s7
    s_mov_b32 s38, 2457600
    s_mov_b32 s39, 0x20000
    s_mov_b32 s80, 1
L_pro_1:
    s_mov_b32 m0, s72
    s_add_u32 s74, s74, 1
    s_cmp_eq_u32 s74, 3
    s_mov_b32 s64, 40960
    s_cmov_b32 s64, 4294885376
    s_cmov_b32 s74, 0
    buffer_load_dwordx4 v226, s[28:31], s70 offen offset:0 lds
    buffer_load_dwordx4 v227, s[28:31], s70 offen offset:1024 lds
    buffer_load_dwordx4 v228, s[28:31], s70 offen offset:2048 lds
    buffer_load_dwordx4 v229, s[28:31], s70 offen offset:3072 lds
    s_add_u32 s72, s72, s64
    s_add_u32 s70, s70, 128
    s_mov_b32 m0, s73
    s_add_u32 s75, s75, 1
    s_cmp_eq_u32 s75, 3
    s_mov_b32 s64, 40960
    s_cmov_b32 s64, 4294885376
    s_cmov_b32 s75, 0
    buffer_load_dwordx4 v230, s[36:39], s71 offen offset:0 lds
    buffer_load_dwordx4 v231, s[36:39], s71 offen offset:1024 lds
    s_add_u32 m0, s73, 8192
    s_add_u32 s65, s71, 1280
    buffer_load_dwordx4 v230, s[36:39], s65 offen offset:0 lds
    buffer_load_dwordx4 v231, s[36:39], s65 offen offset:1024 lds
    s_add_u32 m0, s73, 16384
    s_add_u32 s65, s71, 2560
    buffer_load_dwordx4 v230, s[36:39], s65 offen offset:0 lds
    buffer_load_dwordx4 v231, s[36:39], s65 offen offset:1024 lds
    s_add_u32 s73, s73, s64
    s_add_u32 s71, s71, 245760
    s_sub_u32 s80, s80, 1
    s_cbranch_scc0 L_pro_1
    s_branch L_PQ_L
L_L1:
    s_cmp_lt_u32 s50, 28
    s_cbranch_scc1 L_L2
    s_cmp_eq_u32 s49, 1
    s_cbranch_scc1 L_L2
    s_waitcnt lgkmcnt(0)
    s_load_dwordx2 s[44:45], s[24:25], 0
    s_mov_b32 s28, s4
    s_mov_b32 s29, s5
    s_mov_b32 s32, s24
    s_mov_b32 s33, s25
    s_mov_b32 s40, s20
    s_mov_b32 s41, s21
    s_branch L_PACK
L_L2:
    s_sub_u32 s64, s50, 20
    s_lshr_b32 s64, s64, 2
    s_lshl1_add_u32 s54, s49, s64
    v_lshrrev_b32 v1, 3, v234
    s_lshl_b32 s64, s47, 5
    v_add_u32 v1, s64, v1
    v_mul_u32_u24 v1, 1280, v1
    v_and_b32 v2, 7, v234
    v_lshrrev_b32 v3, 4, v234
    v_xor_b32 v2, v2, v3
    v_xor_b32 v3, 4, v2
    v_lshl_add_u32 v226, v2, 4, v1
    v_lshl_add_u32 v227, v3, 4, v1
    v_add_u32 v228, 18432, v226
    v_add_u32 v227, 9216, v227
    v_add_u32 v229, 18432, v227
    s_mul_i32 s70, s53, 163840
    s_lshl_b32 s72, s47, 12
    s_add_u32 s72, s72, 0
    s_mov_b32 s74, 0
    v_lshrrev_b32 v1, 3, v234
    s_lshl_b32 s64, s47, 4
    v_add_u32 v1, s64, v1
    v_mul_u32_u24 v1, 1280, v1
    v_and_b32 v2, 7, v234
    v_bfe_u32 v3, v234, 4, 1
    v_lshlrev_b32 v3, 2, v3
    v_xor_b32 v2, v2, v3
    v_lshrrev_b32 v3, 5, v234
    v_lshlrev_b32 v3, 1, v3
    v_xor_b32 v2, v2, v3
    v_xor_b32 v3, 2, v2
    v_lshl_add_u32 v230, v2, 4, v1
    v_lshl_add_u32 v231, v3, 4, v1
    v_add_u32 v231, 9216, v231
    s_lshl_b32 s71, s54, 8
    s_lshl_b32 s73, s47, 11
    s_add_u32 s73, s73, 16384
    s_mov_b32 s75, 0
    s_waitcnt lgkmcnt(0)
    s_load_dwordx2 s[44:45], s[24:25], 0
    s_mov_b32 s28, s4
    s_mov_b32 s29, s5
    s_mov_b32 s32, s24
    s_mov_b32 s33, s25
    s_mov_b32 s40, s20
    s_mov_b32 s41, s21
    s_mov_b32 s36, s12
    s_mov_b32 s37, s13
    s_mov_b32 s38, 819200
    s_mov_b32 s39, 0x20000
    s_mov_b32 s80, 1
L_pro_2:
    s_mov_b32 m0, s72
    s_add_u32 s74, s74, 1
    s_cmp_eq_u32 s74, 3
    s_mov_b32 s64, 32768
    s_cmov_b32 s64, 4294901760
    s_cmov_b32 s74, 0
    buffer_load_dwordx4 v226, s[28:31], s70 offen offset:0 lds
    buffer_load_dwordx4 v227, s[28:31], s70 offen offset:1024 lds
    buffer_load_dwordx4 v228, s[28:31], s70 offen offset:2048 lds
    buffer_load_dwordx4 v229, s[28:31], s70 offen offset:3072 lds
    s_add_u32 s72, s72, s64
    s_add_u32 s70, s70, 128
    s_mov_b32 m0, s73
    s_add_u32 s75, s75, 1
    s_cmp_eq_u32 s75, 3
    s_mov_b32 s64, 32768
    s_cmov_b32 s64, 4294901760
    s_cmov_b32 s75, 0
    buffer_load_dwordx4 v230, s[36:39], s71 offen offset:0 lds
    buffer_load_dwordx4 v231, s[36:39], s71 offen offset:1024 lds
    s_add_u32 m0, s73, 8192
    s_add_u32 s65, s71, 128
    buffer_load_dwordx4 v230, s[36:39], s65 offen offset:0 lds
    buffer_load_dwordx4 v231, s[36:39], s65 offen offset:1024 lds
    s_add_u32 s73, s73, s64
    s_add_u32 s71, s71, 81920
    s_sub_u32 s80, s80, 1
    s_cbranch_scc0 L_pro_2
    s_branch L_P1_L
L_C0:
    s_cmp_lg_u32 s46, 3
    s_cbranch_scc1 L_cpf_3
    s_cmp_ge_u32 s50, (L_END-L_PC0+8191)/8192
    s_cbranch_scc1 L_cpf_3
    s_lshl_b32 s64, s50, 13
    v_lshl_add_u32 v1, v234, 7, s64
    v_min_u32 v1, L_END-L_PC0, v1
    global_load_dword v1, v1, s[26:27]
L_cpf_3:
    s_waitcnt lgkmcnt(0)
    s_load_dwordx2 s[44:45], s[24:25], 0
    s_mov_b32 s28, s4
    s_mov_b32 s29, s5
    s_mov_b32 s32, s24
    s_mov_b32 s33, s25
    s_mov_b32 s40, s20
    s_mov_b32 s41, s21
    s_lshl1_add_u32 s64, s48, s49
    s_lshl_b32 s64, s64, 5
    s_add_u32 s64, s64, s50
    s_lshl2_add_u32 s64, s64, s47
    s_lshl_b32 s72, s64, 7
    s_mul_i32 s64, s64, 2560
    v_lshrrev_b32 v2, 5, v234
    v_and_b32 v3, 31, v234
    v_mul_u32_u24 v4, 1280, v2
    v_lshl_add_u32 v4, v3, 4, v4
    v_mov_b32 v5, 67108864
    v_cmp_gt_u32 vcc, 16, v3
    s_nop 1
    v_cndmask_b32 v5, v5, v4, vcc
    buffer_load_dwordx4 v[8:11], v4, s[28:31], s64 offen
    buffer_load_dwordx4 v[12:15], v4, s[28:31], s64 offen offset:512
    buffer_load_dwordx4 v[16:19], v5, s[28:31], s64 offen offset:1024
    s_lshl1_add_u32 s64, s2, s47
    s_cmp_ge_u32 s47, 2
    s_cmov_b32 s64, 1000
    s_mul_i32 s84, s64, 52429
    s_lshr_b32 s84, s84, 19
    s_mul_i32 s85, s84, 10
    s_sub_u32 s85, s64, s85
    s_cmp_ge_u32 s84, 40
    s_cbranch_scc1 L_nocol_4
    s_cmp_lt_u32 s84, 30
    s_cselect_b32 s36, s6, s12
    s_cselect_b32 s37, s7, s13
    s_mov_b32 s38, 819200
    s_cmov_b32 s38, 2457600
    s_mov_b32 s39, 0x20000
    s_mov_b32 s64, 1280
    s_cmov_b32 s64, 3840
    s_cselect_b32 s68, 0, 30
    s_sub_u32 s65, s84, s68
    s_lshl_b32 s65, s65, 7
    s_lshl_b32 s66, s64, 3
    s_mul_i32 s67, s66, s85
    s_lshl3_add_u32 s65, s67, s65
    v_lshrrev_b32 v20, 3, v234
    v_mul_u32_u24 v20, s64, v20
    v_and_b32 v21, 7, v234
    v_lshl_add_u32 v20, v21, 4, v20
    buffer_load_dwordx4 v[32:35], v20, s[36:39], s65 offen
    s_add_u32 s65, s65, s66
    buffer_load_dwordx4 v[36:39], v20, s[36:39], s65 offen
    s_add_u32 s65, s65, s66
    buffer_load_dwordx4 v[40:43], v20, s[36:39], s65 offen
    s_add_u32 s65, s65, s66
    buffer_load_dwordx4 v[44:47], v20, s[36:39], s65 offen
    s_add_u32 s65, s65, s66
    buffer_load_dwordx4 v[48:51], v20, s[36:39], s65 offen
    s_add_u32 s65, s65, s66
    buffer_load_dwordx4 v[52:55], v20, s[36:39], s65 offen
    s_add_u32 s65, s65, s66
    buffer_load_dwordx4 v[56:59], v20, s[36:39], s65 offen
    s_add_u32 s65, s65, s66
    buffer_load_dwordx4 v[60:63], v20, s[36:39], s65 offen
    s_waitcnt vmcnt(8)
    s_branch L_nocol2_5
L_nocol_4:
    s_waitcnt vmcnt(0)
L_nocol2_5:
    v_mov_b32 v20, 0
    v_mov_b32 v21, 0
    v_mov_b32 v22, 0
    v_mov_b32 v23, 0
    v_dot2c_f32_bf16 v20, s98, v8
    v_dot2c_f32_bf16 v22, v8, v8
    v_dot2c_f32_bf16 v21, s98, v9
    v_dot2c_f32_bf16 v23, v9, v9
    v_dot2c_f32_bf16 v20, s98, v10
    v_dot2c_f32_bf16 v22, v10, v10
    v_dot2c_f32_bf16 v21, s98, v11
    v_dot2c_f32_bf16 v23, v11, v11
    v_dot2c_f32_bf16 v20, s98, v12
    v_dot2c_f32_bf16 v22, v12, v12
    v_dot2c_f32_bf16 v21, s98, v13
    v_dot2c_f32_bf16 v23, v13, v13
    v_dot2c_f32_bf16 v20, s98, v14
    v_dot2c_f32_bf16 v22, v14, v14
    v_dot2c_f32_bf16 v21, s98, v15
    v_dot2c_f32_bf16 v23, v15, v15
    v_dot2c_f32_bf16 v20, s98, v16
    v_dot2c_f32_bf16 v22, v16, v16
    v_dot2c_f32_bf16 v21, s98, v17
    v_dot2c_f32_bf16 v23, v17, v17
    v_dot2c_f32_bf16 v20, s98, v18
    v_dot2c_f32_bf16 v22, v18, v18
    v_dot2c_f32_bf16 v21, s98, v19
    v_dot2c_f32_bf16 v23, v19, v19
    s_nop 2
    v_add_f32 v20, v20, v21
    v_add_f32 v22, v22, v23
    s_nop 0
    v_add_f32_dpp v20, v20, v20 row_ror:8 row_mask:0xf bank_mask:0xf
    v_add_f32_dpp v22, v22, v22 row_ror:8 row_mask:0xf bank_mask:0xf
    s_nop 0
    v_add_f32_dpp v20, v20, v20 row_ror:4 row_mask:0xf bank_mask:0xf
    v_add_f32_dpp v22, v22, v22 row_ror:4 row_mask:0xf bank_mask:0xf
    s_nop 0
    v_add_f32_dpp v20, v20, v20 row_ror:2 row_mask:0xf bank_mask:0xf
    v_add_f32_dpp v22, v22, v22 row_ror:2 row_mask:0xf bank_mask:0xf
    s_nop 0
    v_add_f32_dpp v20, v20, v20 row_ror:1 row_mask:0xf bank_mask:0xf
    v_add_f32_dpp v22, v22, v22 row_ror:1 row_mask:0xf bank_mask:0xf
    s_nop 0
    v_mov_b32 v21, v20
    v_mov_b32 v23, v22
    s_nop 0
    v_permlane16_swap_b32 v20, v21
    v_permlane16_swap_b32 v22, v23
    v_add_f32 v20, v20, v21
    v_add_f32 v22, v22, v23
    v_mul_f32 v20, 0x3acccccd, v20
    v_mul_f32 v22, 0x3acccccd, v22
    v_fma_f32 v22, -v20, v20, v22
    v_max_f32 v22, 0, v22
    v_add_f32 v21, 0x3727c5ac, v22
    v_rsq_f32 v26, v21
    v_cvt_pk_bf16_f32 v24, -v20, -v20
    v_lshlrev_b32 v21, 16, v24
    v_add_f32_e64 v21, -v20, -v21
    v_cvt_pk_bf16_f32 v25, v21, 0
    v_mul_f32 v22, v22, v26
    v_fmaak_f32 v22, v22, v26, 0x3727c5ac
    v_rsq_f32 v22, v22
    s_nop 0
    v_mul_f32 v27, v22, v26
    s_add_u32 s72, s72, 1703936
    v_lshl_add_u32 v2, v3, 1, v2
    v_lshlrev_b32 v2, 4, v2
    s_mov_b32 exec_lo, 15
    s_mov_b32 exec_hi, 15
    buffer_store_dwordx4 v[24:27], v2, s[32:35], s72 offen sc1
    s_mov_b64 exec, -1
    s_cmp_ge_u32 s84, 40
    s_cbranch_scc1 L_p0d_6
    s_mov_b32 s64, 0x3f80
    s_mov_b32 s65, 0x3f800000
    v_mov_b32 v8, 0
    v_mov_b32 v9, 0
    v_mov_b32 v10, 0
    v_mov_b32 v11, 0
    v_mov_b32 v12, 0
    v_mov_b32 v13, 0
    v_mov_b32 v14, 0
    v_mov_b32 v15, 0
    s_waitcnt vmcnt(8)
    v_dot2c_f32_bf16 v8, s64, v32
    v_dot2c_f32_bf16 v9, s65, v32
    v_dot2c_f32_bf16 v10, s64, v33
    v_dot2c_f32_bf16 v11, s65, v33
    v_dot2c_f32_bf16 v12, s64, v34
    v_dot2c_f32_bf16 v13, s65, v34
    v_dot2c_f32_bf16 v14, s64, v35
    v_dot2c_f32_bf16 v15, s65, v35
    s_waitcnt vmcnt(7)
    v_dot2c_f32_bf16 v8, s64, v36
    v_dot2c_f32_bf16 v9, s65, v36
    v_dot2c_f32_bf16 v10, s64, v37
    v_dot2c_f32_bf16 v11, s65, v37
    v_dot2c_f32_bf16 v12, s64, v38
    v_dot2c_f32_bf16 v13, s65, v38
    v_dot2c_f32_bf16 v14, s64, v39
    v_dot2c_f32_bf16 v15, s65, v39
    s_waitcnt vmcnt(6)
    v_dot2c_f32_bf16 v8, s64, v40
    v_dot2c_f32_bf16 v9, s65, v40
    v_dot2c_f32_bf16 v10, s64, v41
    v_dot2c_f32_bf16 v11, s65, v41
    v_dot2c_f32_bf16 v12, s64, v42
    v_dot2c_f32_bf16 v13, s65, v42
    v_dot2c_f32_bf16 v14, s64, v43
    v_dot2c_f32_bf16 v15, s65, v43
    s_waitcnt vmcnt(5)
    v_dot2c_f32_bf16 v8, s64, v44
    v_dot2c_f32_bf16 v9, s65, v44
    v_dot2c_f32_bf16 v10, s64, v45
    v_dot2c_f32_bf16 v11, s65, v45
    v_dot2c_f32_bf16 v12, s64, v46
    v_dot2c_f32_bf16 v13, s65, v46
    v_dot2c_f32_bf16 v14, s64, v47
    v_dot2c_f32_bf16 v15, s65, v47
    s_waitcnt vmcnt(4)
    v_dot2c_f32_bf16 v8, s64, v48
    v_dot2c_f32_bf16 v9, s65, v48
    v_dot2c_f32_bf16 v10, s64, v49
    v_dot2c_f32_bf16 v11, s65, v49
    v_dot2c_f32_bf16 v12, s64, v50
    v_dot2c_f32_bf16 v13, s65, v50
    v_dot2c_f32_bf16 v14, s64, v51
    v_dot2c_f32_bf16 v15, s65, v51
    s_waitcnt vmcnt(3)
    v_dot2c_f32_bf16 v8, s64, v52
    v_dot2c_f32_bf16 v9, s65, v52
    v_dot2c_f32_bf16 v10, s64, v53
    v_dot2c_f32_bf16 v11, s65, v53
    v_dot2c_f32_bf16 v12, s64, v54
    v_dot2c_f32_bf16 v13, s65, v54
    v_dot2c_f32_bf16 v14, s64, v55
    v_dot2c_f32_bf16 v15, s65, v55
    s_waitcnt vmcnt(2)
    v_dot2c_f32_bf16 v8, s64, v56
    v_dot2c_f32_bf16 v9, s65, v56
    v_dot2c_f32_bf16 v10, s64, v57
    v_dot2c_f32_bf16 v11, s65, v57
    v_dot2c_f32_bf16 v12, s64, v58
    v_dot2c_f32_bf16 v13, s65, v58
    v_dot2c_f32_bf16 v14, s64, v59
    v_dot2c_f32_bf16 v15, s65, v59
    s_waitcnt vmcnt(1)
    v_dot2c_f32_bf16 v8, s64, v60
    v_dot2c_f32_bf16 v9, s65, v60
    v_dot2c_f32_bf16 v10, s64, v61
    v_dot2c_f32_bf16 v11, s65, v61
    v_dot2c_f32_bf16 v12, s64, v62
    v_dot2c_f32_bf16 v13, s65, v62
    v_dot2c_f32_bf16 v14, s64, v63
    v_dot2c_f32_bf16 v15, s65, v63
    s_nop 2
    v_permlane32_swap_b32 v8, v12
    v_permlane32_swap_b32 v9, v13
    v_permlane32_swap_b32 v10, v14
    v_permlane32_swap_b32 v11, v15
    v_add_f32 v8, v8, v12
    v_add_f32 v9, v9, v13
    v_add_f32 v10, v10, v14
    v_add_f32 v11, v11, v15
    v_and_b32 v12, 7, v234
    v_lshrrev_b32 v13, 4, v234
    v_permlane16_swap_b32 v8, v10
    v_permlane16_swap_b32 v9, v11
    v_add_f32 v8, v8, v10
    v_add_f32 v9, v9, v11
    v_lshlrev_b32 v12, 5, v12
    v_lshl_add_u32 v12, v13, 3, v12
    v_add_f32_dpp v8, v8, v8 row_ror:8 row_mask:0xf bank_mask:0xf
    v_add_f32_dpp v9, v9, v9 row_ror:8 row_mask:0xf bank_mask:0xf
    s_mul_i32 s64, s84, 10
    s_add_u32 s64, s64, s85
    s_lshl_b32 s64, s64, 8
    s_add_u32 s64, s64, 1376256
    s_mov_b32 exec_lo, 0x00ff00ff
    s_mov_b32 exec_hi, 0x00ff00ff
    buffer_store_dwordx2 v[8:9], v12, s[32:35], s64 offen sc1
    s_mov_b64 exec, -1
L_p0d_6:
    s_cmp_lt_u32 s50, 20
    s_cbranch_scc1 L_PQ_C
    s_cmp_lt_u32 s50, 28
    s_cbranch_scc1 L_P1_C
    s_cmp_eq_u32 s49, 1
    s_cbranch_scc1 L_P1_C
    s_branch L_PACK
L_PQ_C:
    s_lshr_b32 s64, s50, 2
    s_mul_i32 s54, s49, 5
    s_add_u32 s54, s54, s64
    v_and_b32 v180, 15, v234
    v_lshrrev_b32 v181, 4, v234
    s_lshl_b32 s64, s55, 13
    s_add_u32 s64, s64, 0
    v_lshrrev_b32 v182, 1, v180
    v_xor_b32 v182, v182, v181
    v_lshlrev_b32 v182, 4, v182
    v_lshl_add_u32 v182, v180, 7, v182
    v_xor_b32 v177, 64, v182
    v_add_u32 v176, s64, v182
    v_add_u32 v177, s64, v177
    v_bfe_u32 v182, v234, 2, 2
    v_lshl_add_u32 v178, v181, 3, v182
    v_and_b32 v179, 1, v181
    v_lshlrev_b32 v178, 7, v178
    v_lshl_add_u32 v178, v179, 5, v178
    v_lshrrev_b32 v182, 1, v182
    v_xor_b32 v182, s56, v182
    v_lshl_add_u32 v178, v182, 6, v178
    v_and_b32 v182, 3, v234
    v_lshl_add_u32 v178, v182, 3, v178
    v_xor_b32 v179, 32, v178
    v_add_u32 v178, 16384, v178
    v_add_u32 v179, 16384, v179
    s_lshl_b32 s64, s55, 8
    s_add_u32 s64, s64, 124928
    v_lshl_add_u32 v182, v181, 4, s64
    s_lshl_b32 s64, s56, 8
    s_add_u32 s64, s64, 125440
    v_lshl_add_u32 v181, v180, 3, s64
    s_lshl_b32 s64, s55, 10
    s_add_u32 s64, s64, 122880
    v_lshl_add_u32 v180, v180, 4, s64
    v_mov_b32 v186, 0
    v_mov_b32 v187, 0
    v_mov_b32 v190, 0
    v_mov_b32 v191, 0
    v_mov_b32 v194, 0
    v_mov_b32 v195, 0
    v_mov_b32 v198, 0
    v_mov_b32 v199, 0
    v_mov_b32 v200, 0
    v_mov_b32 v201, 0
    v_mov_b32 v202, 0
    v_mov_b32 v203, 0
    v_mov_b32 v204, 0
    v_mov_b32 v205, 0
    v_mov_b32 v206, 0
    v_mov_b32 v207, 0
    v_mov_b32 v208, 0
    v_mov_b32 v209, 0
    v_mov_b32 v210, 0
    v_mov_b32 v211, 0
    v_mov_b32 v212, 0
    v_mov_b32 v213, 0
    v_mov_b32 v214, 0
    v_mov_b32 v215, 0
    v_mov_b32 v216, 0
    v_mov_b32 v217, 0
    v_mov_b32 v218, 0
    v_mov_b32 v219, 0
    v_mov_b32 v220, 0
    v_mov_b32 v221, 0
    v_mov_b32 v222, 0
    v_mov_b32 v223, 0
    s_mov_b32 s57, 0
    s_mov_b32 s76, 0
    s_mov_b32 s77, 0
    s_waitcnt lgkmcnt(0)
    s_mul_i32 s64, s45, 0x4c957f2d
    s_mul_i32 s65, s44, 0x5851f42d
    s_mul_hi_u32 s66, s44, 0x4c957f2d
    s_mul_i32 s44, s44, 0x4c957f2d
    s_add_u32 s64, s64, s65
    s_add_u32 s45, s64, s66
    s_add_u32 s44, s44, 0xf767814f
    s_addc_u32 s45, s45, 0x14057b7e
    s_barrier
    ds_read_b128 v[96:99], v176 offset:0
    ds_read_b128 v[100:103], v176 offset:2048
    ds_read_b128 v[104:107], v176 offset:4096
    ds_read_b128 v[108:111], v176 offset:6144
    ds_read_b64_tr_b16 v[112:113], v178 offset:0
    ds_read_b64_tr_b16 v[114:115], v179 offset:512
    s_waitcnt lgkmcnt(0)
    v_mfma_f32_16x16x32_bf16 v[0:3], v[112:115], v[96:99], 0
    ds_read_b128 v[136:139], v177 offset:0
    v_mfma_f32_16x16x32_bf16 v[24:27], v[112:115], v[100:103], 0
    ds_read_b64_tr_b16 v[116:117], v179 offset:0
    ds_read_b64_tr_b16 v[118:119], v178 offset:512
    v_mfma_f32_16x16x32_bf16 v[48:51], v[112:115], v[104:107], 0
    ds_read_b64_tr_b16 v[152:153], v178 offset:4096
    v_mfma_f32_16x16x32_bf16 v[72:75], v[112:115], v[108:111], 0
    ds_read_b64_tr_b16 v[154:155], v179 offset:4608
    s_waitcnt lgkmcnt(2)
    v_mfma_f32_16x16x32_bf16 v[4:7], v[116:119], v[96:99], 0
    v_mfma_f32_16x16x32_bf16 v[28:31], v[116:119], v[100:103], 0
    ds_read_b64_tr_b16 v[120:121], v178 offset:8192
    ds_read_b64_tr_b16 v[122:123], v179 offset:8704
    ds_read_b128 v[140:143], v177 offset:2048
    v_mfma_f32_16x16x32_bf16 v[52:55], v[116:119], v[104:107], 0
    ds_read_b128 v[144:147], v177 offset:4096
    v_mfma_f32_16x16x32_bf16 v[76:79], v[116:119], v[108:111], 0
    s_waitcnt lgkmcnt(2)
    v_mfma_f32_16x16x32_bf16 v[8:11], v[120:123], v[96:99], 0
    ds_read_b128 v[148:151], v177 offset:6144
    v_mfma_f32_16x16x32_bf16 v[32:35], v[120:123], v[100:103], 0
    ds_read_b64_tr_b16 v[124:125], v179 offset:8192
    ds_read_b64_tr_b16 v[126:127], v178 offset:8704
    ds_read_b64_tr_b16 v[156:157], v179 offset:4096
    v_mfma_f32_16x16x32_bf16 v[56:59], v[120:123], v[104:107], 0
    v_mfma_f32_16x16x32_bf16 v[80:83], v[120:123], v[108:111], 0
    ds_read_b64_tr_b16 v[158:159], v178 offset:4608
    s_waitcnt lgkmcnt(2)
    v_mfma_f32_16x16x32_bf16 v[12:15], v[124:127], v[96:99], 0
    ds_read_b64_tr_b16 v[160:161], v178 offset:12288
    v_mfma_f32_16x16x32_bf16 v[36:39], v[124:127], v[100:103], 0
    ds_read_b64_tr_b16 v[128:129], v178 offset:16384
    ds_read_b64_tr_b16 v[130:131], v179 offset:16896
    v_mfma_f32_16x16x32_bf16 v[60:63], v[124:127], v[104:107], 0
    ds_read_b64_tr_b16 v[162:163], v179 offset:12800
    v_mfma_f32_16x16x32_bf16 v[84:87], v[124:127], v[108:111], 0
    ds_read_b64_tr_b16 v[164:165], v179 offset:12288
    s_waitcnt lgkmcnt(2)
    v_mfma_f32_16x16x32_bf16 v[16:19], v[96:99], v[128:131], 0
    v_mfma_f32_16x16x32_bf16 v[40:43], v[100:103], v[128:131], 0
    ds_read_b64_tr_b16 v[132:133], v179 offset:16384
    ds_read_b64_tr_b16 v[134:135], v178 offset:16896
    ds_read_b64_tr_b16 v[166:167], v178 offset:12800
    v_mfma_f32_16x16x32_bf16 v[64:67], v[104:107], v[128:131], 0
    ds_read_b64_tr_b16 v[168:169], v178 offset:20480
    s_add_u32 s76, s76, 1
    v_mfma_f32_16x16x32_bf16 v[88:91], v[108:111], v[128:131], 0
    s_cmp_eq_u32 s76, 3
    s_waitcnt lgkmcnt(2)
    v_mfma_f32_16x16x32_bf16 v[20:23], v[96:99], v[132:135], 0
    ds_read_b64_tr_b16 v[170:171], v179 offset:20992
    s_mov_b32 s78, 40960
    v_mfma_f32_16x16x32_bf16 v[44:47], v[100:103], v[132:135], 0
    ds_read_b64_tr_b16 v[172:173], v179 offset:20480
    s_cmov_b32 s78, 4294885376
    v_mfma_f32_16x16x32_bf16 v[68:71], v[104:107], v[132:135], 0
    s_cmov_b32 s76, 0
    v_mfma_f32_16x16x32_bf16 v[92:95], v[108:111], v[132:135], 0
    ds_read_b64_tr_b16 v[174:175], v178 offset:20992
    s_cmp_lg_u32 s57, 0
    s_cbranch_scc1 L_hk_10
    s_lshl2_add_u32 s64, s2, s47
    s_lshl_b32 s64, s64, 7
    s_add_u32 s64, s64, 856064
    s_waitcnt vmcnt(0)
    v_mov_b32 v230, s44
    v_mov_b32 v231, s45
    s_mov_b64 exec, 0xffff
    buffer_store_dwordx2 v[230:231], v233, s[32:35], s64 offen sc1
    s_mov_b64 exec, -1
L_hk_10:
    s_branch L_cstep1_8
L_cloop_7:
    s_waitcnt lgkmcnt(0)
    v_mfma_f32_16x16x32_bf16 v[0:3], v[112:115], v[96:99], v[0:3]
    ds_read_b128 v[136:139], v177 offset:0
    v_mfma_f32_16x16x32_bf16 v[24:27], v[112:115], v[100:103], v[24:27]
    ds_read_b64_tr_b16 v[116:117], v179 offset:0
    ds_read_b64_tr_b16 v[118:119], v178 offset:512
    v_mfma_f32_16x16x32_bf16 v[48:51], v[112:115], v[104:107], v[48:51]
    ds_read_b64_tr_b16 v[152:153], v178 offset:4096
    v_mfma_f32_16x16x32_bf16 v[72:75], v[112:115], v[108:111], v[72:75]
    ds_read_b64_tr_b16 v[154:155], v179 offset:4608
    s_waitcnt lgkmcnt(2)
    v_mfma_f32_16x16x32_bf16 v[4:7], v[116:119], v[96:99], v[4:7]
    v_mfma_f32_16x16x32_bf16 v[28:31], v[116:119], v[100:103], v[28:31]
    ds_read_b64_tr_b16 v[120:121], v178 offset:8192
    ds_read_b64_tr_b16 v[122:123], v179 offset:8704
    ds_read_b128 v[140:143], v177 offset:2048
    v_mfma_f32_16x16x32_bf16 v[52:55], v[116:119], v[104:107], v[52:55]
    ds_read_b128 v[144:147], v177 offset:4096
    v_mfma_f32_16x16x32_bf16 v[76:79], v[116:119], v[108:111], v[76:79]
    s_waitcnt lgkmcnt(2)
    v_mfma_f32_16x16x32_bf16 v[8:11], v[120:123], v[96:99], v[8:11]
    ds_read_b128 v[148:151], v177 offset:6144
    v_mfma_f32_16x16x32_bf16 v[32:35], v[120:123], v[100:103], v[32:35]
    ds_read_b64_tr_b16 v[124:125], v179 offset:8192
    ds_read_b64_tr_b16 v[126:127], v178 offset:8704
    ds_read_b64_tr_b16 v[156:157], v179 offset:4096
    v_mfma_f32_16x16x32_bf16 v[56:59], v[120:123], v[104:107], v[56:59]
    v_mfma_f32_16x16x32_bf16 v[80:83], v[120:123], v[108:111], v[80:83]
    ds_read_b64_tr_b16 v[158:159], v178 offset:4608
    s_waitcnt lgkmcnt(2)
    v_mfma_f32_16x16x32_bf16 v[12:15], v[124:127], v[96:99], v[12:15]
    ds_read_b64_tr_b16 v[160:161], v178 offset:12288
    v_mfma_f32_16x16x32_bf16 v[36:39], v[124:127], v[100:103], v[36:39]
    ds_read_b64_tr_b16 v[128:129], v178 offset:16384
    ds_read_b64_tr_b16 v[130:131], v179 offset:16896
    v_mfma_f32_16x16x32_bf16 v[60:63], v[124:127], v[104:107], v[60:63]
    ds_read_b64_tr_b16 v[162:163], v179 offset:12800
    v_mfma_f32_16x16x32_bf16 v[84:87], v[124:127], v[108:111], v[84:87]
    ds_read_b64_tr_b16 v[164:165], v179 offset:12288
    s_waitcnt lgkmcnt(2)
    v_mfma_f32_16x16x32_bf16 v[16:19], v[96:99], v[128:131], v[16:19]
    v_mfma_f32_16x16x32_bf16 v[40:43], v[100:103], v[128:131], v[40:43]
    ds_read_b64_tr_b16 v[132:133], v179 offset:16384
    ds_read_b64_tr_b16 v[134:135], v178 offset:16896
    ds_read_b64_tr_b16 v[166:167], v178 offset:12800
    v_mfma_f32_16x16x32_bf16 v[64:67], v[104:107], v[128:131], v[64:67]
    ds_read_b64_tr_b16 v[168:169], v178 offset:20480
    s_add_u32 s76, s76, 1
    v_mfma_f32_16x16x32_bf16 v[88:91], v[108:111], v[128:131], v[88:91]
    s_cmp_eq_u32 s76, 3
    s_waitcnt lgkmcnt(2)
    v_mfma_f32_16x16x32_bf16 v[20:23], v[96:99], v[132:135], v[20:23]
    ds_read_b64_tr_b16 v[170:171], v179 offset:20992
    s_mov_b32 s78, 40960
    v_mfma_f32_16x16x32_bf16 v[44:47], v[100:103], v[132:135], v[44:47]
    ds_read_b64_tr_b16 v[172:173], v179 offset:20480
    s_cmov_b32 s78, 4294885376
    v_mfma_f32_16x16x32_bf16 v[68:71], v[104:107], v[132:135], v[68:71]
    s_cmov_b32 s76, 0
    v_mfma_f32_16x16x32_bf16 v[92:95], v[108:111], v[132:135], v[92:95]
    ds_read_b64_tr_b16 v[174:175], v178 offset:20992
    s_cmp_lg_u32 s57, 0
    s_cbranch_scc1 L_hk_11
    s_lshl2_add_u32 s64, s2, s47
    s_lshl_b32 s64, s64, 7
    s_add_u32 s64, s64, 856064
    s_waitcnt vmcnt(0)
    v_mov_b32 v230, s44
    v_mov_b32 v231, s45
    s_mov_b64 exec, 0xffff
    buffer_store_dwordx2 v[230:231], v233, s[32:35], s64 offen sc1
    s_mov_b64 exec, -1
L_hk_11:
L_cstep1_8:
    s_waitcnt lgkmcnt(0)
    v_mfma_f32_16x16x32_bf16 v[0:3], v[152:155], v[136:139], v[0:3]
    v_add_u32 v176, s78, v176
    v_add_u32 v177, s78, v177
    v_mfma_f32_16x16x32_bf16 v[24:27], v[152:155], v[140:143], v[24:27]
    v_add_u32 v178, s78, v178
    v_add_u32 v179, s78, v179
    s_cmp_eq_u32 s57, 9
    v_mfma_f32_16x16x32_bf16 v[48:51], v[152:155], v[144:147], v[48:51]
    s_barrier
    s_cbranch_scc1 L_clast_9
    ds_read_b128 v[96:99], v176 offset:0
    v_mfma_f32_16x16x32_bf16 v[72:75], v[152:155], v[148:151], v[72:75]
    v_mfma_f32_16x16x32_bf16 v[4:7], v[156:159], v[136:139], v[4:7]
    v_mfma_f32_16x16x32_bf16 v[28:31], v[156:159], v[140:143], v[28:31]
    v_mfma_f32_16x16x32_bf16 v[52:55], v[156:159], v[144:147], v[52:55]
    ds_read_b128 v[100:103], v176 offset:2048
    v_mfma_f32_16x16x32_bf16 v[76:79], v[156:159], v[148:151], v[76:79]
    v_mfma_f32_16x16x32_bf16 v[8:11], v[160:163], v[136:139], v[8:11]
    v_mfma_f32_16x16x32_bf16 v[32:35], v[160:163], v[140:143], v[32:35]
    v_mfma_f32_16x16x32_bf16 v[56:59], v[160:163], v[144:147], v[56:59]
    ds_read_b128 v[104:107], v176 offset:4096
    v_mfma_f32_16x16x32_bf16 v[80:83], v[160:163], v[148:151], v[80:83]
    v_mfma_f32_16x16x32_bf16 v[12:15], v[164:167], v[136:139], v[12:15]
    v_mfma_f32_16x16x32_bf16 v[36:39], v[164:167], v[140:143], v[36:39]
    v_mfma_f32_16x16x32_bf16 v[60:63], v[164:167], v[144:147], v[60:63]
    v_mfma_f32_16x16x32_bf16 v[84:87], v[164:167], v[148:151], v[84:87]
    ds_read_b128 v[108:111], v176 offset:6144
    v_mfma_f32_16x16x32_bf16 v[16:19], v[136:139], v[168:171], v[16:19]
    v_mfma_f32_16x16x32_bf16 v[40:43], v[140:143], v[168:171], v[40:43]
    v_mfma_f32_16x16x32_bf16 v[64:67], v[144:147], v[168:171], v[64:67]
    v_mfma_f32_16x16x32_bf16 v[88:91], v[148:151], v[168:171], v[88:91]
    ds_read_b64_tr_b16 v[112:113], v178 offset:0
    v_mfma_f32_16x16x32_bf16 v[20:23], v[136:139], v[172:175], v[20:23]
    v_mfma_f32_16x16x32_bf16 v[44:47], v[140:143], v[172:175], v[44:47]
    s_add_u32 s57, s57, 1
    v_mfma_f32_16x16x32_bf16 v[68:71], v[144:147], v[172:175], v[68:71]
    v_mfma_f32_16x16x32_bf16 v[92:95], v[148:151], v[172:175], v[92:95]
    ds_read_b64_tr_b16 v[114:115], v179 offset:512
    s_branch L_cloop_7
L_clast_9:
    v_mfma_f32_16x16x32_bf16 v[72:75], v[152:155], v[148:151], v[72:75]
    ds_read_b64 v[184:185], v180 offset:0
    v_mfma_f32_16x16x32_bf16 v[4:7], v[156:159], v[136:139], v[4:7]
    ds_read_b64 v[188:189], v180 offset:256
    v_mfma_f32_16x16x32_bf16 v[28:31], v[156:159], v[140:143], v[28:31]
    ds_read_b64 v[192:193], v180 offset:512
    v_mfma_f32_16x16x32_bf16 v[52:55], v[156:159], v[144:147], v[52:55]
    ds_read_b64 v[196:197], v180 offset:768
    v_mfma_f32_16x16x32_bf16 v[76:79], v[156:159], v[148:151], v[76:79]
    s_mov_b64 exec, 0xffff
    ds_read_b64 v[200:201], v181 offset:0
    ds_read_b64 v[204:205], v181 offset:128
    s_mov_b64 exec, -1
    v_mfma_f32_16x16x32_bf16 v[8:11], v[160:163], v[136:139], v[8:11]
    s_mov_b64 exec, 0xffff
    ds_read_b64 v[208:209], v181 offset:512
    ds_read_b64 v[212:213], v181 offset:640
    s_mov_b64 exec, -1
    v_mfma_f32_16x16x32_bf16 v[32:35], v[160:163], v[140:143], v[32:35]
    s_mov_b64 exec, 0xffff
    ds_read_b64 v[216:217], v181 offset:1024
    ds_read_b64 v[220:221], v181 offset:1152
    s_mov_b64 exec, -1
    v_mfma_f32_16x16x32_bf16 v[56:59], v[160:163], v[144:147], v[56:59]
    ds_read_b64 v[224:225], v180 offset:8
    v_mfma_f32_16x16x32_bf16 v[80:83], v[160:163], v[148:151], v[80:83]
    ds_read_b64 v[226:227], v180 offset:264
    v_mfma_f32_16x16x32_bf16 v[12:15], v[164:167], v[136:139], v[12:15]
    ds_read_b64 v[228:229], v180 offset:520
    v_mfma_f32_16x16x32_bf16 v[36:39], v[164:167], v[140:143], v[36:39]
    ds_read_b64 v[230:231], v180 offset:776
    v_mfma_f32_16x16x32_bf16 v[60:63], v[164:167], v[144:147], v[60:63]
    ds_read_b128 v[96:99], v182 offset:0
    v_mfma_f32_16x16x32_bf16 v[84:87], v[164:167], v[148:151], v[84:87]
    ds_read_b128 v[100:103], v182 offset:64
    v_mfma_f32_16x16x32_bf16 v[16:19], v[136:139], v[168:171], v[16:19]
    ds_read_b128 v[104:107], v182 offset:128
    v_mfma_f32_16x16x32_bf16 v[40:43], v[140:143], v[168:171], v[40:43]
    ds_read_b128 v[108:111], v182 offset:192
    v_mfma_f32_16x16x32_bf16 v[64:67], v[144:147], v[168:171], v[64:67]
    v_mfma_f32_16x16x32_bf16 v[88:91], v[148:151], v[168:171], v[88:91]
    v_mfma_f32_16x16x32_bf16 v[20:23], v[136:139], v[172:175], v[20:23]
    v_mfma_f32_16x16x32_bf16 v[44:47], v[140:143], v[172:175], v[44:47]
    v_mfma_f32_16x16x32_bf16 v[68:71], v[144:147], v[172:175], v[68:71]
    v_mfma_f32_16x16x32_bf16 v[92:95], v[148:151], v[172:175], v[92:95]
    s_waitcnt lgkmcnt(0)
    v_mfma_f32_16x16x32_bf16 v[0:3], v[200:203], v[184:187], v[0:3]
    s_barrier
    v_mfma_f32_16x16x32_bf16 v[24:27], v[200:203], v[188:191], v[24:27]
    v_mfma_f32_16x16x32_bf16 v[48:51], v[200:203], v[192:195], v[48:51]
    v_mfma_f32_16x16x32_bf16 v[72:75], v[200:203], v[196:199], v[72:75]
    v_mfma_f32_16x16x32_bf16 v[4:7], v[204:207], v[184:187], v[4:7]
    v_mfma_f32_16x16x32_bf16 v[28:31], v[204:207], v[188:191], v[28:31]
    v_mfma_f32_16x16x32_bf16 v[52:55], v[204:207], v[192:195], v[52:55]
    v_mfma_f32_16x16x32_bf16 v[76:79], v[204:207], v[196:199], v[76:79]
    v_mfma_f32_16x16x32_bf16 v[8:11], v[208:211], v[184:187], v[8:11]
    v_mfma_f32_16x16x32_bf16 v[32:35], v[208:211], v[188:191], v[32:35]
    v_mfma_f32_16x16x32_bf16 v[56:59], v[208:211], v[192:195], v[56:59]
    v_mfma_f32_16x16x32_bf16 v[80:83], v[208:211], v[196:199], v[80:83]
    v_mfma_f32_16x16x32_bf16 v[12:15], v[212:215], v[184:187], v[12:15]
    v_mfma_f32_16x16x32_bf16 v[36:39], v[212:215], v[188:191], v[36:39]
    v_mfma_f32_16x16x32_bf16 v[60:63], v[212:215], v[192:195], v[60:63]
    v_mfma_f32_16x16x32_bf16 v[84:87], v[212:215], v[196:199], v[84:87]
    v_mfma_f32_16x16x32_bf16 v[16:19], v[184:187], v[216:219], v[16:19]
    v_mfma_f32_16x16x32_bf16 v[40:43], v[188:191], v[216:219], v[40:43]
    v_mfma_f32_16x16x32_bf16 v[64:67], v[192:195], v[216:219], v[64:67]
    v_mfma_f32_16x16x32_bf16 v[88:91], v[196:199], v[216:219], v[88:91]
    v_mfma_f32_16x16x32_bf16 v[20:23], v[184:187], v[220:223], v[20:23]
    v_mfma_f32_16x16x32_bf16 v[44:47], v[188:191], v[220:223], v[44:47]
    v_mfma_f32_16x16x32_bf16 v[68:71], v[192:195], v[220:223], v[68:71]
    v_mfma_f32_16x16x32_bf16 v[92:95], v[196:199], v[220:223], v[92:95]
    s_setprio 2
    v_mul_f32 v225, 0x3ea52b5c, v224
    v_mul_f32 v227, 0x3ea52b5c, v226
    v_mul_f32 v229, 0x3ea52b5c, v228
    v_mul_f32 v231, 0x3ea52b5c, v230
    v_and_b32 v112, 15, v234
    v_lshrrev_b32 v113, 4, v234
    v_lshlrev_b32 v114, 3, v112
    v_lshl_add_u32 v114, v113, 14, v114
    v_and_b32 v115, 1, v113
    v_mul_u32_u24 v115, 10240, v115
    v_lshl_add_u32 v115, v112, 4, v115
    v_lshrrev_b32 v113, 1, v113
    v_lshl_add_u32 v115, v113, 8, v115
    s_lshl1_add_u32 s64, s54, s56
    s_lshl1_add_u32 s65, s53, s55
    s_lshl_b32 s66, s64, 17
    s_lshl_b32 s67, s65, 9
    s_add_u32 s66, s66, s67
    s_add_u32 s66, s66, 4718592
    s_mul_i32 s67, s65, 81920
    s_lshl_b32 s68, s64, 9
    s_add_u32 s67, s67, s68
    s_add_u32 s67, s67, 9961472
    s_lshl_b32 s65, s65, 5
    s_add_u32 s65, s65, s64
    s_lshl_b32 s65, s65, 7
    s_add_u32 s93, s65, 69632
    v_pk_mul_f32 v[0:1], v[0:1], v[224:225] op_sel:[0,1] op_sel_hi:[1,1]
    v_pk_mul_f32 v[2:3], v[2:3], v[224:225] op_sel:[0,1] op_sel_hi:[1,1]
    v_pk_mul_f32 v[24:25], v[24:25], v[226:227] op_sel:[0,1] op_sel_hi:[1,1]
    v_pk_mul_f32 v[26:27], v[26:27], v[226:227] op_sel:[0,1] op_sel_hi:[1,1]
    v_pk_mul_f32 v[48:49], v[48:49], v[228:229] op_sel:[0,1] op_sel_hi:[1,1]
    v_pk_mul_f32 v[50:51], v[50:51], v[228:229] op_sel:[0,1] op_sel_hi:[1,1]
    v_pk_mul_f32 v[72:73], v[72:73], v[230:231] op_sel:[0,1] op_sel_hi:[1,1]
    v_pk_mul_f32 v[74:75], v[74:75], v[230:231] op_sel:[0,1] op_sel_hi:[1,1]
    s_add_u32 s68, s66, 0
    v_cvt_pk_bf16_f32 v120, v0, v1
    v_cvt_pk_bf16_f32 v121, v2, v3
    v_cvt_pk_bf16_f32 v122, v24, v25
    v_cvt_pk_bf16_f32 v123, v26, v27
    v_cvt_pk_bf16_f32 v124, v48, v49
    v_cvt_pk_bf16_f32 v125, v50, v51
    v_cvt_pk_bf16_f32 v126, v72, v73
    v_cvt_pk_bf16_f32 v127, v74, v75
    buffer_store_dwordx2 v[120:121], v114, s[32:35], s68 offen offset:0 sc1
    buffer_store_dwordx2 v[122:123], v114, s[32:35], s68 offen offset:128 sc1
    buffer_store_dwordx2 v[124:125], v114, s[32:35], s68 offen offset:256 sc1
    buffer_store_dwordx2 v[126:127], v114, s[32:35], s68 offen offset:384 sc1
    v_pk_mul_f32 v[4:5], v[4:5], v[224:225] op_sel:[0,1] op_sel_hi:[1,1]
    v_pk_mul_f32 v[6:7], v[6:7], v[224:225] op_sel:[0,1] op_sel_hi:[1,1]
    v_pk_mul_f32 v[28:29], v[28:29], v[226:227] op_sel:[0,1] op_sel_hi:[1,1]
    v_pk_mul_f32 v[30:31], v[30:31], v[226:227] op_sel:[0,1] op_sel_hi:[1,1]
    v_pk_mul_f32 v[52:53], v[52:53], v[228:229] op_sel:[0,1] op_sel_hi:[1,1]
    v_pk_mul_f32 v[54:55], v[54:55], v[228:229] op_sel:[0,1] op_sel_hi:[1,1]
    v_pk_mul_f32 v[76:77], v[76:77], v[230:231] op_sel:[0,1] op_sel_hi:[1,1]
    v_pk_mul_f32 v[78:79], v[78:79], v[230:231] op_sel:[0,1] op_sel_hi:[1,1]
    s_add_u32 s68, s66, 65536
    v_cvt_pk_bf16_f32 v128, v4, v5
    v_cvt_pk_bf16_f32 v129, v6, v7
    v_cvt_pk_bf16_f32 v130, v28, v29
    v_cvt_pk_bf16_f32 v131, v30, v31
    v_cvt_pk_bf16_f32 v132, v52, v53
    v_cvt_pk_bf16_f32 v133, v54, v55
    v_cvt_pk_bf16_f32 v134, v76, v77
    v_cvt_pk_bf16_f32 v135, v78, v79
    buffer_store_dwordx2 v[128:129], v114, s[32:35], s68 offen offset:0 sc1
    buffer_store_dwordx2 v[130:131], v114, s[32:35], s68 offen offset:128 sc1
    buffer_store_dwordx2 v[132:133], v114, s[32:35], s68 offen offset:256 sc1
    buffer_store_dwordx2 v[134:135], v114, s[32:35], s68 offen offset:384 sc1
    v_pk_mul_f32 v[8:9], v[8:9], v[224:225] op_sel_hi:[1,0]
    v_pk_mul_f32 v[10:11], v[10:11], v[224:225] op_sel_hi:[1,0]
    v_pk_mul_f32 v[32:33], v[32:33], v[226:227] op_sel_hi:[1,0]
    v_pk_mul_f32 v[34:35], v[34:35], v[226:227] op_sel_hi:[1,0]
    v_pk_mul_f32 v[56:57], v[56:57], v[228:229] op_sel_hi:[1,0]
    v_pk_mul_f32 v[58:59], v[58:59], v[228:229] op_sel_hi:[1,0]
    v_pk_mul_f32 v[80:81], v[80:81], v[230:231] op_sel_hi:[1,0]
    v_pk_mul_f32 v[82:83], v[82:83], v[230:231] op_sel_hi:[1,0]
    s_add_u32 s68, s66, 2621440
    v_cvt_pk_bf16_f32 v120, v8, v9
    v_cvt_pk_bf16_f32 v121, v10, v11
    v_cvt_pk_bf16_f32 v122, v32, v33
    v_cvt_pk_bf16_f32 v123, v34, v35
    v_cvt_pk_bf16_f32 v124, v56, v57
    v_cvt_pk_bf16_f32 v125, v58, v59
    v_cvt_pk_bf16_f32 v126, v80, v81
    v_cvt_pk_bf16_f32 v127, v82, v83
    buffer_store_dwordx2 v[120:121], v114, s[32:35], s68 offen offset:0 sc1
    buffer_store_dwordx2 v[122:123], v114, s[32:35], s68 offen offset:128 sc1
    buffer_store_dwordx2 v[124:125], v114, s[32:35], s68 offen offset:256 sc1
    buffer_store_dwordx2 v[126:127], v114, s[32:35], s68 offen offset:384 sc1
    v_pk_mul_f32 v[12:13], v[12:13], v[224:225] op_sel_hi:[1,0]
    v_pk_mul_f32 v[14:15], v[14:15], v[224:225] op_sel_hi:[1,0]
    v_pk_mul_f32 v[36:37], v[36:37], v[226:227] op_sel_hi:[1,0]
    v_pk_mul_f32 v[38:39], v[38:39], v[226:227] op_sel_hi:[1,0]
    v_pk_mul_f32 v[60:61], v[60:61], v[228:229] op_sel_hi:[1,0]
    v_pk_mul_f32 v[62:63], v[62:63], v[228:229] op_sel_hi:[1,0]
    v_pk_mul_f32 v[84:85], v[84:85], v[230:231] op_sel_hi:[1,0]
    v_pk_mul_f32 v[86:87], v[86:87], v[230:231] op_sel_hi:[1,0]
    s_add_u32 s68, s66, 2686976
    v_cvt_pk_bf16_f32 v128, v12, v13
    v_cvt_pk_bf16_f32 v129, v14, v15
    v_cvt_pk_bf16_f32 v130, v36, v37
    v_cvt_pk_bf16_f32 v131, v38, v39
    v_cvt_pk_bf16_f32 v132, v60, v61
    v_cvt_pk_bf16_f32 v133, v62, v63
    v_cvt_pk_bf16_f32 v134, v84, v85
    v_cvt_pk_bf16_f32 v135, v86, v87
    buffer_store_dwordx2 v[128:129], v114, s[32:35], s68 offen offset:0 sc1
    buffer_store_dwordx2 v[130:131], v114, s[32:35], s68 offen offset:128 sc1
    buffer_store_dwordx2 v[132:133], v114, s[32:35], s68 offen offset:256 sc1
    buffer_store_dwordx2 v[134:135], v114, s[32:35], s68 offen offset:384 sc1
    s_barrier
    v_pk_mul_f32 v[16:17], v[16:17], v[96:97]
    v_pk_mul_f32 v[18:19], v[18:19], v[98:99]
    v_pk_mul_f32 v[20:21], v[20:21], v[96:97]
    v_pk_mul_f32 v[22:23], v[22:23], v[98:99]
    v_cvt_pk_bf16_f32 v136, v16, v17
    v_cvt_pk_bf16_f32 v137, v18, v19
    v_cvt_pk_bf16_f32 v138, v20, v21
    v_cvt_pk_bf16_f32 v139, v22, v23
    s_add_u32 s68, s67, 0
    s_nop 0
    v_permlane32_swap_b32 v136, v138
    v_permlane32_swap_b32 v137, v139
    buffer_store_dwordx4 v[136:139], v115, s[32:35], s68 offen sc1
    v_pk_mul_f32 v[40:41], v[40:41], v[100:101]
    v_pk_mul_f32 v[42:43], v[42:43], v[102:103]
    v_pk_mul_f32 v[44:45], v[44:45], v[100:101]
    v_pk_mul_f32 v[46:47], v[46:47], v[102:103]
    v_cvt_pk_bf16_f32 v140, v40, v41
    v_cvt_pk_bf16_f32 v141, v42, v43
    v_cvt_pk_bf16_f32 v142, v44, v45
    v_cvt_pk_bf16_f32 v143, v46, v47
    s_add_u32 s68, s67, 20480
    s_nop 0
    v_permlane32_swap_b32 v140, v142
    v_permlane32_swap_b32 v141, v143
    buffer_store_dwordx4 v[140:143], v115, s[32:35], s68 offen sc1
    v_pk_mul_f32 v[64:65], v[64:65], v[104:105]
    v_pk_mul_f32 v[66:67], v[66:67], v[106:107]
    v_pk_mul_f32 v[68:69], v[68:69], v[104:105]
    v_pk_mul_f32 v[70:71], v[70:71], v[106:107]
    v_cvt_pk_bf16_f32 v144, v64, v65
    v_cvt_pk_bf16_f32 v145, v66, v67
    v_cvt_pk_bf16_f32 v146, v68, v69
    v_cvt_pk_bf16_f32 v147, v70, v71
    s_add_u32 s68, s67, 40960
    s_nop 0
    v_permlane32_swap_b32 v144, v146
    v_permlane32_swap_b32 v145, v147
    buffer_store_dwordx4 v[144:147], v115, s[32:35], s68 offen sc1
    v_pk_mul_f32 v[88:89], v[88:89], v[108:109]
    v_pk_mul_f32 v[90:91], v[90:91], v[110:111]
    v_pk_mul_f32 v[92:93], v[92:93], v[108:109]
    v_pk_mul_f32 v[94:95], v[94:95], v[110:111]
    v_cvt_pk_bf16_f32 v148, v88, v89
    v_cvt_pk_bf16_f32 v149, v90, v91
    v_cvt_pk_bf16_f32 v150, v92, v93
    v_cvt_pk_bf16_f32 v151, v94, v95
    s_add_u32 s68, s67, 61440
    s_nop 0
    v_permlane32_swap_b32 v148, v150
    v_permlane32_swap_b32 v149, v151
    buffer_store_dwordx4 v[148:151], v115, s[32:35], s68 offen sc1
    s_mov_b32 s60, 0
    s_branch L_T2_C
L_PQ_L:
    s_waitcnt lgkmcnt(0)
    s_mul_i32 s64, s45, 0x4c957f2d
    s_mul_i32 s65, s44, 0x5851f42d
    s_mul_hi_u32 s66, s44, 0x4c957f2d
    s_mul_i32 s44, s44, 0x4c957f2d
    s_add_u32 s64, s64, s65
    s_add_u32 s45, s64, s66
    s_add_u32 s44, s44, 0xf767814f
    s_addc_u32 s45, s45, 0x14057b7e
    s_mov_b32 s64, s54
    s_min_u32 s65, s47, 2
    s_mul_i32 s65, s65, 10
    s_add_u32 s65, s65, s64
    s_mul_i32 s65, s65, 10
    v_and_b32 v1, 15, v234
    v_min_u32 v1, 9, v1
    v_add_u32 v1, s65, v1
    v_and_b32 v2, 1, v1
    v_lshrrev_b32 v1, 1, v1
    v_lshl_add_u32 v1, v1, 2, v2
    s_and_b32 s65, s53, 1
    s_lshl2_add_u32 s65, s65, s47
    s_lshl_b32 s65, s65, 5
    s_bfe_u32 s66, s53, 0x10001
    s_add_u32 s65, s65, s66
    s_lshl1_add_u32 s65, s48, s65
    v_lshrrev_b32 v2, 2, v234
    v_lshl_add_u32 v2, v2, 3, s65
    v_and_b32 v0, 3, v234
    v_cmp_gt_u32 vcc, 16, v234
    v_lshl_add_u32 v0, v2, 2, v0
    s_nop 0
    v_cndmask_b32 v0, v1, v0, vcc
    v_lshlrev_b32 v0, 7, v0
    v_add_u32 v0, 856064, v0
    s_min_u32 s65, s47, 2
    s_mul_i32 s66, s65, 10
    s_add_u32 s64, s64, s66
    s_mul_i32 s64, s64, 2560
    s_add_u32 s64, s64, 1376256
    v_lshl_add_u32 v5, v234, 2, s64
    s_lshl_b32 s65, s65, 9
    s_add_u32 s65, s65, 125440
    v_lshl_add_u32 v7, v234, 3, s65
    s_lshl2_add_u32 s64, s53, s47
    s_lshl_b32 s64, s64, 5
    v_and_b32 v6, 31, v234
    v_add_u32 v4, s64, v6
    v_and_b32 v3, 1, v4
    v_lshrrev_b32 v4, 1, v4
    v_lshlrev_b32 v4, 7, v4
    v_lshl_add_u32 v4, v3, 4, v4
    v_add_u32 v4, 1703936, v4
    s_lshl_b32 s64, s47, 5
    v_add_u32 v6, s64, v6
    s_mov_b32 s57, 0
    v_and_b32 v26, 15, v234
    v_lshlrev_b32 v26, 7, v26
    v_add_u32 v26, 724992, v26
    s_waitcnt vmcnt(10)
    s_barrier
    s_sub_u32 s94, s2, 224
    s_lshr_b32 s94, s94, 1
    s_add_u32 s94, s94, 224
    s_min_u32 s94, s94, s2
    s_lshl2_add_u32 s94, s94, s47
    s_mov_b32 s90, 430080
    s_mul_i32 s95, s94, 384
    s_mov_b64 s[82:83], s[16:17]
    s_mov_b32 s91, 2211776
L_lloop_12:
    s_cmp_lg_u32 s57, 6
    s_cbranch_scc1 L_tw_22
    s_mul_i32 s95, s94, 448
    s_mov_b64 s[82:83], s[8:9]
    s_mov_b32 s91, 818752
L_tw_22:
    s_min_u32 s96, s95, s91
    s_load_dword s10, s[82:83], s96
    s_add_u32 s96, s96, 64
    s_load_dword s10, s[82:83], s96
    s_add_u32 s96, s96, 64
    s_load_dword s10, s[82:83], s96
    s_add_u32 s96, s96, 64
    s_load_dword s10, s[82:83], s96
    s_add_u32 s96, s96, 64
    s_load_dword s10, s[82:83], s96
    s_add_u32 s96, s96, 64
    s_load_dword s10, s[82:83], s96
    s_add_u32 s96, s96, 64
    s_min_u32 s96, s96, s91
    s_load_dword s10, s[82:83], s96
    s_cmp_lt_u32 s57, 6
    s_cselect_b32 s96, 368640, s90
    s_add_u32 s95, s95, s96
    s_cmp_lg_u32 s57, 7
    s_cbranch_scc1 L_lh_14
    buffer_load_dwordx2 v[2:3], v0, s[32:35], 0 offen sc1
    buffer_load_dwordx2 v[28:29], v26, s[32:35], 0 offen sc1
L_lh_14:
    s_mov_b32 m0, s72
    s_add_u32 s74, s74, 1
    s_cmp_eq_u32 s74, 3
    s_mov_b32 s64, 40960
    s_cmov_b32 s64, 4294885376
    s_cmov_b32 s74, 0
    buffer_load_dwordx4 v226, s[28:31], s70 offen offset:0 lds
    buffer_load_dwordx4 v227, s[28:31], s70 offen offset:1024 lds
    buffer_load_dwordx4 v228, s[28:31], s70 offen offset:2048 lds
    buffer_load_dwordx4 v229, s[28:31], s70 offen offset:3072 lds
    s_add_u32 s72, s72, s64
    s_add_u32 s70, s70, 128
    s_mov_b32 m0, s73
    s_add_u32 s75, s75, 1
    s_cmp_eq_u32 s75, 3
    s_mov_b32 s64, 40960
    s_cmov_b32 s64, 4294885376
    s_cmov_b32 s75, 0
    buffer_load_dwordx4 v230, s[36:39], s71 offen offset:0 lds
    buffer_load_dwordx4 v231, s[36:39], s71 offen offset:1024 lds
    s_add_u32 m0, s73, 8192
    s_add_u32 s65, s71, 1280
    buffer_load_dwordx4 v230, s[36:39], s65 offen offset:0 lds
    buffer_load_dwordx4 v231, s[36:39], s65 offen offset:1024 lds
    s_add_u32 m0, s73, 16384
    s_add_u32 s65, s71, 2560
    buffer_load_dwordx4 v230, s[36:39], s65 offen offset:0 lds
    buffer_load_dwordx4 v231, s[36:39], s65 offen offset:1024 lds
    s_add_u32 s73, s73, s64
    s_add_u32 s71, s71, 245760
    s_cmp_eq_u32 s57, 7
    s_cbranch_scc1 L_lh_15
    s_waitcnt vmcnt(10)
    s_branch L_lwd_13
L_lh_15:
    s_waitcnt vmcnt(12)
L_lwd_13:
    s_barrier
    s_add_u32 s57, s57, 1
    s_cmp_lt_u32 s57, 8
    s_cbranch_scc1 L_lloop_12
    s_waitcnt vmcnt(10)
    v_cmp_ne_u64 vcc, s[44:45], v[2:3]
    s_cbranch_vccz L_lok_23
    s_mov_b32 s59, 0x40000
L_poll_24:
    buffer_load_dwordx2 v[2:3], v0, s[32:35], 0 offen sc1
    s_waitcnt vmcnt(0)
    v_cmp_ne_u64 vcc, s[44:45], v[2:3]
    s_cbranch_vccz L_pdone_25
    s_sleep 4
    s_sub_u32 s59, s59, 1
    s_cbranch_scc0 L_poll_24
    s_or_b32 s58, s58, 512
L_pdone_25:
L_lok_23:
    v_cmp_ne_u64 vcc, s[44:45], v[28:29]
    s_cbranch_vccz L_lok_26
    s_mov_b32 s59, 0x40000
L_poll_27:
    buffer_load_dwordx2 v[28:29], v26, s[32:35], 0 offen sc1
    s_waitcnt vmcnt(0)
    v_cmp_ne_u64 vcc, s[44:45], v[28:29]
    s_cbranch_vccz L_pdone_28
    s_sleep 4
    s_sub_u32 s59, s59, 1
    s_cbranch_scc0 L_poll_27
    s_or_b32 s58, s58, 2
L_pdone_28:
L_lok_26:
    buffer_load_dwordx4 v[8:11], v4, s[32:35], 0 offen sc1
    buffer_load_dword v16, v5, s[32:35], 0 offen offset:0 sc1
    buffer_load_dword v17, v5, s[32:35], 0 offen offset:256 sc1
    buffer_load_dword v18, v5, s[32:35], 0 offen offset:512 sc1
    buffer_load_dword v19, v5, s[32:35], 0 offen offset:768 sc1
    buffer_load_dword v20, v5, s[32:35], 0 offen offset:1024 sc1
    buffer_load_dword v21, v5, s[32:35], 0 offen offset:1280 sc1
    buffer_load_dword v22, v5, s[32:35], 0 offen offset:1536 sc1
    buffer_load_dword v23, v5, s[32:35], 0 offen offset:1792 sc1
    buffer_load_dword v24, v5, s[32:35], 0 offen offset:2048 sc1
    buffer_load_dword v25, v5, s[32:35], 0 offen offset:2304 sc1
    v_lshlrev_b32 v4, 4, v234
    s_mul_i32 s64, s52, 102400
    s_mul_i32 s65, s47, 9216
    s_add_u32 s64, s64, s65
    s_add_u32 s64, s64, 24969216
    s_add_u32 s65, s65, 126976
    s_mov_b32 m0, s65
    s_nop 0
    buffer_load_dwordx4 v4, s[32:35], s64 offen offset:0 sc1 lds
    buffer_load_dwordx4 v4, s[32:35], s64 offen offset:1024 sc1 lds
    buffer_load_dwordx4 v4, s[32:35], s64 offen offset:2048 sc1 lds
    buffer_load_dwordx4 v4, s[32:35], s64 offen offset:3072 sc1 lds
    s_add_u32 s64, s64, 4096
    s_add_u32 s65, s65, 4096
    s_mov_b32 m0, s65
    s_nop 0
    buffer_load_dwordx4 v4, s[32:35], s64 offen offset:0 sc1 lds
    buffer_load_dwordx4 v4, s[32:35], s64 offen offset:1024 sc1 lds
    buffer_load_dwordx4 v4, s[32:35], s64 offen offset:2048 sc1 lds
    buffer_load_dwordx4 v4, s[32:35], s64 offen offset:3072 sc1 lds
    s_add_u32 s64, s64, 4096
    s_add_u32 s65, s65, 4096
    s_mov_b32 m0, s65
    s_nop 0
    buffer_load_dwordx4 v4, s[32:35], s64 offen offset:0 sc1 lds
    s_waitcnt vmcnt(20)
    s_barrier
    s_waitcnt vmcnt(9)
    v_add_f32 v16, v16, v17
    v_add_f32 v18, v18, v19
    v_add_f32 v20, v20, v21
    v_add_f32 v22, v22, v23
    v_add_f32 v24, v24, v25
    v_add_f32 v16, v16, v18
    v_add_f32 v20, v20, v22
    v_add_f32 v16, v16, v24
    v_add_f32 v16, v16, v20
    v_cvt_pk_bf16_f32 v19, v16, 0
    v_lshlrev_b32 v17, 16, v19
    v_sub_f32 v17, v16, v17
    v_cvt_pk_bf16_f32 v18, v16, v17
    v_mov_b32 v27, 122880
    v_lshl_add_u32 v30, v6, 4, v27
    ds_write_b128 v30, v[8:11] offset:0
    ds_write_b64 v7, v[18:19]
    v_lshl_add_u32 v28, v6, 2, v27
    ds_write_b32 v28, v10 offset:2048
    s_mul_i32 s64, s52, 102400
    s_mul_i32 s65, s47, 10240
    s_add_u32 s64, s64, s65
    s_add_u32 s64, s64, 24903680
    s_add_u32 s65, s65, 40960
    s_mov_b32 m0, s65
    s_nop 0
    buffer_load_dwordx4 v4, s[32:35], s64 offen offset:0 sc1 lds
    buffer_load_dwordx4 v4, s[32:35], s64 offen offset:1024 sc1 lds
    buffer_load_dwordx4 v4, s[32:35], s64 offen offset:2048 sc1 lds
    buffer_load_dwordx4 v4, s[32:35], s64 offen offset:3072 sc1 lds
    s_add_u32 s64, s64, 4096
    s_add_u32 s65, s65, 4096
    s_mov_b32 m0, s65
    s_nop 0
    buffer_load_dwordx4 v4, s[32:35], s64 offen offset:0 sc1 lds
    buffer_load_dwordx4 v4, s[32:35], s64 offen offset:1024 sc1 lds
    buffer_load_dwordx4 v4, s[32:35], s64 offen offset:2048 sc1 lds
    buffer_load_dwordx4 v4, s[32:35], s64 offen offset:3072 sc1 lds
    s_add_u32 s64, s64, 4096
    s_add_u32 s65, s65, 4096
    s_mov_b32 m0, s65
    s_nop 0
    buffer_load_dwordx4 v4, s[32:35], s64 offen offset:0 sc1 lds
    buffer_load_dwordx4 v4, s[32:35], s64 offen offset:1024 sc1 lds
    s_waitcnt lgkmcnt(0)
    s_barrier
    s_mul_i32 s64, s52, 102400
    s_mul_i32 s65, s47, 6144
    s_add_u32 s64, s64, s65
    s_add_u32 s64, s64, 24944640
    s_add_u32 s65, s65, 81920
    s_mov_b32 m0, s65
    s_nop 0
    buffer_load_dwordx4 v4, s[32:35], s64 offen offset:0 sc1 lds
    buffer_load_dwordx4 v4, s[32:35], s64 offen offset:1024 sc1 lds
    buffer_load_dwordx4 v4, s[32:35], s64 offen offset:2048 sc1 lds
    buffer_load_dwordx4 v4, s[32:35], s64 offen offset:3072 sc1 lds
    s_add_u32 s64, s64, 4096
    s_add_u32 s65, s65, 4096
    s_mov_b32 m0, s65
    s_nop 0
    buffer_load_dwordx4 v4, s[32:35], s64 offen offset:0 sc1 lds
    buffer_load_dwordx4 v4, s[32:35], s64 offen offset:1024 sc1 lds
    s_barrier
    v_and_b32 v224, 15, v234
    v_lshrrev_b32 v225, 4, v234
    v_mul_u32_u24 v224, 1280, v224
    v_lshl_add_u32 v224, v225, 3, v224
    s_lshl2_add_u32 s64, s51, s47
    s_mul_i32 s64, s64, 20480
    s_mul_i32 s65, s52, 160
    s_add_u32 s64, s64, s65
    buffer_load_dwordx2 v[236:237], v224, s[28:31], s64 offen offset:0
    buffer_load_dwordx2 v[238:239], v224, s[28:31], s64 offen offset:32
    buffer_load_dwordx2 v[240:241], v224, s[28:31], s64 offen offset:64
    buffer_load_dwordx2 v[242:243], v224, s[28:31], s64 offen offset:96
    buffer_load_dwordx2 v[244:245], v224, s[28:31], s64 offen offset:128
    s_branch L_T2_L
L_P1_C:
    s_sub_u32 s64, s50, 20
    s_lshr_b32 s64, s64, 2
    s_lshl1_add_u32 s54, s49, s64
    v_and_b32 v164, 15, v234
    v_lshrrev_b32 v165, 4, v234
    s_lshl_b32 s64, s55, 13
    s_add_u32 s64, s64, 0
    v_lshrrev_b32 v166, 1, v164
    v_xor_b32 v166, v166, v165
    v_lshlrev_b32 v166, 4, v166
    v_lshl_add_u32 v166, v164, 7, v166
    v_xor_b32 v161, 64, v166
    v_add_u32 v160, s64, v166
    v_add_u32 v161, s64, v161
    v_bfe_u32 v166, v234, 2, 2
    v_lshl_add_u32 v162, v165, 3, v166
    v_and_b32 v163, 1, v165
    v_lshlrev_b32 v162, 7, v162
    v_lshl_add_u32 v162, v163, 5, v162
    v_lshrrev_b32 v166, 1, v166
    v_xor_b32 v166, s56, v166
    v_lshl_add_u32 v162, v166, 6, v162
    v_and_b32 v166, 3, v234
    v_lshl_add_u32 v162, v166, 3, v162
    v_xor_b32 v163, 32, v162
    v_add_u32 v162, 16384, v162
    v_add_u32 v163, 16384, v163
    s_lshl_b32 s64, s55, 8
    s_add_u32 s64, s64, 124928
    v_lshl_add_u32 v166, v165, 4, s64
    s_lshl_b32 s64, s56, 8
    s_add_u32 s64, s64, 125440
    v_lshl_add_u32 v165, v164, 3, s64
    s_lshl_b32 s64, s55, 10
    s_add_u32 s64, s64, 122880
    v_lshl_add_u32 v164, v164, 4, s64
    v_mov_b32 v66, 0
    v_mov_b32 v67, 0
    v_mov_b32 v70, 0
    v_mov_b32 v71, 0
    v_mov_b32 v74, 0
    v_mov_b32 v75, 0
    v_mov_b32 v78, 0
    v_mov_b32 v79, 0
    v_mov_b32 v80, 0
    v_mov_b32 v81, 0
    v_mov_b32 v82, 0
    v_mov_b32 v83, 0
    v_mov_b32 v84, 0
    v_mov_b32 v85, 0
    v_mov_b32 v86, 0
    v_mov_b32 v87, 0
    v_mov_b32 v88, 0
    v_mov_b32 v89, 0
    v_mov_b32 v90, 0
    v_mov_b32 v91, 0
    v_mov_b32 v92, 0
    v_mov_b32 v93, 0
    v_mov_b32 v94, 0
    v_mov_b32 v95, 0
    s_mov_b32 s57, 0
    s_mov_b32 s76, 0
    s_mov_b32 s77, 0
    s_waitcnt lgkmcnt(0)
    s_mul_i32 s64, s45, 0x4c957f2d
    s_mul_i32 s65, s44, 0x5851f42d
    s_mul_hi_u32 s66, s44, 0x4c957f2d
    s_mul_i32 s44, s44, 0x4c957f2d
    s_add_u32 s64, s64, s65
    s_add_u32 s45, s64, s66
    s_add_u32 s44, s44, 0xf767814f
    s_addc_u32 s45, s45, 0x14057b7e
    s_barrier
    ds_read_b128 v[96:99], v160 offset:0
    ds_read_b128 v[100:103], v160 offset:2048
    ds_read_b128 v[104:107], v160 offset:4096
    ds_read_b128 v[108:111], v160 offset:6144
    ds_read_b64_tr_b16 v[112:113], v162 offset:0
    ds_read_b64_tr_b16 v[114:115], v163 offset:512
    s_waitcnt lgkmcnt(0)
    v_mfma_f32_16x16x32_bf16 v[0:3], v[112:115], v[96:99], 0
    ds_read_b128 v[128:131], v161 offset:0
    v_mfma_f32_16x16x32_bf16 v[16:19], v[112:115], v[100:103], 0
    ds_read_b64_tr_b16 v[144:145], v162 offset:4096
    v_mfma_f32_16x16x32_bf16 v[32:35], v[112:115], v[104:107], 0
    ds_read_b64_tr_b16 v[116:117], v163 offset:0
    ds_read_b64_tr_b16 v[118:119], v162 offset:512
    v_mfma_f32_16x16x32_bf16 v[48:51], v[112:115], v[108:111], 0
    ds_read_b64_tr_b16 v[146:147], v163 offset:4608
    s_waitcnt lgkmcnt(1)
    v_mfma_f32_16x16x32_bf16 v[4:7], v[116:119], v[96:99], 0
    ds_read_b128 v[132:135], v161 offset:2048
    v_mfma_f32_16x16x32_bf16 v[20:23], v[116:119], v[100:103], 0
    ds_read_b128 v[136:139], v161 offset:4096
    v_mfma_f32_16x16x32_bf16 v[36:39], v[116:119], v[104:107], 0
    ds_read_b64_tr_b16 v[120:121], v162 offset:8192
    ds_read_b64_tr_b16 v[122:123], v163 offset:8704
    v_mfma_f32_16x16x32_bf16 v[52:55], v[116:119], v[108:111], 0
    ds_read_b128 v[140:143], v161 offset:6144
    s_waitcnt lgkmcnt(1)
    v_mfma_f32_16x16x32_bf16 v[8:11], v[120:123], v[96:99], 0
    ds_read_b64_tr_b16 v[148:149], v163 offset:4096
    v_mfma_f32_16x16x32_bf16 v[24:27], v[120:123], v[100:103], 0
    v_mfma_f32_16x16x32_bf16 v[40:43], v[120:123], v[104:107], 0
    ds_read_b64_tr_b16 v[124:125], v163 offset:8192
    ds_read_b64_tr_b16 v[126:127], v162 offset:8704
    ds_read_b64_tr_b16 v[150:151], v162 offset:4608
    s_add_u32 s76, s76, 1
    v_mfma_f32_16x16x32_bf16 v[56:59], v[120:123], v[108:111], 0
    ds_read_b64_tr_b16 v[152:153], v162 offset:12288
    s_cmp_eq_u32 s76, 3
    s_waitcnt lgkmcnt(2)
    v_mfma_f32_16x16x32_bf16 v[12:15], v[124:127], v[96:99], 0
    ds_read_b64_tr_b16 v[154:155], v163 offset:12800
    s_mov_b32 s78, 32768
    v_mfma_f32_16x16x32_bf16 v[28:31], v[124:127], v[100:103], 0
    s_cmov_b32 s78, 4294901760
    v_mfma_f32_16x16x32_bf16 v[44:47], v[124:127], v[104:107], 0
    ds_read_b64_tr_b16 v[156:157], v163 offset:12288
    s_cmov_b32 s76, 0
    v_mfma_f32_16x16x32_bf16 v[60:63], v[124:127], v[108:111], 0
    ds_read_b64_tr_b16 v[158:159], v162 offset:12800
    s_cmp_lg_u32 s57, 0
    s_cbranch_scc1 L_hk_32
    s_lshl2_add_u32 s64, s2, s47
    s_lshl_b32 s64, s64, 7
    s_add_u32 s64, s64, 856064
    s_waitcnt vmcnt(0)
    v_mov_b32 v230, s44
    v_mov_b32 v231, s45
    s_mov_b64 exec, 0xffff
    buffer_store_dwordx2 v[230:231], v233, s[32:35], s64 offen sc1
    s_mov_b64 exec, -1
L_hk_32:
    s_branch L_cstep1_30
L_cloop_29:
    s_waitcnt lgkmcnt(0)
    v_mfma_f32_16x16x32_bf16 v[0:3], v[112:115], v[96:99], v[0:3]
    ds_read_b128 v[128:131], v161 offset:0
    v_mfma_f32_16x16x32_bf16 v[16:19], v[112:115], v[100:103], v[16:19]
    ds_read_b64_tr_b16 v[144:145], v162 offset:4096
    v_mfma_f32_16x16x32_bf16 v[32:35], v[112:115], v[104:107], v[32:35]
    ds_read_b64_tr_b16 v[116:117], v163 offset:0
    ds_read_b64_tr_b16 v[118:119], v162 offset:512
    v_mfma_f32_16x16x32_bf16 v[48:51], v[112:115], v[108:111], v[48:51]
    ds_read_b64_tr_b16 v[146:147], v163 offset:4608
    s_waitcnt lgkmcnt(1)
    v_mfma_f32_16x16x32_bf16 v[4:7], v[116:119], v[96:99], v[4:7]
    ds_read_b128 v[132:135], v161 offset:2048
    v_mfma_f32_16x16x32_bf16 v[20:23], v[116:119], v[100:103], v[20:23]
    ds_read_b128 v[136:139], v161 offset:4096
    v_mfma_f32_16x16x32_bf16 v[36:39], v[116:119], v[104:107], v[36:39]
    ds_read_b64_tr_b16 v[120:121], v162 offset:8192
    ds_read_b64_tr_b16 v[122:123], v163 offset:8704
    v_mfma_f32_16x16x32_bf16 v[52:55], v[116:119], v[108:111], v[52:55]
    ds_read_b128 v[140:143], v161 offset:6144
    s_waitcnt lgkmcnt(1)
    v_mfma_f32_16x16x32_bf16 v[8:11], v[120:123], v[96:99], v[8:11]
    ds_read_b64_tr_b16 v[148:149], v163 offset:4096
    v_mfma_f32_16x16x32_bf16 v[24:27], v[120:123], v[100:103], v[24:27]
    v_mfma_f32_16x16x32_bf16 v[40:43], v[120:123], v[104:107], v[40:43]
    ds_read_b64_tr_b16 v[124:125], v163 offset:8192
    ds_read_b64_tr_b16 v[126:127], v162 offset:8704
    ds_read_b64_tr_b16 v[150:151], v162 offset:4608
    s_add_u32 s76, s76, 1
    v_mfma_f32_16x16x32_bf16 v[56:59], v[120:123], v[108:111], v[56:59]
    ds_read_b64_tr_b16 v[152:153], v162 offset:12288
    s_cmp_eq_u32 s76, 3
    s_waitcnt lgkmcnt(2)
    v_mfma_f32_16x16x32_bf16 v[12:15], v[124:127], v[96:99], v[12:15]
    ds_read_b64_tr_b16 v[154:155], v163 offset:12800
    s_mov_b32 s78, 32768
    v_mfma_f32_16x16x32_bf16 v[28:31], v[124:127], v[100:103], v[28:31]
    s_cmov_b32 s78, 4294901760
    v_mfma_f32_16x16x32_bf16 v[44:47], v[124:127], v[104:107], v[44:47]
    ds_read_b64_tr_b16 v[156:157], v163 offset:12288
    s_cmov_b32 s76, 0
    v_mfma_f32_16x16x32_bf16 v[60:63], v[124:127], v[108:111], v[60:63]
    ds_read_b64_tr_b16 v[158:159], v162 offset:12800
    s_cmp_lg_u32 s57, 0
    s_cbranch_scc1 L_hk_33
    s_lshl2_add_u32 s64, s2, s47
    s_lshl_b32 s64, s64, 7
    s_add_u32 s64, s64, 856064
    s_waitcnt vmcnt(0)
    v_mov_b32 v230, s44
    v_mov_b32 v231, s45
    s_mov_b64 exec, 0xffff
    buffer_store_dwordx2 v[230:231], v233, s[32:35], s64 offen sc1
    s_mov_b64 exec, -1
L_hk_33:
L_cstep1_30:
    s_waitcnt lgkmcnt(0)
    v_mfma_f32_16x16x32_bf16 v[0:3], v[144:147], v[128:131], v[0:3]
    v_add_u32 v160, s78, v160
    v_add_u32 v161, s78, v161
    v_mfma_f32_16x16x32_bf16 v[16:19], v[144:147], v[132:135], v[16:19]
    v_add_u32 v162, s78, v162
    v_add_u32 v163, s78, v163
    s_cmp_eq_u32 s57, 9
    v_mfma_f32_16x16x32_bf16 v[32:35], v[144:147], v[136:139], v[32:35]
    s_barrier
    s_cbranch_scc1 L_clast_31
    ds_read_b128 v[96:99], v160 offset:0
    v_mfma_f32_16x16x32_bf16 v[48:51], v[144:147], v[140:143], v[48:51]
    v_mfma_f32_16x16x32_bf16 v[4:7], v[148:151], v[128:131], v[4:7]
    v_mfma_f32_16x16x32_bf16 v[20:23], v[148:151], v[132:135], v[20:23]
    ds_read_b128 v[100:103], v160 offset:2048
    v_mfma_f32_16x16x32_bf16 v[36:39], v[148:151], v[136:139], v[36:39]
    v_mfma_f32_16x16x32_bf16 v[52:55], v[148:151], v[140:143], v[52:55]
    ds_read_b128 v[104:107], v160 offset:4096
    v_mfma_f32_16x16x32_bf16 v[8:11], v[152:155], v[128:131], v[8:11]
    v_mfma_f32_16x16x32_bf16 v[24:27], v[152:155], v[132:135], v[24:27]
    v_mfma_f32_16x16x32_bf16 v[40:43], v[152:155], v[136:139], v[40:43]
    ds_read_b128 v[108:111], v160 offset:6144
    v_mfma_f32_16x16x32_bf16 v[56:59], v[152:155], v[140:143], v[56:59]
    v_mfma_f32_16x16x32_bf16 v[12:15], v[156:159], v[128:131], v[12:15]
    ds_read_b64_tr_b16 v[112:113], v162 offset:0
    v_mfma_f32_16x16x32_bf16 v[28:31], v[156:159], v[132:135], v[28:31]
    s_add_u32 s57, s57, 1
    v_mfma_f32_16x16x32_bf16 v[44:47], v[156:159], v[136:139], v[44:47]
    v_mfma_f32_16x16x32_bf16 v[60:63], v[156:159], v[140:143], v[60:63]
    ds_read_b64_tr_b16 v[114:115], v163 offset:512
    s_branch L_cloop_29
L_clast_31:
    v_mfma_f32_16x16x32_bf16 v[48:51], v[144:147], v[140:143], v[48:51]
    ds_read_b64 v[64:65], v164 offset:0
    v_mfma_f32_16x16x32_bf16 v[4:7], v[148:151], v[128:131], v[4:7]
    ds_read_b64 v[68:69], v164 offset:256
    v_mfma_f32_16x16x32_bf16 v[20:23], v[148:151], v[132:135], v[20:23]
    ds_read_b64 v[72:73], v164 offset:512
    v_mfma_f32_16x16x32_bf16 v[36:39], v[148:151], v[136:139], v[36:39]
    ds_read_b64 v[76:77], v164 offset:768
    v_mfma_f32_16x16x32_bf16 v[52:55], v[148:151], v[140:143], v[52:55]
    s_mov_b64 exec, 0xffff
    ds_read_b64 v[80:81], v165 offset:0
    ds_read_b64 v[84:85], v165 offset:128
    s_mov_b64 exec, -1
    v_mfma_f32_16x16x32_bf16 v[8:11], v[152:155], v[128:131], v[8:11]
    s_mov_b64 exec, 0xffff
    ds_read_b64 v[88:89], v165 offset:512
    ds_read_b64 v[92:93], v165 offset:640
    s_mov_b64 exec, -1
    v_mfma_f32_16x16x32_bf16 v[24:27], v[152:155], v[132:135], v[24:27]
    ds_read_b64 v[208:209], v164 offset:8
    v_mfma_f32_16x16x32_bf16 v[40:43], v[152:155], v[136:139], v[40:43]
    ds_read_b64 v[210:211], v164 offset:264
    v_mfma_f32_16x16x32_bf16 v[56:59], v[152:155], v[140:143], v[56:59]
    ds_read_b64 v[212:213], v164 offset:520
    v_mfma_f32_16x16x32_bf16 v[12:15], v[156:159], v[128:131], v[12:15]
    ds_read_b64 v[214:215], v164 offset:776
    v_mfma_f32_16x16x32_bf16 v[28:31], v[156:159], v[132:135], v[28:31]
    v_mfma_f32_16x16x32_bf16 v[44:47], v[156:159], v[136:139], v[44:47]
    v_mfma_f32_16x16x32_bf16 v[60:63], v[156:159], v[140:143], v[60:63]
    s_waitcnt lgkmcnt(0)
    v_mfma_f32_16x16x32_bf16 v[0:3], v[80:83], v[64:67], v[0:3]
    s_barrier
    v_mfma_f32_16x16x32_bf16 v[16:19], v[80:83], v[68:71], v[16:19]
    v_mfma_f32_16x16x32_bf16 v[32:35], v[80:83], v[72:75], v[32:35]
    v_mfma_f32_16x16x32_bf16 v[48:51], v[80:83], v[76:79], v[48:51]
    v_mfma_f32_16x16x32_bf16 v[4:7], v[84:87], v[64:67], v[4:7]
    v_mfma_f32_16x16x32_bf16 v[20:23], v[84:87], v[68:71], v[20:23]
    v_mfma_f32_16x16x32_bf16 v[36:39], v[84:87], v[72:75], v[36:39]
    v_mfma_f32_16x16x32_bf16 v[52:55], v[84:87], v[76:79], v[52:55]
    v_mfma_f32_16x16x32_bf16 v[8:11], v[88:91], v[64:67], v[8:11]
    v_mfma_f32_16x16x32_bf16 v[24:27], v[88:91], v[68:71], v[24:27]
    v_mfma_f32_16x16x32_bf16 v[40:43], v[88:91], v[72:75], v[40:43]
    v_mfma_f32_16x16x32_bf16 v[56:59], v[88:91], v[76:79], v[56:59]
    v_mfma_f32_16x16x32_bf16 v[12:15], v[92:95], v[64:67], v[12:15]
    v_mfma_f32_16x16x32_bf16 v[28:31], v[92:95], v[68:71], v[28:31]
    v_mfma_f32_16x16x32_bf16 v[44:47], v[92:95], v[72:75], v[44:47]
    v_mfma_f32_16x16x32_bf16 v[60:63], v[92:95], v[76:79], v[60:63]
    s_setprio 2
    v_mul_f32 v216, 0xc0135761, v209
    v_mul_f32 v217, v209, v209
    v_rcp_f32 v218, v209
    v_mul_f32 v217, v217, v209
    v_mul_f32 v217, 0xbdd2d3e8, v217
    v_mul_f32 v220, 0xc0135761, v211
    v_mul_f32 v221, v211, v211
    v_rcp_f32 v222, v211
    v_mul_f32 v221, v221, v211
    v_mul_f32 v221, 0xbdd2d3e8, v221
    v_mul_f32 v224, 0xc0135761, v213
    v_mul_f32 v225, v213, v213
    v_rcp_f32 v226, v213
    v_mul_f32 v225, v225, v213
    v_mul_f32 v225, 0xbdd2d3e8, v225
    v_mul_f32 v228, 0xc0135761, v215
    v_mul_f32 v229, v215, v215
    v_rcp_f32 v230, v215
    v_mul_f32 v229, v229, v215
    v_mul_f32 v229, 0xbdd2d3e8, v229
    v_lshlrev_b32 v204, 4, v234
    s_lshl1_add_u32 s65, s53, s55
    s_mul_i32 s66, s65, 81920
    s_lshl2_add_u32 s67, s54, s56
    s_lshl_b32 s67, s67, 10
    s_add_u32 s66, s66, s67
    s_add_u32 s66, s66, 2097152
    s_add_u32 s67, s66, 2048
    v_pk_mul_f32 v[176:177], v[0:1], v[0:1]
    v_pk_mul_f32 v[178:179], v[2:3], v[2:3]
    v_pk_mul_f32 v[180:181], v[4:5], v[4:5]
    v_pk_mul_f32 v[182:183], v[6:7], v[6:7]
    v_pk_fma_f32 v[176:177], v[176:177], v[216:217], v[216:217] op_sel:[0,1,0] op_sel_hi:[1,1,0]
    v_pk_fma_f32 v[178:179], v[178:179], v[216:217], v[216:217] op_sel:[0,1,0] op_sel_hi:[1,1,0]
    v_pk_fma_f32 v[180:181], v[180:181], v[216:217], v[216:217] op_sel:[0,1,0] op_sel_hi:[1,1,0]
    v_pk_fma_f32 v[182:183], v[182:183], v[216:217], v[216:217] op_sel:[0,1,0] op_sel_hi:[1,1,0]
    v_pk_mul_f32 v[176:177], v[176:177], v[0:1]
    v_pk_mul_f32 v[178:179], v[178:179], v[2:3]
    v_pk_mul_f32 v[180:181], v[180:181], v[4:5]
    v_pk_mul_f32 v[182:183], v[182:183], v[6:7]
    v_exp_f32 v176, v176
    v_exp_f32 v177, v177
    v_exp_f32 v178, v178
    v_exp_f32 v179, v179
    v_exp_f32 v180, v180
    v_exp_f32 v181, v181
    v_exp_f32 v182, v182
    v_exp_f32 v183, v183
    s_add_u32 s68, s66, 0
    v_pk_fma_f32 v[176:177], v[176:177], v[218:219], v[218:219] op_sel_hi:[1,0,0]
    v_pk_fma_f32 v[178:179], v[178:179], v[218:219], v[218:219] op_sel_hi:[1,0,0]
    v_pk_fma_f32 v[180:181], v[180:181], v[218:219], v[218:219] op_sel_hi:[1,0,0]
    v_pk_fma_f32 v[182:183], v[182:183], v[218:219], v[218:219] op_sel_hi:[1,0,0]
    v_rcp_f32 v176, v176
    v_rcp_f32 v177, v177
    v_rcp_f32 v178, v178
    v_rcp_f32 v179, v179
    v_rcp_f32 v180, v180
    v_rcp_f32 v181, v181
    v_rcp_f32 v182, v182
    v_rcp_f32 v183, v183
    v_pk_mul_f32 v[176:177], v[176:177], v[0:1]
    v_pk_mul_f32 v[178:179], v[178:179], v[2:3]
    v_pk_mul_f32 v[180:181], v[180:181], v[4:5]
    v_pk_mul_f32 v[182:183], v[182:183], v[6:7]
    v_cvt_pk_bf16_f32 v192, v176, v177
    v_cvt_pk_bf16_f32 v193, v178, v179
    v_cvt_pk_bf16_f32 v194, v180, v181
    v_cvt_pk_bf16_f32 v195, v182, v183
    buffer_store_dwordx4 v[192:195], v204, s[32:35], s68 offen sc1
    v_pk_mul_f32 v[184:185], v[16:17], v[16:17]
    v_pk_mul_f32 v[186:187], v[18:19], v[18:19]
    v_pk_mul_f32 v[188:189], v[20:21], v[20:21]
    v_pk_mul_f32 v[190:191], v[22:23], v[22:23]
    v_pk_fma_f32 v[184:185], v[184:185], v[220:221], v[220:221] op_sel:[0,1,0] op_sel_hi:[1,1,0]
    v_pk_fma_f32 v[186:187], v[186:187], v[220:221], v[220:221] op_sel:[0,1,0] op_sel_hi:[1,1,0]
    v_pk_fma_f32 v[188:189], v[188:189], v[220:221], v[220:221] op_sel:[0,1,0] op_sel_hi:[1,1,0]
    v_pk_fma_f32 v[190:191], v[190:191], v[220:221], v[220:221] op_sel:[0,1,0] op_sel_hi:[1,1,0]
    v_pk_mul_f32 v[184:185], v[184:185], v[16:17]
    v_pk_mul_f32 v[186:187], v[186:187], v[18:19]
    v_pk_mul_f32 v[188:189], v[188:189], v[20:21]
    v_pk_mul_f32 v[190:191], v[190:191], v[22:23]
    v_exp_f32 v184, v184
    v_exp_f32 v185, v185
    v_exp_f32 v186, v186
    v_exp_f32 v187, v187
    v_exp_f32 v188, v188
    v_exp_f32 v189, v189
    v_exp_f32 v190, v190
    v_exp_f32 v191, v191
    s_add_u32 s68, s66, 20480
    v_pk_fma_f32 v[184:185], v[184:185], v[222:223], v[222:223] op_sel_hi:[1,0,0]
    v_pk_fma_f32 v[186:187], v[186:187], v[222:223], v[222:223] op_sel_hi:[1,0,0]
    v_pk_fma_f32 v[188:189], v[188:189], v[222:223], v[222:223] op_sel_hi:[1,0,0]
    v_pk_fma_f32 v[190:191], v[190:191], v[222:223], v[222:223] op_sel_hi:[1,0,0]
    v_rcp_f32 v184, v184
    v_rcp_f32 v185, v185
    v_rcp_f32 v186, v186
    v_rcp_f32 v187, v187
    v_rcp_f32 v188, v188
    v_rcp_f32 v189, v189
    v_rcp_f32 v190, v190
    v_rcp_f32 v191, v191
    v_pk_mul_f32 v[184:185], v[184:185], v[16:17]
    v_pk_mul_f32 v[186:187], v[186:187], v[18:19]
    v_pk_mul_f32 v[188:189], v[188:189], v[20:21]
    v_pk_mul_f32 v[190:191], v[190:191], v[22:23]
    v_cvt_pk_bf16_f32 v196, v184, v185
    v_cvt_pk_bf16_f32 v197, v186, v187
    v_cvt_pk_bf16_f32 v198, v188, v189
    v_cvt_pk_bf16_f32 v199, v190, v191
    buffer_store_dwordx4 v[196:199], v204, s[32:35], s68 offen sc1
    v_pk_mul_f32 v[176:177], v[32:33], v[32:33]
    v_pk_mul_f32 v[178:179], v[34:35], v[34:35]
    v_pk_mul_f32 v[180:181], v[36:37], v[36:37]
    v_pk_mul_f32 v[182:183], v[38:39], v[38:39]
    v_pk_fma_f32 v[176:177], v[176:177], v[224:225], v[224:225] op_sel:[0,1,0] op_sel_hi:[1,1,0]
    v_pk_fma_f32 v[178:179], v[178:179], v[224:225], v[224:225] op_sel:[0,1,0] op_sel_hi:[1,1,0]
    v_pk_fma_f32 v[180:181], v[180:181], v[224:225], v[224:225] op_sel:[0,1,0] op_sel_hi:[1,1,0]
    v_pk_fma_f32 v[182:183], v[182:183], v[224:225], v[224:225] op_sel:[0,1,0] op_sel_hi:[1,1,0]
    v_pk_mul_f32 v[176:177], v[176:177], v[32:33]
    v_pk_mul_f32 v[178:179], v[178:179], v[34:35]
    v_pk_mul_f32 v[180:181], v[180:181], v[36:37]
    v_pk_mul_f32 v[182:183], v[182:183], v[38:39]
    v_exp_f32 v176, v176
    v_exp_f32 v177, v177
    v_exp_f32 v178, v178
    v_exp_f32 v179, v179
    v_exp_f32 v180, v180
    v_exp_f32 v181, v181
    v_exp_f32 v182, v182
    v_exp_f32 v183, v183
    s_add_u32 s68, s66, 40960
    v_pk_fma_f32 v[176:177], v[176:177], v[226:227], v[226:227] op_sel_hi:[1,0,0]
    v_pk_fma_f32 v[178:179], v[178:179], v[226:227], v[226:227] op_sel_hi:[1,0,0]
    v_pk_fma_f32 v[180:181], v[180:181], v[226:227], v[226:227] op_sel_hi:[1,0,0]
    v_pk_fma_f32 v[182:183], v[182:183], v[226:227], v[226:227] op_sel_hi:[1,0,0]
    v_rcp_f32 v176, v176
    v_rcp_f32 v177, v177
    v_rcp_f32 v178, v178
    v_rcp_f32 v179, v179
    v_rcp_f32 v180, v180
    v_rcp_f32 v181, v181
    v_rcp_f32 v182, v182
    v_rcp_f32 v183, v183
    v_pk_mul_f32 v[176:177], v[176:177], v[32:33]
    v_pk_mul_f32 v[178:179], v[178:179], v[34:35]
    v_pk_mul_f32 v[180:181], v[180:181], v[36:37]
    v_pk_mul_f32 v[182:183], v[182:183], v[38:39]
    v_cvt_pk_bf16_f32 v200, v176, v177
    v_cvt_pk_bf16_f32 v201, v178, v179
    v_cvt_pk_bf16_f32 v202, v180, v181
    v_cvt_pk_bf16_f32 v203, v182, v183
    buffer_store_dwordx4 v[200:203], v204, s[32:35], s68 offen sc1
    v_pk_mul_f32 v[184:185], v[48:49], v[48:49]
    v_pk_mul_f32 v[186:187], v[50:51], v[50:51]
    v_pk_mul_f32 v[188:189], v[52:53], v[52:53]
    v_pk_mul_f32 v[190:191], v[54:55], v[54:55]
    v_pk_fma_f32 v[184:185], v[184:185], v[228:229], v[228:229] op_sel:[0,1,0] op_sel_hi:[1,1,0]
    v_pk_fma_f32 v[186:187], v[186:187], v[228:229], v[228:229] op_sel:[0,1,0] op_sel_hi:[1,1,0]
    v_pk_fma_f32 v[188:189], v[188:189], v[228:229], v[228:229] op_sel:[0,1,0] op_sel_hi:[1,1,0]
    v_pk_fma_f32 v[190:191], v[190:191], v[228:229], v[228:229] op_sel:[0,1,0] op_sel_hi:[1,1,0]
    v_pk_mul_f32 v[184:185], v[184:185], v[48:49]
    v_pk_mul_f32 v[186:187], v[186:187], v[50:51]
    v_pk_mul_f32 v[188:189], v[188:189], v[52:53]
    v_pk_mul_f32 v[190:191], v[190:191], v[54:55]
    v_exp_f32 v184, v184
    v_exp_f32 v185, v185
    v_exp_f32 v186, v186
    v_exp_f32 v187, v187
    v_exp_f32 v188, v188
    v_exp_f32 v189, v189
    v_exp_f32 v190, v190
    v_exp_f32 v191, v191
    s_add_u32 s68, s66, 61440
    v_pk_fma_f32 v[184:185], v[184:185], v[230:231], v[230:231] op_sel_hi:[1,0,0]
    v_pk_fma_f32 v[186:187], v[186:187], v[230:231], v[230:231] op_sel_hi:[1,0,0]
    v_pk_fma_f32 v[188:189], v[188:189], v[230:231], v[230:231] op_sel_hi:[1,0,0]
    v_pk_fma_f32 v[190:191], v[190:191], v[230:231], v[230:231] op_sel_hi:[1,0,0]
    v_rcp_f32 v184, v184
    v_rcp_f32 v185, v185
    v_rcp_f32 v186, v186
    v_rcp_f32 v187, v187
    v_rcp_f32 v188, v188
    v_rcp_f32 v189, v189
    v_rcp_f32 v190, v190
    v_rcp_f32 v191, v191
    v_pk_mul_f32 v[184:185], v[184:185], v[48:49]
    v_pk_mul_f32 v[186:187], v[186:187], v[50:51]
    v_pk_mul_f32 v[188:189], v[188:189], v[52:53]
    v_pk_mul_f32 v[190:191], v[190:191], v[54:55]
    v_cvt_pk_bf16_f32 v192, v184, v185
    v_cvt_pk_bf16_f32 v193, v186, v187
    v_cvt_pk_bf16_f32 v194, v188, v189
    v_cvt_pk_bf16_f32 v195, v190, v191
    buffer_store_dwordx4 v[192:195], v204, s[32:35], s68 offen sc1
    v_pk_mul_f32 v[176:177], v[8:9], v[8:9]
    v_pk_mul_f32 v[178:179], v[10:11], v[10:11]
    v_pk_mul_f32 v[180:181], v[12:13], v[12:13]
    v_pk_mul_f32 v[182:183], v[14:15], v[14:15]
    v_pk_fma_f32 v[176:177], v[176:177], v[216:217], v[216:217] op_sel:[0,1,0] op_sel_hi:[1,1,0]
    v_pk_fma_f32 v[178:179], v[178:179], v[216:217], v[216:217] op_sel:[0,1,0] op_sel_hi:[1,1,0]
    v_pk_fma_f32 v[180:181], v[180:181], v[216:217], v[216:217] op_sel:[0,1,0] op_sel_hi:[1,1,0]
    v_pk_fma_f32 v[182:183], v[182:183], v[216:217], v[216:217] op_sel:[0,1,0] op_sel_hi:[1,1,0]
    v_pk_mul_f32 v[176:177], v[176:177], v[8:9]
    v_pk_mul_f32 v[178:179], v[178:179], v[10:11]
    v_pk_mul_f32 v[180:181], v[180:181], v[12:13]
    v_pk_mul_f32 v[182:183], v[182:183], v[14:15]
    v_exp_f32 v176, v176
    v_exp_f32 v177, v177
    v_exp_f32 v178, v178
    v_exp_f32 v179, v179
    v_exp_f32 v180, v180
    v_exp_f32 v181, v181
    v_exp_f32 v182, v182
    v_exp_f32 v183, v183
    s_add_u32 s68, s67, 0
    v_pk_fma_f32 v[176:177], v[176:177], v[218:219], v[218:219] op_sel_hi:[1,0,0]
    v_pk_fma_f32 v[178:179], v[178:179], v[218:219], v[218:219] op_sel_hi:[1,0,0]
    v_pk_fma_f32 v[180:181], v[180:181], v[218:219], v[218:219] op_sel_hi:[1,0,0]
    v_pk_fma_f32 v[182:183], v[182:183], v[218:219], v[218:219] op_sel_hi:[1,0,0]
    v_rcp_f32 v176, v176
    v_rcp_f32 v177, v177
    v_rcp_f32 v178, v178
    v_rcp_f32 v179, v179
    v_rcp_f32 v180, v180
    v_rcp_f32 v181, v181
    v_rcp_f32 v182, v182
    v_rcp_f32 v183, v183
    v_pk_mul_f32 v[176:177], v[176:177], v[8:9]
    v_pk_mul_f32 v[178:179], v[178:179], v[10:11]
    v_pk_mul_f32 v[180:181], v[180:181], v[12:13]
    v_pk_mul_f32 v[182:183], v[182:183], v[14:15]
    v_cvt_pk_bf16_f32 v196, v176, v177
    v_cvt_pk_bf16_f32 v197, v178, v179
    v_cvt_pk_bf16_f32 v198, v180, v181
    v_cvt_pk_bf16_f32 v199, v182, v183
    buffer_store_dwordx4 v[196:199], v204, s[32:35], s68 offen sc1
    v_pk_mul_f32 v[184:185], v[24:25], v[24:25]
    v_pk_mul_f32 v[186:187], v[26:27], v[26:27]
    v_pk_mul_f32 v[188:189], v[28:29], v[28:29]
    v_pk_mul_f32 v[190:191], v[30:31], v[30:31]
    v_pk_fma_f32 v[184:185], v[184:185], v[220:221], v[220:221] op_sel:[0,1,0] op_sel_hi:[1,1,0]
    v_pk_fma_f32 v[186:187], v[186:187], v[220:221], v[220:221] op_sel:[0,1,0] op_sel_hi:[1,1,0]
    v_pk_fma_f32 v[188:189], v[188:189], v[220:221], v[220:221] op_sel:[0,1,0] op_sel_hi:[1,1,0]
    v_pk_fma_f32 v[190:191], v[190:191], v[220:221], v[220:221] op_sel:[0,1,0] op_sel_hi:[1,1,0]
    v_pk_mul_f32 v[184:185], v[184:185], v[24:25]
    v_pk_mul_f32 v[186:187], v[186:187], v[26:27]
    v_pk_mul_f32 v[188:189], v[188:189], v[28:29]
    v_pk_mul_f32 v[190:191], v[190:191], v[30:31]
    v_exp_f32 v184, v184
    v_exp_f32 v185, v185
    v_exp_f32 v186, v186
    v_exp_f32 v187, v187
    v_exp_f32 v188, v188
    v_exp_f32 v189, v189
    v_exp_f32 v190, v190
    v_exp_f32 v191, v191
    s_add_u32 s68, s67, 20480
    v_pk_fma_f32 v[184:185], v[184:185], v[222:223], v[222:223] op_sel_hi:[1,0,0]
    v_pk_fma_f32 v[186:187], v[186:187], v[222:223], v[222:223] op_sel_hi:[1,0,0]
    v_pk_fma_f32 v[188:189], v[188:189], v[222:223], v[222:223] op_sel_hi:[1,0,0]
    v_pk_fma_f32 v[190:191], v[190:191], v[222:223], v[222:223] op_sel_hi:[1,0,0]
    v_rcp_f32 v184, v184
    v_rcp_f32 v185, v185
    v_rcp_f32 v186, v186
    v_rcp_f32 v187, v187
    v_rcp_f32 v188, v188
    v_rcp_f32 v189, v189
    v_rcp_f32 v190, v190
    v_rcp_f32 v191, v191
    v_pk_mul_f32 v[184:185], v[184:185], v[24:25]
    v_pk_mul_f32 v[186:187], v[186:187], v[26:27]
    v_pk_mul_f32 v[188:189], v[188:189], v[28:29]
    v_pk_mul_f32 v[190:191], v[190:191], v[30:31]
    v_cvt_pk_bf16_f32 v200, v184, v185
    v_cvt_pk_bf16_f32 v201, v186, v187
    v_cvt_pk_bf16_f32 v202, v188, v189
    v_cvt_pk_bf16_f32 v203, v190, v191
    buffer_store_dwordx4 v[200:203], v204, s[32:35], s68 offen sc1
    v_pk_mul_f32 v[176:177], v[40:41], v[40:41]
    v_pk_mul_f32 v[178:179], v[42:43], v[42:43]
    v_pk_mul_f32 v[180:181], v[44:45], v[44:45]
    v_pk_mul_f32 v[182:183], v[46:47], v[46:47]
    v_pk_fma_f32 v[176:177], v[176:177], v[224:225], v[224:225] op_sel:[0,1,0] op_sel_hi:[1,1,0]
    v_pk_fma_f32 v[178:179], v[178:179], v[224:225], v[224:225] op_sel:[0,1,0] op_sel_hi:[1,1,0]
    v_pk_fma_f32 v[180:181], v[180:181], v[224:225], v[224:225] op_sel:[0,1,0] op_sel_hi:[1,1,0]
    v_pk_fma_f32 v[182:183], v[182:183], v[224:225], v[224:225] op_sel:[0,1,0] op_sel_hi:[1,1,0]
    v_pk_mul_f32 v[176:177], v[176:177], v[40:41]
    v_pk_mul_f32 v[178:179], v[178:179], v[42:43]
    v_pk_mul_f32 v[180:181], v[180:181], v[44:45]
    v_pk_mul_f32 v[182:183], v[182:183], v[46:47]
    v_exp_f32 v176, v176
    v_exp_f32 v177, v177
    v_exp_f32 v178, v178
    v_exp_f32 v179, v179
    v_exp_f32 v180, v180
    v_exp_f32 v181, v181
    v_exp_f32 v182, v182
    v_exp_f32 v183, v183
    s_add_u32 s68, s67, 40960
    v_pk_fma_f32 v[176:177], v[176:177], v[226:227], v[226:227] op_sel_hi:[1,0,0]
    v_pk_fma_f32 v[178:179], v[178:179], v[226:227], v[226:227] op_sel_hi:[1,0,0]
    v_pk_fma_f32 v[180:181], v[180:181], v[226:227], v[226:227] op_sel_hi:[1,0,0]
    v_pk_fma_f32 v[182:183], v[182:183], v[226:227], v[226:227] op_sel_hi:[1,0,0]
    v_rcp_f32 v176, v176
    v_rcp_f32 v177, v177
    v_rcp_f32 v178, v178
    v_rcp_f32 v179, v179
    v_rcp_f32 v180, v180
    v_rcp_f32 v181, v181
    v_rcp_f32 v182, v182
    v_rcp_f32 v183, v183
    v_pk_mul_f32 v[176:177], v[176:177], v[40:41]
    v_pk_mul_f32 v[178:179], v[178:179], v[42:43]
    v_pk_mul_f32 v[180:181], v[180:181], v[44:45]
    v_pk_mul_f32 v[182:183], v[182:183], v[46:47]
    v_cvt_pk_bf16_f32 v192, v176, v177
    v_cvt_pk_bf16_f32 v193, v178, v179
    v_cvt_pk_bf16_f32 v194, v180, v181
    v_cvt_pk_bf16_f32 v195, v182, v183
    buffer_store_dwordx4 v[192:195], v204, s[32:35], s68 offen sc1
    v_pk_mul_f32 v[184:185], v[56:57], v[56:57]
    v_pk_mul_f32 v[186:187], v[58:59], v[58:59]
    v_pk_mul_f32 v[188:189], v[60:61], v[60:61]
    v_pk_mul_f32 v[190:191], v[62:63], v[62:63]
    v_pk_fma_f32 v[184:185], v[184:185], v[228:229], v[228:229] op_sel:[0,1,0] op_sel_hi:[1,1,0]
    v_pk_fma_f32 v[186:187], v[186:187], v[228:229], v[228:229] op_sel:[0,1,0] op_sel_hi:[1,1,0]
    v_pk_fma_f32 v[188:189], v[188:189], v[228:229], v[228:229] op_sel:[0,1,0] op_sel_hi:[1,1,0]
    v_pk_fma_f32 v[190:191], v[190:191], v[228:229], v[228:229] op_sel:[0,1,0] op_sel_hi:[1,1,0]
    v_pk_mul_f32 v[184:185], v[184:185], v[56:57]
    v_pk_mul_f32 v[186:187], v[186:187], v[58:59]
    v_pk_mul_f32 v[188:189], v[188:189], v[60:61]
    v_pk_mul_f32 v[190:191], v[190:191], v[62:63]
    v_exp_f32 v184, v184
    v_exp_f32 v185, v185
    v_exp_f32 v186, v186
    v_exp_f32 v187, v187
    v_exp_f32 v188, v188
    v_exp_f32 v189, v189
    v_exp_f32 v190, v190
    v_exp_f32 v191, v191
    s_add_u32 s68, s67, 61440
    v_pk_fma_f32 v[184:185], v[184:185], v[230:231], v[230:231] op_sel_hi:[1,0,0]
    v_pk_fma_f32 v[186:187], v[186:187], v[230:231], v[230:231] op_sel_hi:[1,0,0]
    v_pk_fma_f32 v[188:189], v[188:189], v[230:231], v[230:231] op_sel_hi:[1,0,0]
    v_pk_fma_f32 v[190:191], v[190:191], v[230:231], v[230:231] op_sel_hi:[1,0,0]
    v_rcp_f32 v184, v184
    v_rcp_f32 v185, v185
    v_rcp_f32 v186, v186
    v_rcp_f32 v187, v187
    v_rcp_f32 v188, v188
    v_rcp_f32 v189, v189
    v_rcp_f32 v190, v190
    v_rcp_f32 v191, v191
    v_pk_mul_f32 v[184:185], v[184:185], v[56:57]
    v_pk_mul_f32 v[186:187], v[186:187], v[58:59]
    v_pk_mul_f32 v[188:189], v[188:189], v[60:61]
    v_pk_mul_f32 v[190:191], v[190:191], v[62:63]
    v_cvt_pk_bf16_f32 v196, v184, v185
    v_cvt_pk_bf16_f32 v197, v186, v187
    v_cvt_pk_bf16_f32 v198, v188, v189
    v_cvt_pk_bf16_f32 v199, v190, v191
    buffer_store_dwordx4 v[196:199], v204, s[32:35], s68 offen sc1
    s_lshl_b32 s65, s65, 4
    s_lshl1_add_u32 s64, s54, s56
    s_add_u32 s65, s65, s64
    s_lshl_b32 s65, s65, 7
    s_add_u32 s93, s65, 4096
    s_mov_b32 s60, 1
    s_branch L_T2_C
L_P1_L:
    s_waitcnt lgkmcnt(0)
    s_mul_i32 s64, s45, 0x4c957f2d
    s_mul_i32 s65, s44, 0x5851f42d
    s_mul_hi_u32 s66, s44, 0x4c957f2d
    s_mul_i32 s44, s44, 0x4c957f2d
    s_add_u32 s64, s64, s65
    s_add_u32 s45, s64, s66
    s_add_u32 s44, s44, 0xf767814f
    s_addc_u32 s45, s45, 0x14057b7e
    s_lshl_b32 s64, s54, 1
    s_add_u32 s64, s64, 30
    s_min_u32 s65, s47, 1
    s_mul_i32 s65, s65, 1
    s_add_u32 s65, s65, s64
    s_mul_i32 s65, s65, 10
    v_and_b32 v1, 15, v234
    v_min_u32 v1, 9, v1
    v_add_u32 v1, s65, v1
    v_and_b32 v2, 1, v1
    v_lshrrev_b32 v1, 1, v1
    v_lshl_add_u32 v1, v1, 2, v2
    s_and_b32 s65, s53, 1
    s_lshl2_add_u32 s65, s65, s47
    s_lshl_b32 s65, s65, 5
    s_bfe_u32 s66, s53, 0x10001
    s_add_u32 s65, s65, s66
    s_lshl1_add_u32 s65, s48, s65
    v_lshrrev_b32 v2, 2, v234
    v_lshl_add_u32 v2, v2, 3, s65
    v_and_b32 v0, 3, v234
    v_cmp_gt_u32 vcc, 16, v234
    v_lshl_add_u32 v0, v2, 2, v0
    s_nop 0
    v_cndmask_b32 v0, v1, v0, vcc
    v_lshlrev_b32 v0, 7, v0
    v_add_u32 v0, 856064, v0
    s_min_u32 s65, s47, 1
    s_mul_i32 s66, s65, 1
    s_add_u32 s64, s64, s66
    s_mul_i32 s64, s64, 2560
    s_add_u32 s64, s64, 1376256
    v_lshl_add_u32 v5, v234, 2, s64
    s_lshl_b32 s65, s65, 9
    s_add_u32 s65, s65, 125440
    v_lshl_add_u32 v7, v234, 3, s65
    s_lshl2_add_u32 s64, s53, s47
    s_lshl_b32 s64, s64, 5
    v_and_b32 v6, 31, v234
    v_add_u32 v4, s64, v6
    v_and_b32 v3, 1, v4
    v_lshrrev_b32 v4, 1, v4
    v_lshlrev_b32 v4, 7, v4
    v_lshl_add_u32 v4, v3, 4, v4
    v_add_u32 v4, 1703936, v4
    s_lshl_b32 s64, s47, 5
    v_add_u32 v6, s64, v6
    s_mov_b32 s57, 0
    v_and_b32 v26, 15, v234
    v_lshlrev_b32 v26, 7, v26
    v_add_u32 v26, 724992, v26
    s_waitcnt vmcnt(8)
    s_barrier
    s_sub_u32 s94, s2, 224
    s_lshr_b32 s94, s94, 1
    s_add_u32 s94, s94, 224
    s_min_u32 s94, s94, s2
    s_lshl2_add_u32 s94, s94, s47
    s_mov_b32 s90, 430080
    s_mul_i32 s95, s94, 384
    s_mov_b64 s[82:83], s[16:17]
    s_mov_b32 s91, 2211776
L_lloop_34:
    s_cmp_lg_u32 s57, 6
    s_cbranch_scc1 L_tw_44
    s_mul_i32 s95, s94, 448
    s_mov_b64 s[82:83], s[8:9]
    s_mov_b32 s91, 818752
L_tw_44:
    s_min_u32 s96, s95, s91
    s_load_dword s10, s[82:83], s96
    s_add_u32 s96, s96, 64
    s_load_dword s10, s[82:83], s96
    s_add_u32 s96, s96, 64
    s_load_dword s10, s[82:83], s96
    s_add_u32 s96, s96, 64
    s_load_dword s10, s[82:83], s96
    s_add_u32 s96, s96, 64
    s_load_dword s10, s[82:83], s96
    s_add_u32 s96, s96, 64
    s_load_dword s10, s[82:83], s96
    s_add_u32 s96, s96, 64
    s_min_u32 s96, s96, s91
    s_load_dword s10, s[82:83], s96
    s_cmp_lt_u32 s57, 6
    s_cselect_b32 s96, 368640, s90
    s_add_u32 s95, s95, s96
    s_cmp_lg_u32 s57, 7
    s_cbranch_scc1 L_lh_36
    buffer_load_dwordx2 v[2:3], v0, s[32:35], 0 offen sc1
    buffer_load_dwordx2 v[28:29], v26, s[32:35], 0 offen sc1
L_lh_36:
    s_mov_b32 m0, s72
    s_add_u32 s74, s74, 1
    s_cmp_eq_u32 s74, 3
    s_mov_b32 s64, 32768
    s_cmov_b32 s64, 4294901760
    s_cmov_b32 s74, 0
    buffer_load_dwordx4 v226, s[28:31], s70 offen offset:0 lds
    buffer_load_dwordx4 v227, s[28:31], s70 offen offset:1024 lds
    buffer_load_dwordx4 v228, s[28:31], s70 offen offset:2048 lds
    buffer_load_dwordx4 v229, s[28:31], s70 offen offset:3072 lds
    s_add_u32 s72, s72, s64
    s_add_u32 s70, s70, 128
    s_mov_b32 m0, s73
    s_add_u32 s75, s75, 1
    s_cmp_eq_u32 s75, 3
    s_mov_b32 s64, 32768
    s_cmov_b32 s64, 4294901760
    s_cmov_b32 s75, 0
    buffer_load_dwordx4 v230, s[36:39], s71 offen offset:0 lds
    buffer_load_dwordx4 v231, s[36:39], s71 offen offset:1024 lds
    s_add_u32 m0, s73, 8192
    s_add_u32 s65, s71, 128
    buffer_load_dwordx4 v230, s[36:39], s65 offen offset:0 lds
    buffer_load_dwordx4 v231, s[36:39], s65 offen offset:1024 lds
    s_add_u32 s73, s73, s64
    s_add_u32 s71, s71, 81920
    s_cmp_eq_u32 s57, 7
    s_cbranch_scc1 L_lh_37
    s_waitcnt vmcnt(8)
    s_branch L_lwd_35
L_lh_37:
    s_waitcnt vmcnt(10)
L_lwd_35:
    s_barrier
    s_add_u32 s57, s57, 1
    s_cmp_lt_u32 s57, 8
    s_cbranch_scc1 L_lloop_34
    s_waitcnt vmcnt(8)
    v_cmp_ne_u64 vcc, s[44:45], v[2:3]
    s_cbranch_vccz L_lok_45
    s_mov_b32 s59, 0x40000
L_poll_46:
    buffer_load_dwordx2 v[2:3], v0, s[32:35], 0 offen sc1
    s_waitcnt vmcnt(0)
    v_cmp_ne_u64 vcc, s[44:45], v[2:3]
    s_cbranch_vccz L_pdone_47
    s_sleep 4
    s_sub_u32 s59, s59, 1
    s_cbranch_scc0 L_poll_46
    s_or_b32 s58, s58, 512
L_pdone_47:
L_lok_45:
    buffer_load_dwordx4 v[8:11], v4, s[32:35], 0 offen sc1
    buffer_load_dword v16, v5, s[32:35], 0 offen offset:0 sc1
    buffer_load_dword v17, v5, s[32:35], 0 offen offset:256 sc1
    buffer_load_dword v18, v5, s[32:35], 0 offen offset:512 sc1
    buffer_load_dword v19, v5, s[32:35], 0 offen offset:768 sc1
    buffer_load_dword v20, v5, s[32:35], 0 offen offset:1024 sc1
    buffer_load_dword v21, v5, s[32:35], 0 offen offset:1280 sc1
    buffer_load_dword v22, v5, s[32:35], 0 offen offset:1536 sc1
    buffer_load_dword v23, v5, s[32:35], 0 offen offset:1792 sc1
    buffer_load_dword v24, v5, s[32:35], 0 offen offset:2048 sc1
    buffer_load_dword v25, v5, s[32:35], 0 offen offset:2304 sc1
    v_lshlrev_b32 v4, 4, v234
    s_waitcnt vmcnt(11)
    s_barrier
    s_waitcnt vmcnt(0)
    v_add_f32 v16, v16, v17
    v_add_f32 v18, v18, v19
    v_add_f32 v20, v20, v21
    v_add_f32 v22, v22, v23
    v_add_f32 v24, v24, v25
    v_add_f32 v16, v16, v18
    v_add_f32 v20, v20, v22
    v_add_f32 v16, v16, v24
    v_add_f32 v16, v16, v20
    v_cvt_pk_bf16_f32 v19, v16, 0
    v_lshlrev_b32 v17, 16, v19
    v_sub_f32 v17, v16, v17
    v_cvt_pk_bf16_f32 v18, v16, v17
    v_mov_b32 v27, 122880
    v_lshl_add_u32 v30, v6, 4, v27
    ds_write_b128 v30, v[8:11] offset:0
    ds_write_b64 v7, v[18:19]
    s_waitcnt lgkmcnt(0)
    s_barrier
    s_barrier
    v_and_b32 v224, 15, v234
    v_lshrrev_b32 v225, 4, v234
    v_mul_u32_u24 v224, 1280, v224
    v_lshl_add_u32 v224, v225, 3, v224
    s_lshl2_add_u32 s64, s51, s47
    s_mul_i32 s64, s64, 20480
    s_mul_i32 s65, s52, 160
    s_add_u32 s64, s64, s65
    buffer_load_dwordx2 v[236:237], v224, s[28:31], s64 offen offset:0
    buffer_load_dwordx2 v[238:239], v224, s[28:31], s64 offen offset:32
    buffer_load_dwordx2 v[240:241], v224, s[28:31], s64 offen offset:64
    buffer_load_dwordx2 v[242:243], v224, s[28:31], s64 offen offset:96
    buffer_load_dwordx2 v[244:245], v224, s[28:31], s64 offen offset:128
    v_cmp_ne_u64 vcc, s[44:45], v[28:29]
    s_cbranch_vccz L_lok_48
    s_mov_b32 s59, 0x40000
L_poll_49:
    buffer_load_dwordx2 v[28:29], v26, s[32:35], 0 offen sc1
    s_waitcnt vmcnt(0)
    v_cmp_ne_u64 vcc, s[44:45], v[28:29]
    s_cbranch_vccz L_pdone_50
    s_sleep 4
    s_sub_u32 s59, s59, 1
    s_cbranch_scc0 L_poll_49
    s_or_b32 s58, s58, 2
L_pdone_50:
L_lok_48:
    s_mul_i32 s64, s52, 102400
    s_mul_i32 s65, s47, 16384
    s_add_u32 s64, s64, s65
    s_add_u32 s64, s64, 24903680
    s_add_u32 s65, s65, 40960
    s_mov_b32 m0, s65
    s_nop 0
    buffer_load_dwordx4 v4, s[32:35], s64 offen offset:0 sc1 lds
    buffer_load_dwordx4 v4, s[32:35], s64 offen offset:1024 sc1 lds
    buffer_load_dwordx4 v4, s[32:35], s64 offen offset:2048 sc1 lds
    buffer_load_dwordx4 v4, s[32:35], s64 offen offset:3072 sc1 lds
    s_add_u32 s64, s64, 4096
    s_add_u32 s65, s65, 4096
    s_mov_b32 m0, s65
    s_nop 0
    buffer_load_dwordx4 v4, s[32:35], s64 offen offset:0 sc1 lds
    buffer_load_dwordx4 v4, s[32:35], s64 offen offset:1024 sc1 lds
    buffer_load_dwordx4 v4, s[32:35], s64 offen offset:2048 sc1 lds
    buffer_load_dwordx4 v4, s[32:35], s64 offen offset:3072 sc1 lds
    s_add_u32 s64, s64, 4096
    s_add_u32 s65, s65, 4096
    s_mov_b32 m0, s65
    s_nop 0
    buffer_load_dwordx4 v4, s[32:35], s64 offen offset:0 sc1 lds
    buffer_load_dwordx4 v4, s[32:35], s64 offen offset:1024 sc1 lds
    buffer_load_dwordx4 v4, s[32:35], s64 offen offset:2048 sc1 lds
    buffer_load_dwordx4 v4, s[32:35], s64 offen offset:3072 sc1 lds
    s_add_u32 s64, s64, 4096
    s_add_u32 s65, s65, 4096
    s_mov_b32 m0, s65
    s_nop 0
    buffer_load_dwordx4 v4, s[32:35], s64 offen offset:0 sc1 lds
    buffer_load_dwordx4 v4, s[32:35], s64 offen offset:1024 sc1 lds
    buffer_load_dwordx4 v4, s[32:35], s64 offen offset:2048 sc1 lds
    buffer_load_dwordx4 v4, s[32:35], s64 offen offset:3072 sc1 lds
    s_mul_i32 s64, s52, 102400
    s_mul_i32 s65, s47, 9216
    s_add_u32 s64, s64, s65
    s_add_u32 s64, s64, 24969216
    s_add_u32 s65, s65, 126976
    s_mov_b32 m0, s65
    s_nop 0
    buffer_load_dwordx4 v4, s[32:35], s64 offen offset:0 sc1 lds
    buffer_load_dwordx4 v4, s[32:35], s64 offen offset:1024 sc1 lds
    buffer_load_dwordx4 v4, s[32:35], s64 offen offset:2048 sc1 lds
    buffer_load_dwordx4 v4, s[32:35], s64 offen offset:3072 sc1 lds
    s_add_u32 s64, s64, 4096
    s_add_u32 s65, s65, 4096
    s_mov_b32 m0, s65
    s_nop 0
    buffer_load_dwordx4 v4, s[32:35], s64 offen offset:0 sc1 lds
    buffer_load_dwordx4 v4, s[32:35], s64 offen offset:1024 sc1 lds
    buffer_load_dwordx4 v4, s[32:35], s64 offen offset:2048 sc1 lds
    buffer_load_dwordx4 v4, s[32:35], s64 offen offset:3072 sc1 lds
    s_add_u32 s64, s64, 4096
    s_add_u32 s65, s65, 4096
    s_mov_b32 m0, s65
    s_nop 0
    buffer_load_dwordx4 v4, s[32:35], s64 offen offset:0 sc1 lds
    s_branch L_T2_L
L_PACK:
    s_sub_u32 s64, s50, 28
    s_lshl2_add_u32 s73, s48, s64
    s_lshl3_add_u32 s70, s73, s46
    s_mov_b32 s86, s70
    s_lshl_b32 s87, s46, 12
    v_and_b32 v71, 7, v234
    v_lshlrev_b32 v71, 4, v71
    v_lshlrev_b32 v66, 4, v234
    v_bfe_u32 v67, v234, 2, 2
    v_and_b32 v68, 3, v234
    v_lshlrev_b32 v68, 3, v68
    v_lshl_add_u32 v67, v67, 7, v68
    v_add_u32 v67, s87, v67
    v_lshrrev_b32 v68, 4, v234
    v_lshl_add_u32 v69, v68, 9, v67
    v_and_b32 v70, 1, v68
    v_lshl_add_u32 v70, v70, 9, v67
    v_lshrrev_b32 v68, 1, v68
    v_lshl_add_u32 v70, v68, 11, v70
    s_cmp_lt_u32 s86, 200
    s_cselect_b32 s36, s14, s8
    s_cselect_b32 s37, s15, s9
    s_mov_b64 vcc, 0
    s_mov_b32 s64, 200
    s_cmov_b32 s64, 0
    s_mov_b32 s88, 25722880
    s_cmov_b32 s88, 24903680
    s_mov_b32 s67, 2048
    s_mov_b32 s38, 819200
    s_mov_b32 s39, 0x20000
    s_mov_b32 s89, 20
    s_cmp_ge_u32 s86, 400
    s_cselect_b32 s36, s18, s36
    s_cselect_b32 s37, s19, s37
    s_cmov_b32 s38, 2211840
    s_cmov_b32 s64, 400
    s_cmov_b32 s88, 26542080
    s_cmov_b32 s89, 54
    s_sub_u32 s64, s86, s64
    s_mul_i32 s90, s64, 52429
    s_lshr_b32 s90, s90, 19
    s_mul_i32 s91, s90, 10
    s_sub_u32 s91, s64, s91
    s_lshl_b32 s64, s90, 5
    s_mov_b32 s65, 0
    s_mov_b32 s66, 4
    s_cmp_lg_u32 s88, 25722880
    s_cbranch_scc1 L_pkn_51
    s_mul_i32 s68, s90, 52
    s_lshr_b32 s68, s68, 8
    s_mul_i32 s64, s68, 160
    s_mul_i32 s68, s68, 5
    s_sub_u32 s68, s90, s68
    s_cmp_eq_u32 s68, 4
    s_cbranch_scc1 L_pk4_52
    s_mul_i32 s68, s68, 40
    s_add_u32 s64, s64, s68
    s_mov_b32 s65, 4
    s_mov_b64 vcc, -1
    s_mov_b32 s67, 1024
    s_branch L_pkn_51
L_pk4_52:
    s_add_u32 s64, s64, 16
    s_mov_b32 s65, 16
    s_mov_b32 s66, 2
L_pkn_51:
    s_mov_b32 s68, 1280
    v_lshrrev_b32 v28, 3, v234
    v_add_u32 v28, 0, v28
    v_lshrrev_b32 v65, s66, v28
    v_mad_u32_u24 v28, v65, s65, v28
    v_mad_u32_u24 v28, v28, s68, v71
    v_lshrrev_b32 v29, 3, v234
    v_add_u32 v29, 8, v29
    v_lshrrev_b32 v65, s66, v29
    v_mad_u32_u24 v29, v65, s65, v29
    v_mad_u32_u24 v29, v29, s68, v71
    v_subrev_u32 v29, 1024, v29
    v_lshrrev_b32 v30, 3, v234
    v_add_u32 v30, 16, v30
    v_lshrrev_b32 v65, s66, v30
    v_mad_u32_u24 v30, v65, s65, v30
    v_mad_u32_u24 v30, v30, s68, v71
    v_subrev_u32 v30, 2048, v30
    v_lshrrev_b32 v31, 3, v234
    v_add_u32 v31, 24, v31
    v_lshrrev_b32 v65, s66, v31
    v_mad_u32_u24 v31, v65, s65, v31
    v_mad_u32_u24 v31, v31, s68, v71
    v_subrev_u32 v31, 3072, v31
    s_mul_i32 s64, s64, 1280
    s_lshl_b32 s65, s91, 7
    s_add_u32 s64, s64, s65
    s_mov_b32 m0, s87
    v_cndmask_b32 v64, v69, v70, vcc
    buffer_load_dwordx4 v28, s[36:39], s64 offen offset:0 lds
    buffer_load_dwordx4 v29, s[36:39], s64 offen offset:1024 lds
    buffer_load_dwordx4 v30, s[36:39], s64 offen offset:2048 lds
    buffer_load_dwordx4 v31, s[36:39], s64 offen offset:3072 lds
    v_add_u32 v65, s67, v64
    s_waitcnt lgkmcnt(0)
    s_mul_i32 s64, s45, 0x4c957f2d
    s_mul_i32 s65, s44, 0x5851f42d
    s_mul_hi_u32 s66, s44, 0x4c957f2d
    s_mul_i32 s44, s44, 0x4c957f2d
    s_add_u32 s64, s64, s65
    s_add_u32 s45, s64, s66
    s_add_u32 s44, s44, 0xf767814f
    s_addc_u32 s45, s45, 0x14057b7e
    s_lshl2_add_u32 s71, s2, s47
    s_lshl_b32 s71, s71, 7
    s_add_u32 s71, s71, 856064
    s_cmp_ge_u32 s46, 4
    s_cmov_b32 s71, 67108864
    s_waitcnt vmcnt(4)
    v_mov_b32 v12, s44
    v_mov_b32 v13, s45
    s_mov_b64 exec, 0xffff
    buffer_store_dwordx2 v[12:13], v233, s[32:35], s71 offen sc1
    s_mov_b64 exec, -1
L_pk_53:
    s_waitcnt vmcnt(0)
    ds_read_b64_tr_b16 v[72:73], v64 offset:0
    ds_read_b64_tr_b16 v[74:75], v65 offset:0
    ds_read_b64_tr_b16 v[76:77], v64 offset:32
    ds_read_b64_tr_b16 v[78:79], v65 offset:32
    ds_read_b64_tr_b16 v[80:81], v64 offset:64
    ds_read_b64_tr_b16 v[82:83], v65 offset:64
    ds_read_b64_tr_b16 v[84:85], v64 offset:96
    ds_read_b64_tr_b16 v[86:87], v65 offset:96
    s_mul_i32 s67, s90, 5120
    s_add_u32 s67, s67, s88
    s_lshl2_add_u32 s64, s91, 0
    s_mul_i32 s65, s64, 52429
    s_lshr_b32 s65, s65, 18
    s_mul_i32 s66, s65, 5
    s_sub_u32 s64, s64, s66
    s_mul_i32 s66, s66, s89
    s_add_u32 s64, s64, s66
    s_lshl_b32 s64, s64, 10
    s_add_u32 s64, s64, s67
    s_waitcnt lgkmcnt(6)
    buffer_store_dwordx4 v[72:75], v66, s[32:35], s64 offen sc1
    s_lshl2_add_u32 s64, s91, 1
    s_mul_i32 s65, s64, 52429
    s_lshr_b32 s65, s65, 18
    s_mul_i32 s66, s65, 5
    s_sub_u32 s64, s64, s66
    s_mul_i32 s66, s66, s89
    s_add_u32 s64, s64, s66
    s_lshl_b32 s64, s64, 10
    s_add_u32 s64, s64, s67
    s_waitcnt lgkmcnt(4)
    buffer_store_dwordx4 v[76:79], v66, s[32:35], s64 offen sc1
    s_lshl2_add_u32 s64, s91, 2
    s_mul_i32 s65, s64, 52429
    s_lshr_b32 s65, s65, 18
    s_mul_i32 s66, s65, 5
    s_sub_u32 s64, s64, s66
    s_mul_i32 s66, s66, s89
    s_add_u32 s64, s64, s66
    s_lshl_b32 s64, s64, 10
    s_add_u32 s64, s64, s67
    s_waitcnt lgkmcnt(2)
    buffer_store_dwordx4 v[80:83], v66, s[32:35], s64 offen sc1
    s_lshl2_add_u32 s64, s91, 3
    s_mul_i32 s65, s64, 52429
    s_lshr_b32 s65, s65, 18
    s_mul_i32 s66, s65, 5
    s_sub_u32 s64, s64, s66
    s_mul_i32 s66, s66, s89
    s_add_u32 s64, s64, s66
    s_lshl_b32 s64, s64, 10
    s_add_u32 s64, s64, s67
    s_waitcnt lgkmcnt(0)
    buffer_store_dwordx4 v[84:87], v66, s[32:35], s64 offen sc1
    s_add_u32 s86, s86, 128
    s_cmp_ge_u32 s86, 200
    s_cbranch_scc1 L_pk2_54
    s_cmp_lt_u32 s86, 200
    s_cselect_b32 s36, s14, s8
    s_cselect_b32 s37, s15, s9
    s_mov_b64 vcc, 0
    s_mov_b32 s64, 200
    s_cmov_b32 s64, 0
    s_mov_b32 s88, 25722880
    s_cmov_b32 s88, 24903680
    s_mov_b32 s67, 2048
    s_mov_b32 s38, 819200
    s_mov_b32 s39, 0x20000
    s_mov_b32 s89, 20
    s_cmp_ge_u32 s86, 400
    s_cselect_b32 s36, s18, s36
    s_cselect_b32 s37, s19, s37
    s_cmov_b32 s38, 2211840
    s_cmov_b32 s64, 400
    s_cmov_b32 s88, 26542080
    s_cmov_b32 s89, 54
    s_sub_u32 s64, s86, s64
    s_mul_i32 s90, s64, 52429
    s_lshr_b32 s90, s90, 19
    s_mul_i32 s91, s90, 10
    s_sub_u32 s91, s64, s91
    s_lshl_b32 s64, s90, 5
    s_mov_b32 s65, 0
    s_mov_b32 s66, 4
    s_cmp_lg_u32 s88, 25722880
    s_cbranch_scc1 L_pkn_55
    s_mul_i32 s68, s90, 52
    s_lshr_b32 s68, s68, 8
    s_mul_i32 s64, s68, 160
    s_mul_i32 s68, s68, 5
    s_sub_u32 s68, s90, s68
    s_cmp_eq_u32 s68, 4
    s_cbranch_scc1 L_pk4_56
    s_mul_i32 s68, s68, 40
    s_add_u32 s64, s64, s68
    s_mov_b32 s65, 4
    s_mov_b64 vcc, -1
    s_mov_b32 s67, 1024
    s_branch L_pkn_55
L_pk4_56:
    s_add_u32 s64, s64, 16
    s_mov_b32 s65, 16
    s_mov_b32 s66, 2
L_pkn_55:
    s_mov_b32 s68, 1280
    v_lshrrev_b32 v28, 3, v234
    v_add_u32 v28, 0, v28
    v_lshrrev_b32 v65, s66, v28
    v_mad_u32_u24 v28, v65, s65, v28
    v_mad_u32_u24 v28, v28, s68, v71
    v_lshrrev_b32 v29, 3, v234
    v_add_u32 v29, 8, v29
    v_lshrrev_b32 v65, s66, v29
    v_mad_u32_u24 v29, v65, s65, v29
    v_mad_u32_u24 v29, v29, s68, v71
    v_subrev_u32 v29, 1024, v29
    v_lshrrev_b32 v30, 3, v234
    v_add_u32 v30, 16, v30
    v_lshrrev_b32 v65, s66, v30
    v_mad_u32_u24 v30, v65, s65, v30
    v_mad_u32_u24 v30, v30, s68, v71
    v_subrev_u32 v30, 2048, v30
    v_lshrrev_b32 v31, 3, v234
    v_add_u32 v31, 24, v31
    v_lshrrev_b32 v65, s66, v31
    v_mad_u32_u24 v31, v65, s65, v31
    v_mad_u32_u24 v31, v31, s68, v71
    v_subrev_u32 v31, 3072, v31
    s_mul_i32 s64, s64, 1280
    s_lshl_b32 s65, s91, 7
    s_add_u32 s64, s64, s65
    s_mov_b32 m0, s87
    v_cndmask_b32 v64, v69, v70, vcc
    buffer_load_dwordx4 v28, s[36:39], s64 offen offset:0 lds
    buffer_load_dwordx4 v29, s[36:39], s64 offen offset:1024 lds
    buffer_load_dwordx4 v30, s[36:39], s64 offen offset:2048 lds
    buffer_load_dwordx4 v31, s[36:39], s64 offen offset:3072 lds
    v_add_u32 v65, s67, v64
    s_branch L_pk_53
L_pk2_54:
    s_lshl_b32 s71, s73, 7
    s_add_u32 s71, s71, 724992
    s_cmp_lg_u32 s46, 0
    s_cmov_b32 s71, 67108864
    s_waitcnt vmcnt(0) lgkmcnt(0)
    s_barrier
    v_mov_b32 v12, s44
    v_mov_b32 v13, s45
    s_mov_b64 exec, 0xffff
    buffer_store_dwordx2 v[12:13], v233, s[32:35], s71 offen sc1
    s_mov_b64 exec, -1
    s_mov_b32 s36, s16
    s_mov_b32 s37, s17
    s_mov_b32 s38, 2211840
    s_mov_b32 s39, 0x20000
    s_mov_b32 s72, s70
L_pk3_57:
    s_mul_i32 s85, s72, 2428
    s_lshr_b32 s85, s85, 16
    s_mul_i32 s84, s85, 27
    s_sub_u32 s84, s72, s84
    s_add_u32 s84, s84, 40
    s_sub_u32 s65, s84, 40
    s_lshl_b32 s65, s65, 7
    s_lshl_b32 s66, 3456, 3
    s_mul_i32 s67, s66, s85
    s_lshl3_add_u32 s65, s67, s65
    v_lshrrev_b32 v20, 3, v234
    v_mul_u32_u24 v20, 3456, v20
    v_and_b32 v21, 7, v234
    v_lshl_add_u32 v20, v21, 4, v20
    buffer_load_dwordx4 v[32:35], v20, s[36:39], s65 offen
    s_add_u32 s65, s65, s66
    buffer_load_dwordx4 v[36:39], v20, s[36:39], s65 offen
    s_add_u32 s65, s65, s66
    buffer_load_dwordx4 v[40:43], v20, s[36:39], s65 offen
    s_add_u32 s65, s65, s66
    buffer_load_dwordx4 v[44:47], v20, s[36:39], s65 offen
    s_add_u32 s65, s65, s66
    buffer_load_dwordx4 v[48:51], v20, s[36:39], s65 offen
    s_add_u32 s65, s65, s66
    buffer_load_dwordx4 v[52:55], v20, s[36:39], s65 offen
    s_add_u32 s65, s65, s66
    buffer_load_dwordx4 v[56:59], v20, s[36:39], s65 offen
    s_add_u32 s65, s65, s66
    buffer_load_dwordx4 v[60:63], v20, s[36:39], s65 offen
    s_mov_b32 s64, 0x3f80
    s_mov_b32 s65, 0x3f800000
    v_mov_b32 v8, 0
    v_mov_b32 v9, 0
    v_mov_b32 v10, 0
    v_mov_b32 v11, 0
    v_mov_b32 v12, 0
    v_mov_b32 v13, 0
    v_mov_b32 v14, 0
    v_mov_b32 v15, 0
    s_waitcnt vmcnt(7)
    v_dot2c_f32_bf16 v8, s64, v32
    v_dot2c_f32_bf16 v9, s65, v32
    v_dot2c_f32_bf16 v10, s64, v33
    v_dot2c_f32_bf16 v11, s65, v33
    v_dot2c_f32_bf16 v12, s64, v34
    v_dot2c_f32_bf16 v13, s65, v34
    v_dot2c_f32_bf16 v14, s64, v35
    v_dot2c_f32_bf16 v15, s65, v35
    s_waitcnt vmcnt(6)
    v_dot2c_f32_bf16 v8, s64, v36
    v_dot2c_f32_bf16 v9, s65, v36
    v_dot2c_f32_bf16 v10, s64, v37
    v_dot2c_f32_bf16 v11, s65, v37
    v_dot2c_f32_bf16 v12, s64, v38
    v_dot2c_f32_bf16 v13, s65, v38
    v_dot2c_f32_bf16 v14, s64, v39
    v_dot2c_f32_bf16 v15, s65, v39
    s_waitcnt vmcnt(5)
    v_dot2c_f32_bf16 v8, s64, v40
    v_dot2c_f32_bf16 v9, s65, v40
    v_dot2c_f32_bf16 v10, s64, v41
    v_dot2c_f32_bf16 v11, s65, v41
    v_dot2c_f32_bf16 v12, s64, v42
    v_dot2c_f32_bf16 v13, s65, v42
    v_dot2c_f32_bf16 v14, s64, v43
    v_dot2c_f32_bf16 v15, s65, v43
    s_waitcnt vmcnt(4)
    v_dot2c_f32_bf16 v8, s64, v44
    v_dot2c_f32_bf16 v9, s65, v44
    v_dot2c_f32_bf16 v10, s64, v45
    v_dot2c_f32_bf16 v11, s65, v45
    v_dot2c_f32_bf16 v12, s64, v46
    v_dot2c_f32_bf16 v13, s65, v46
    v_dot2c_f32_bf16 v14, s64, v47
    v_dot2c_f32_bf16 v15, s65, v47
    s_waitcnt vmcnt(3)
    v_dot2c_f32_bf16 v8, s64, v48
    v_dot2c_f32_bf16 v9, s65, v48
    v_dot2c_f32_bf16 v10, s64, v49
    v_dot2c_f32_bf16 v11, s65, v49
    v_dot2c_f32_bf16 v12, s64, v50
    v_dot2c_f32_bf16 v13, s65, v50
    v_dot2c_f32_bf16 v14, s64, v51
    v_dot2c_f32_bf16 v15, s65, v51
    s_waitcnt vmcnt(2)
    v_dot2c_f32_bf16 v8, s64, v52
    v_dot2c_f32_bf16 v9, s65, v52
    v_dot2c_f32_bf16 v10, s64, v53
    v_dot2c_f32_bf16 v11, s65, v53
    v_dot2c_f32_bf16 v12, s64, v54
    v_dot2c_f32_bf16 v13, s65, v54
    v_dot2c_f32_bf16 v14, s64, v55
    v_dot2c_f32_bf16 v15, s65, v55
    s_waitcnt vmcnt(1)
    v_dot2c_f32_bf16 v8, s64, v56
    v_dot2c_f32_bf16 v9, s65, v56
    v_dot2c_f32_bf16 v10, s64, v57
    v_dot2c_f32_bf16 v11, s65, v57
    v_dot2c_f32_bf16 v12, s64, v58
    v_dot2c_f32_bf16 v13, s65, v58
    v_dot2c_f32_bf16 v14, s64, v59
    v_dot2c_f32_bf16 v15, s65, v59
    s_waitcnt vmcnt(0)
    v_dot2c_f32_bf16 v8, s64, v60
    v_dot2c_f32_bf16 v9, s65, v60
    v_dot2c_f32_bf16 v10, s64, v61
    v_dot2c_f32_bf16 v11, s65, v61
    v_dot2c_f32_bf16 v12, s64, v62
    v_dot2c_f32_bf16 v13, s65, v62
    v_dot2c_f32_bf16 v14, s64, v63
    v_dot2c_f32_bf16 v15, s65, v63
    s_nop 2
    v_permlane32_swap_b32 v8, v12
    v_permlane32_swap_b32 v9, v13
    v_permlane32_swap_b32 v10, v14
    v_permlane32_swap_b32 v11, v15
    v_add_f32 v8, v8, v12
    v_add_f32 v9, v9, v13
    v_add_f32 v10, v10, v14
    v_add_f32 v11, v11, v15
    v_and_b32 v12, 7, v234
    v_lshrrev_b32 v13, 4, v234
    v_permlane16_swap_b32 v8, v10
    v_permlane16_swap_b32 v9, v11
    v_add_f32 v8, v8, v10
    v_add_f32 v9, v9, v11
    v_lshlrev_b32 v12, 5, v12
    v_lshl_add_u32 v12, v13, 3, v12
    v_add_f32_dpp v8, v8, v8 row_ror:8 row_mask:0xf bank_mask:0xf
    v_add_f32_dpp v9, v9, v9 row_ror:8 row_mask:0xf bank_mask:0xf
    s_mul_i32 s64, s84, 10
    s_add_u32 s64, s64, s85
    s_lshl_b32 s64, s64, 8
    s_add_u32 s64, s64, 1376256
    s_mov_b32 exec_lo, 0x00ff00ff
    s_mov_b32 exec_hi, 0x00ff00ff
    buffer_store_dwordx2 v[8:9], v12, s[32:35], s64 offen sc1
    s_mov_b64 exec, -1
    s_add_u32 s72, s72, 128
    s_cmp_lt_u32 s72, 270
    s_cbranch_scc1 L_pk3_57
    s_nop 0
    s_lshl_b32 s71, s73, 7
    s_add_u32 s71, s71, 727040
    s_cmp_lg_u32 s46, 0
    s_cmov_b32 s71, 67108864
    s_waitcnt vmcnt(0) lgkmcnt(0)
    s_barrier
    v_mov_b32 v12, s44
    v_mov_b32 v13, s45
    s_mov_b64 exec, 0xffff
    buffer_store_dwordx2 v[12:13], v233, s[32:35], s71 offen sc1
    s_mov_b64 exec, -1
    s_mov_b32 s93, 67108864
    s_mov_b32 s60, 1
    s_cmp_lt_u32 s46, 4
    s_cbranch_scc1 L_T2_C
    v_and_b32 v26, 15, v234
    v_lshlrev_b32 v26, 7, v26
    v_add_u32 v26, 724992, v26
    s_mov_b32 s59, 0x40000
L_poll_58:
    buffer_load_dwordx2 v[2:3], v26, s[32:35], 0 offen sc1
    s_waitcnt vmcnt(0)
    v_cmp_ne_u64 vcc, s[44:45], v[2:3]
    s_cbranch_vccz L_pdone_59
    s_sleep 4
    s_sub_u32 s59, s59, 1
    s_cbranch_scc0 L_poll_58
    s_or_b32 s58, s58, 2
L_pdone_59:
    v_lshlrev_b32 v4, 4, v234
    s_mul_i32 s64, s52, 102400
    s_mul_i32 s65, s47, 16384
    s_add_u32 s64, s64, s65
    s_add_u32 s64, s64, 24903680
    s_add_u32 s65, s65, 40960
    s_mov_b32 m0, s65
    s_nop 0
    buffer_load_dwordx4 v4, s[32:35], s64 offen offset:0 sc1 lds
    buffer_load_dwordx4 v4, s[32:35], s64 offen offset:1024 sc1 lds
    buffer_load_dwordx4 v4, s[32:35], s64 offen offset:2048 sc1 lds
    buffer_load_dwordx4 v4, s[32:35], s64 offen offset:3072 sc1 lds
    s_add_u32 s64, s64, 4096
    s_add_u32 s65, s65, 4096
    s_mov_b32 m0, s65
    s_nop 0
    buffer_load_dwordx4 v4, s[32:35], s64 offen offset:0 sc1 lds
    buffer_load_dwordx4 v4, s[32:35], s64 offen offset:1024 sc1 lds
    buffer_load_dwordx4 v4, s[32:35], s64 offen offset:2048 sc1 lds
    buffer_load_dwordx4 v4, s[32:35], s64 offen offset:3072 sc1 lds
    s_add_u32 s64, s64, 4096
    s_add_u32 s65, s65, 4096
    s_mov_b32 m0, s65
    s_nop 0
    buffer_load_dwordx4 v4, s[32:35], s64 offen offset:0 sc1 lds
    buffer_load_dwordx4 v4, s[32:35], s64 offen offset:1024 sc1 lds
    buffer_load_dwordx4 v4, s[32:35], s64 offen offset:2048 sc1 lds
    buffer_load_dwordx4 v4, s[32:35], s64 offen offset:3072 sc1 lds
    s_add_u32 s64, s64, 4096
    s_add_u32 s65, s65, 4096
    s_mov_b32 m0, s65
    s_nop 0
    buffer_load_dwordx4 v4, s[32:35], s64 offen offset:0 sc1 lds
    buffer_load_dwordx4 v4, s[32:35], s64 offen offset:1024 sc1 lds
    buffer_load_dwordx4 v4, s[32:35], s64 offen offset:2048 sc1 lds
    buffer_load_dwordx4 v4, s[32:35], s64 offen offset:3072 sc1 lds
    s_mul_i32 s64, s52, 102400
    s_mul_i32 s65, s47, 9216
    s_add_u32 s64, s64, s65
    s_add_u32 s64, s64, 24969216
    s_add_u32 s65, s65, 126976
    s_mov_b32 m0, s65
    s_nop 0
    buffer_load_dwordx4 v4, s[32:35], s64 offen offset:0 sc1 lds
    buffer_load_dwordx4 v4, s[32:35], s64 offen offset:1024 sc1 lds
    buffer_load_dwordx4 v4, s[32:35], s64 offen offset:2048 sc1 lds
    buffer_load_dwordx4 v4, s[32:35], s64 offen offset:3072 sc1 lds
    s_add_u32 s64, s64, 4096
    s_add_u32 s65, s65, 4096
    s_mov_b32 m0, s65
    s_nop 0
    buffer_load_dwordx4 v4, s[32:35], s64 offen offset:0 sc1 lds
    buffer_load_dwordx4 v4, s[32:35], s64 offen offset:1024 sc1 lds
    buffer_load_dwordx4 v4, s[32:35], s64 offen offset:2048 sc1 lds
    buffer_load_dwordx4 v4, s[32:35], s64 offen offset:3072 sc1 lds
    s_add_u32 s64, s64, 4096
    s_add_u32 s65, s65, 4096
    s_mov_b32 m0, s65
    s_nop 0
    buffer_load_dwordx4 v4, s[32:35], s64 offen offset:0 sc1 lds
    v_and_b32 v224, 15, v234
    v_lshrrev_b32 v225, 4, v234
    v_mul_u32_u24 v224, 1280, v224
    v_lshl_add_u32 v224, v225, 3, v224
    s_lshl2_add_u32 s64, s51, s47
    s_mul_i32 s64, s64, 20480
    s_mul_i32 s65, s52, 160
    s_add_u32 s64, s64, s65
    buffer_load_dwordx2 v[236:237], v224, s[28:31], s64 offen offset:0
    buffer_load_dwordx2 v[238:239], v224, s[28:31], s64 offen offset:32
    buffer_load_dwordx2 v[240:241], v224, s[28:31], s64 offen offset:64
    buffer_load_dwordx2 v[242:243], v224, s[28:31], s64 offen offset:96
    buffer_load_dwordx2 v[244:245], v224, s[28:31], s64 offen offset:128
    s_mov_b32 s94, 959
    s_branch L_T2_L
L_T2_L:
    s_setprio 1
    s_mul_i32 s64, s56, 51200
    s_add_u32 s64, s64, 40960
    v_add_u32 v216, s64, v4
    s_add_u32 s64, s64, 14336
    s_cmp_eq_u32 s56, 1
    s_cmov_b32 s64, 126976
    v_add_u32 v217, s64, v4
    s_xor_b32 s64, s47, 1
    s_mul_i32 s64, s64, 5120
    s_add_u32 s64, s64, 106496
    v_add_u32 v218, s64, v4
    s_mul_i32 s64, s47, 5120
    s_add_u32 s64, s64, 106496
    v_add_u32 v219, s64, v4
    v_mov_b32 v224, -1
    ds_write_b32 v219, v224 offset:4108
    s_sub_u32 s64, s51, 1
    s_max_i32 s64, s64, 0
    s_add_u32 s65, s51, 1
    s_min_u32 s65, s65, 31
    s_cmp_eq_u32 s55, 0
    s_cselect_b32 s64, s64, s65
    s_sub_u32 s64, s64, s51
    v_bfe_u32 v1, v234, 4, 1
    v_mul_i32_i24 v1, s64, v1
    v_add_u32 v1, s51, v1
    v_and_b32 v0, 15, v234
    v_min_u32 v0, 5, v0
    s_lshl_b32 s64, s56, 2
    s_and_b32 s64, s64, 15
    v_add_u32 v0, s64, v0
    v_lshl_add_u32 v0, v1, 4, v0
    v_lshlrev_b32 v0, 7, v0
    v_add_u32 v0, 4096, v0
    s_lshl2_add_u32 s66, s51, s47
    s_lshl_b32 s67, s66, 4
    v_and_b32 v9, 15, v234
    v_add_u32 v9, s67, v9
    v_and_b32 v10, 1, v9
    v_lshrrev_b32 v8, 1, v9
    v_lshlrev_b32 v8, 7, v8
    v_lshl_add_u32 v8, v10, 4, v8
    v_xor_b32 v17, 16, v9
    v_lshrrev_b32 v10, 4, v234
    v_lshlrev_b32 v10, 8, v10
    v_mov_b32 v13, 67108864
    s_mov_b32 s68, 2048
    s_add_u32 s64, s56, 1
    v_subrev_u32 v11, s64, v9
    v_lshrrev_b32 v12, 4, v11
    v_mul_u32_u24 v12, 20480, v12
    v_cmp_gt_u32 vcc, s68, v11
    v_and_b32 v11, 15, v11
    v_lshl_add_u32 v11, v11, 4, v10
    v_add_u32 v12, v12, v11
    v_cndmask_b32 v4, v13, v12, vcc
    v_subrev_u32 v11, s64, v17
    v_lshrrev_b32 v12, 4, v11
    v_mul_u32_u24 v12, 20480, v12
    v_cmp_gt_u32 vcc, s68, v11
    v_and_b32 v11, 15, v11
    v_lshl_add_u32 v11, v11, 4, v10
    v_add_u32 v12, v12, v11
    v_cndmask_b32 v5, v13, v12, vcc
    v_add_u32 v11, s64, v9
    v_lshrrev_b32 v12, 4, v11
    v_mul_u32_u24 v12, 20480, v12
    v_cmp_gt_u32 vcc, s68, v11
    v_and_b32 v11, 15, v11
    v_lshl_add_u32 v11, v11, 4, v10
    v_add_u32 v12, v12, v11
    v_cndmask_b32 v6, v13, v12, vcc
    v_add_u32 v11, s64, v17
    v_lshrrev_b32 v12, 4, v11
    v_mul_u32_u24 v12, 20480, v12
    v_cmp_gt_u32 vcc, s68, v11
    v_and_b32 v11, 15, v11
    v_lshl_add_u32 v11, v11, 4, v10
    v_add_u32 v12, v12, v11
    v_cndmask_b32 v7, v13, v12, vcc
    s_mul_i32 s65, s56, 10240
    s_add_u32 s65, s65, 2097152
    s_mov_b32 s95, s65
    s_lshr_b32 s64, s50, 2
    s_mul_i32 s54, s49, 7
    s_add_u32 s54, s54, s64
    s_mov_b32 s36, s16
    s_mov_b32 s37, s17
    s_mov_b32 s38, 2211840
    s_mov_b32 s39, 0x20000
    s_cmp_eq_u32 s61, 0
    s_cmov_b32 s38, 0
    v_lshrrev_b32 v1, 3, v234
    s_lshl_b32 s64, s47, 4
    v_add_u32 v1, s64, v1
    v_mul_u32_u24 v1, 3456, v1
    v_and_b32 v2, 7, v234
    v_bfe_u32 v3, v234, 4, 1
    v_lshlrev_b32 v3, 2, v3
    v_xor_b32 v2, v2, v3
    v_lshrrev_b32 v3, 5, v234
    v_lshlrev_b32 v3, 1, v3
    v_xor_b32 v2, v2, v3
    v_xor_b32 v3, 2, v2
    v_lshl_add_u32 v230, v2, 4, v1
    v_lshl_add_u32 v231, v3, 4, v1
    v_add_u32 v231, 26624, v231
    s_lshl_b32 s71, s54, 8
    s_lshl_b32 s73, s47, 11
    s_add_u32 s73, s73, 40960
    s_mov_b32 s75, 1
    v_lshlrev_b32 v226, 4, v234
    v_add_u32 v227, 18432, v226
    s_lshl2_add_u32 s64, s53, s47
    s_mul_i32 s70, s64, 40960
    s_add_u32 s70, s70, 12582912
    s_lshl_b32 s72, s47, 12
    s_add_u32 s72, s72, 131072
    s_mov_b32 s74, 1
    s_lshl2_add_u32 s64, s53, s47
    s_lshl_b32 s64, s64, 11
    s_add_u32 s64, s64, 200704
    v_and_b32 v232, 15, v234
    v_lshl_add_u32 v232, v232, 7, s64
    s_cmp_lt_u32 s46, 4
    s_cselect_b32 s64, 442368, 0
    s_add_u32 s71, s71, s64
    s_cmp_lt_u32 s46, 4
    s_cselect_b32 s64, 32768, 0
    s_add_u32 s73, s73, s64
    v_and_b32 v30, 31, v234
    v_lshrrev_b32 v31, 5, v234
    s_lshl_b32 s64, s46, 8
    v_lshl_add_u32 v25, v30, 3, s64
    v_lshl_add_u32 v24, v31, 13, v25
    v_lshl_add_u32 v27, v31, 15, v25
    s_mul_i32 s65, s46, 1280
    s_add_u32 s65, s65, 20480
    v_lshl_add_u32 v26, v30, 4, s65
    v_mul_u32_u24 v31, 320, v31
    v_add_u32 v26, v26, v31
    v_mov_b32 v30, 0xf149f2ca
    v_mov_b32 v20, 0
    v_mov_b32 v21, 0
    v_mov_b32 v22, 0
    v_mov_b32 v23, 0
    s_mov_b32 exec_hi, 0
    v_mov_b32 v22, 0x3f80
    s_mov_b32 exec_hi, -1
    s_sub_u32 s96, 8, s46
    s_cmp_eq_u32 s62, 0
    s_cselect_b32 s96, s96, 0
    s_mul_i32 s97, s63, 81920
    s_lshl_b32 s65, s62, 11
    s_add_u32 s97, s97, s65
    v_and_b32 v210, 15, v234
    v_bfe_u32 v211, v234, 4, 1
    v_mul_u32_u24 v211, 20480, v211
    v_lshrrev_b32 v209, 5, v234
    v_lshl_add_u32 v208, v209, 26, v211
    v_lshl_add_u32 v208, v210, 3, v208
    v_lshl_add_u32 v211, v209, 8, v211
    v_lshl_add_u32 v210, v210, 4, v211
    s_lshl3_add_u32 s64, s62, s46
    s_mul_i32 s64, s64, 40960
    s_lshr_b32 s65, s63, 3
    s_mul_i32 s65, s65, 5120
    s_add_u32 s64, s64, s65
    s_add_u32 s64, s64, 15204352
    s_and_b32 s65, s63, 7
    s_lshl_b32 s66, s65, 7
    s_lshl_b32 s65, s65, 9
    s_add_u32 s87, s65, s64
    s_add_u32 s66, s64, s66
    s_add_u32 s86, s66, 4096
    s_mov_b32 vcc_lo, 0x0
    s_mov_b32 vcc_hi, 0xf
    v_cndmask_b32 v48, 0, v30, vcc
    v_cndmask_b32_e64 v32, v30, 0, vcc
    s_mov_b32 vcc_lo, 0x1
    s_mov_b32 vcc_hi, 0x1f
    v_cndmask_b32 v49, 0, v30, vcc
    v_cndmask_b32_e64 v33, v30, 0, vcc
    s_mov_b32 vcc_lo, 0x3
    s_mov_b32 vcc_hi, 0x3f
    v_cndmask_b32 v50, 0, v30, vcc
    v_cndmask_b32_e64 v34, v30, 0, vcc
    s_mov_b32 vcc_lo, 0x7
    s_mov_b32 vcc_hi, 0x7f
    v_cndmask_b32 v51, 0, v30, vcc
    v_cndmask_b32_e64 v35, v30, 0, vcc
    s_mov_b32 vcc_lo, 0xff
    s_mov_b32 vcc_hi, 0xfff
    v_cndmask_b32 v52, 0, v30, vcc
    v_cndmask_b32_e64 v36, v30, 0, vcc
    s_mov_b32 vcc_lo, 0x1ff
    s_mov_b32 vcc_hi, 0x1fff
    v_cndmask_b32 v53, 0, v30, vcc
    v_cndmask_b32_e64 v37, v30, 0, vcc
    s_mov_b32 vcc_lo, 0x3ff
    s_mov_b32 vcc_hi, 0x3fff
    v_cndmask_b32 v54, 0, v30, vcc
    v_cndmask_b32_e64 v38, v30, 0, vcc
    s_mov_b32 vcc_lo, 0x7ff
    s_mov_b32 vcc_hi, 0x7fff
    v_cndmask_b32 v55, 0, v30, vcc
    v_cndmask_b32_e64 v39, v30, 0, vcc
    s_mov_b32 vcc_lo, 0xffff
    s_mov_b32 vcc_hi, 0xfffff
    v_cndmask_b32 v56, 0, v30, vcc
    v_cndmask_b32_e64 v40, v30, 0, vcc
    s_mov_b32 vcc_lo, 0x1ffff
    s_mov_b32 vcc_hi, 0x1fffff
    v_cndmask_b32 v57, 0, v30, vcc
    v_cndmask_b32_e64 v41, v30, 0, vcc
    s_mov_b32 vcc_lo, 0x3ffff
    s_mov_b32 vcc_hi, 0x3fffff
    v_cndmask_b32 v58, 0, v30, vcc
    v_cndmask_b32_e64 v42, v30, 0, vcc
    s_mov_b32 vcc_lo, 0x7ffff
    s_mov_b32 vcc_hi, 0x7fffff
    v_cndmask_b32 v59, 0, v30, vcc
    v_cndmask_b32_e64 v43, v30, 0, vcc
    s_mov_b32 vcc_lo, 0xffffff
    s_mov_b32 vcc_hi, 0xfffffff
    v_cndmask_b32 v60, 0, v30, vcc
    v_cndmask_b32_e64 v44, v30, 0, vcc
    s_mov_b32 vcc_lo, 0x1ffffff
    s_mov_b32 vcc_hi, 0x1fffffff
    v_cndmask_b32 v61, 0, v30, vcc
    v_cndmask_b32_e64 v45, v30, 0, vcc
    s_mov_b32 vcc_lo, 0x3ffffff
    s_mov_b32 vcc_hi, 0x3fffffff
    v_cndmask_b32 v62, 0, v30, vcc
    v_cndmask_b32_e64 v46, v30, 0, vcc
    s_mov_b32 vcc_lo, 0x7ffffff
    s_mov_b32 vcc_hi, 0x7fffffff
    v_cndmask_b32 v63, 0, v30, vcc
    v_cndmask_b32_e64 v47, v30, 0, vcc
    s_waitcnt vmcnt(0) lgkmcnt(0)
    s_barrier
    s_mul_i32 s64, s94, 960
    s_load_dword s10, s[18:19], s64
    s_add_u32 s64, s64, 64
    s_load_dword s10, s[18:19], s64
    s_add_u32 s64, s64, 64
    s_load_dword s10, s[18:19], s64
    s_add_u32 s64, s64, 64
    s_load_dword s10, s[18:19], s64
    s_add_u32 s64, s64, 64
    s_load_dword s10, s[18:19], s64
    s_add_u32 s64, s64, 64
    s_load_dword s10, s[18:19], s64
    s_add_u32 s64, s64, 64
    s_load_dword s10, s[18:19], s64
    s_add_u32 s64, s64, 64
    s_load_dword s10, s[18:19], s64
    s_add_u32 s64, s64, 64
    s_load_dword s10, s[18:19], s64
    s_add_u32 s64, s64, 64
    s_load_dword s10, s[18:19], s64
    s_add_u32 s64, s64, 64
    s_load_dword s10, s[18:19], s64
    s_add_u32 s64, s64, 64
    s_load_dword s10, s[18:19], s64
    s_add_u32 s64, s64, 64
    s_load_dword s10, s[18:19], s64
    s_add_u32 s64, s64, 64
    s_load_dword s10, s[18:19], s64
    s_add_u32 s64, s64, 64
    s_load_dword s10, s[18:19], s64
    s_add_u32 s64, s64, 64
    v_lshlrev_b32 v64, 16, v236
    v_and_b32 v65, 0xffff0000, v236
    v_lshlrev_b32 v66, 16, v237
    v_and_b32 v67, 0xffff0000, v237
    v_lshlrev_b32 v68, 16, v238
    v_and_b32 v69, 0xffff0000, v238
    v_lshlrev_b32 v70, 16, v239
    v_and_b32 v71, 0xffff0000, v239
    v_lshlrev_b32 v72, 16, v240
    v_and_b32 v73, 0xffff0000, v240
    v_lshlrev_b32 v74, 16, v241
    v_and_b32 v75, 0xffff0000, v241
    v_lshlrev_b32 v76, 16, v242
    v_and_b32 v77, 0xffff0000, v242
    v_lshlrev_b32 v78, 16, v243
    v_and_b32 v79, 0xffff0000, v243
    v_lshlrev_b32 v80, 16, v244
    v_and_b32 v81, 0xffff0000, v244
    v_lshlrev_b32 v82, 16, v245
    v_and_b32 v83, 0xffff0000, v245
    s_lshl2_add_u32 s64, s51, s47
    s_lshr_b32 s65, s64, 4
    s_and_b32 s64, s64, 15
    s_lshl_b32 s64, s64, 4
    s_add_u32 s64, s64, s65
    v_bfe_u32 v9, v234, 2, 1
    v_lshl_add_u32 v9, v9, 3, s64
    v_and_b32 v10, 3, v234
    v_lshl_add_u32 v9, v9, 2, v10
    v_lshlrev_b32 v9, 7, v9
    v_add_u32 v9, 856064, v9
    s_mov_b32 s59, 0x40000
L_poll_60:
    buffer_load_dwordx2 v[2:3], v9, s[32:35], 0 offen sc1
    s_waitcnt vmcnt(0)
    v_cmp_ne_u64 vcc, s[44:45], v[2:3]
    s_cbranch_vccz L_pdone_61
    s_sleep 4
    s_sub_u32 s59, s59, 1
    s_cbranch_scc0 L_poll_60
    s_or_b32 s58, s58, 2048
L_pdone_61:
    s_mov_b32 s64, 1703936
    buffer_load_dwordx3 v[14:16], v8, s[32:35], s64 offen sc1
    s_waitcnt vmcnt(0)
    v_lshlrev_b32 v14, 16, v14
    v_lshlrev_b32 v15, 16, v15
    v_add_f32 v14, v14, v15
    v_mul_f32 v14, v14, v16
    v_fma_f32 v64, v64, v16, v14
    v_fma_f32 v65, v65, v16, v14
    v_fma_f32 v66, v66, v16, v14
    v_fma_f32 v67, v67, v16, v14
    v_fma_f32 v68, v68, v16, v14
    v_fma_f32 v69, v69, v16, v14
    v_fma_f32 v70, v70, v16, v14
    v_fma_f32 v71, v71, v16, v14
    v_fma_f32 v72, v72, v16, v14
    v_fma_f32 v73, v73, v16, v14
    v_fma_f32 v74, v74, v16, v14
    v_fma_f32 v75, v75, v16, v14
    v_fma_f32 v76, v76, v16, v14
    v_fma_f32 v77, v77, v16, v14
    v_fma_f32 v78, v78, v16, v14
    v_fma_f32 v79, v79, v16, v14
    v_fma_f32 v80, v80, v16, v14
    v_fma_f32 v81, v81, v16, v14
    v_fma_f32 v82, v82, v16, v14
    v_fma_f32 v83, v83, v16, v14
    s_mov_b32 s59, 0x40000
L_poll_62:
    buffer_load_dwordx2 v[2:3], v0, s[32:35], 0 offen sc1
    s_waitcnt vmcnt(0)
    v_cmp_ne_u64 vcc, s[44:45], v[2:3]
    s_cbranch_vccz L_pdone_63
    s_sleep 4
    s_sub_u32 s59, s59, 1
    s_cbranch_scc0 L_poll_62
    s_or_b32 s58, s58, 1
L_pdone_63:
    s_add_u32 s64, s95, 0
    buffer_load_dwordx4 v[104:107], v4, s[32:35], s64 offen offset:0 sc1
    buffer_load_dwordx4 v[108:111], v5, s[32:35], s64 offen offset:0 sc1
    buffer_load_dwordx4 v[112:115], v4, s[32:35], s64 offen offset:1024 sc1
    buffer_load_dwordx4 v[116:119], v5, s[32:35], s64 offen offset:1024 sc1
    buffer_load_dwordx4 v[120:123], v4, s[32:35], s64 offen offset:2048 sc1
    buffer_load_dwordx4 v[124:127], v5, s[32:35], s64 offen offset:2048 sc1
    buffer_load_dwordx4 v[128:131], v4, s[32:35], s64 offen offset:3072 sc1
    buffer_load_dwordx4 v[132:135], v5, s[32:35], s64 offen offset:3072 sc1
    s_add_u32 s64, s95, 4096
    buffer_load_dwordx4 v[136:139], v4, s[32:35], s64 offen offset:0 sc1
    buffer_load_dwordx4 v[140:143], v5, s[32:35], s64 offen offset:0 sc1
    s_add_u32 s64, s95, 5120
    buffer_load_dwordx4 v[144:147], v6, s[32:35], s64 offen offset:0 sc1
    buffer_load_dwordx4 v[148:151], v7, s[32:35], s64 offen offset:0 sc1
    s_waitcnt lgkmcnt(0)
    ds_read_b128 v[184:187], v216 offset:0
    ds_read_b128 v[188:191], v216 offset:1024
    ds_read_b128 v[192:195], v216 offset:2048
    ds_read_b128 v[196:199], v216 offset:3072
    ds_read_b128 v[200:203], v216 offset:4096
    s_waitcnt vmcnt(10)
    s_waitcnt lgkmcnt(4)
    v_mfma_f32_16x16x32_bf16 v[84:87], v[184:187], v[108:111], 0
    v_mfma_f32_16x16x32_bf16 v[64:67], v[184:187], v[104:107], v[64:67]
    ds_read_b128 v[184:187], v216 offset:5120
    buffer_load_dwordx4 v[152:155], v6, s[32:35], s64 offen offset:1024 sc1
    s_waitcnt lgkmcnt(4)
    v_mfma_f32_16x16x32_bf16 v[88:91], v[188:191], v[108:111], 0
    v_mfma_f32_16x16x32_bf16 v[68:71], v[188:191], v[104:107], v[68:71]
    ds_read_b128 v[188:191], v216 offset:6144
    buffer_load_dwordx4 v[156:159], v7, s[32:35], s64 offen offset:1024 sc1
    s_waitcnt lgkmcnt(4)
    v_mfma_f32_16x16x32_bf16 v[92:95], v[192:195], v[108:111], 0
    v_mfma_f32_16x16x32_bf16 v[72:75], v[192:195], v[104:107], v[72:75]
    ds_read_b128 v[192:195], v216 offset:7168
    s_waitcnt lgkmcnt(4)
    v_mfma_f32_16x16x32_bf16 v[96:99], v[196:199], v[108:111], 0
    v_mfma_f32_16x16x32_bf16 v[76:79], v[196:199], v[104:107], v[76:79]
    ds_read_b128 v[196:199], v216 offset:8192
    s_waitcnt lgkmcnt(4)
    v_mfma_f32_16x16x32_bf16 v[100:103], v[200:203], v[108:111], 0
    v_mfma_f32_16x16x32_bf16 v[80:83], v[200:203], v[104:107], v[80:83]
    ds_read_b128 v[200:203], v216 offset:9216
    s_waitcnt vmcnt(10)
    s_waitcnt lgkmcnt(4)
    v_mfma_f32_16x16x32_bf16 v[84:87], v[184:187], v[116:119], v[84:87]
    v_mfma_f32_16x16x32_bf16 v[64:67], v[184:187], v[112:115], v[64:67]
    ds_read_b128 v[184:187], v216 offset:10240
    buffer_load_dwordx4 v[160:163], v6, s[32:35], s64 offen offset:2048 sc1
    s_waitcnt lgkmcnt(4)
    v_mfma_f32_16x16x32_bf16 v[88:91], v[188:191], v[116:119], v[88:91]
    v_mfma_f32_16x16x32_bf16 v[68:71], v[188:191], v[112:115], v[68:71]
    ds_read_b128 v[188:191], v216 offset:11264
    buffer_load_dwordx4 v[164:167], v7, s[32:35], s64 offen offset:2048 sc1
    s_waitcnt lgkmcnt(4)
    v_mfma_f32_16x16x32_bf16 v[92:95], v[192:195], v[116:119], v[92:95]
    v_mfma_f32_16x16x32_bf16 v[72:75], v[192:195], v[112:115], v[72:75]
    ds_read_b128 v[192:195], v216 offset:12288
    s_waitcnt lgkmcnt(4)
    v_mfma_f32_16x16x32_bf16 v[96:99], v[196:199], v[116:119], v[96:99]
    v_mfma_f32_16x16x32_bf16 v[76:79], v[196:199], v[112:115], v[76:79]
    ds_read_b128 v[196:199], v216 offset:13312
    s_waitcnt lgkmcnt(4)
    v_mfma_f32_16x16x32_bf16 v[100:103], v[200:203], v[116:119], v[100:103]
    v_mfma_f32_16x16x32_bf16 v[80:83], v[200:203], v[112:115], v[80:83]
    ds_read_b128 v[200:203], v217 offset:0
    s_waitcnt vmcnt(10)
    s_waitcnt lgkmcnt(4)
    v_mfma_f32_16x16x32_bf16 v[84:87], v[184:187], v[124:127], v[84:87]
    v_mfma_f32_16x16x32_bf16 v[64:67], v[184:187], v[120:123], v[64:67]
    ds_read_b128 v[184:187], v217 offset:1024
    buffer_load_dwordx4 v[168:171], v6, s[32:35], s64 offen offset:3072 sc1
    s_waitcnt lgkmcnt(4)
    v_mfma_f32_16x16x32_bf16 v[88:91], v[188:191], v[124:127], v[88:91]
    v_mfma_f32_16x16x32_bf16 v[68:71], v[188:191], v[120:123], v[68:71]
    ds_read_b128 v[188:191], v217 offset:2048
    buffer_load_dwordx4 v[172:175], v7, s[32:35], s64 offen offset:3072 sc1
    s_waitcnt lgkmcnt(4)
    v_mfma_f32_16x16x32_bf16 v[92:95], v[192:195], v[124:127], v[92:95]
    v_mfma_f32_16x16x32_bf16 v[72:75], v[192:195], v[120:123], v[72:75]
    ds_read_b128 v[192:195], v217 offset:3072
    s_waitcnt lgkmcnt(4)
    v_mfma_f32_16x16x32_bf16 v[96:99], v[196:199], v[124:127], v[96:99]
    v_mfma_f32_16x16x32_bf16 v[76:79], v[196:199], v[120:123], v[76:79]
    ds_read_b128 v[196:199], v217 offset:4096
    s_waitcnt lgkmcnt(4)
    v_mfma_f32_16x16x32_bf16 v[100:103], v[200:203], v[124:127], v[100:103]
    v_mfma_f32_16x16x32_bf16 v[80:83], v[200:203], v[120:123], v[80:83]
    ds_read_b128 v[200:203], v217 offset:5120
    s_waitcnt vmcnt(10)
    s_waitcnt lgkmcnt(4)
    v_mfma_f32_16x16x32_bf16 v[84:87], v[184:187], v[132:135], v[84:87]
    v_mfma_f32_16x16x32_bf16 v[64:67], v[184:187], v[128:131], v[64:67]
    ds_read_b128 v[184:187], v217 offset:6144
    s_add_u32 s64, s95, 9216
    buffer_load_dwordx4 v[176:179], v6, s[32:35], s64 offen offset:0 sc1
    s_waitcnt lgkmcnt(4)
    v_mfma_f32_16x16x32_bf16 v[88:91], v[188:191], v[132:135], v[88:91]
    v_mfma_f32_16x16x32_bf16 v[68:71], v[188:191], v[128:131], v[68:71]
    ds_read_b128 v[188:191], v217 offset:7168
    buffer_load_dwordx4 v[180:183], v7, s[32:35], s64 offen offset:0 sc1
    s_waitcnt lgkmcnt(4)
    v_mfma_f32_16x16x32_bf16 v[92:95], v[192:195], v[132:135], v[92:95]
    v_mfma_f32_16x16x32_bf16 v[72:75], v[192:195], v[128:131], v[72:75]
    ds_read_b128 v[192:195], v217 offset:8192
    s_waitcnt lgkmcnt(4)
    v_mfma_f32_16x16x32_bf16 v[96:99], v[196:199], v[132:135], v[96:99]
    v_mfma_f32_16x16x32_bf16 v[76:79], v[196:199], v[128:131], v[76:79]
    ds_read_b128 v[196:199], v217 offset:9216
    s_waitcnt lgkmcnt(4)
    v_mfma_f32_16x16x32_bf16 v[100:103], v[200:203], v[132:135], v[100:103]
    v_mfma_f32_16x16x32_bf16 v[80:83], v[200:203], v[128:131], v[80:83]
    ds_read_b128 v[200:203], v217 offset:10240
    s_waitcnt vmcnt(10)
    s_waitcnt lgkmcnt(4)
    v_mfma_f32_16x16x32_bf16 v[84:87], v[184:187], v[140:143], v[84:87]
    v_mfma_f32_16x16x32_bf16 v[64:67], v[184:187], v[136:139], v[64:67]
    ds_read_b128 v[184:187], v217 offset:11264
    s_waitcnt lgkmcnt(4)
    v_mfma_f32_16x16x32_bf16 v[88:91], v[188:191], v[140:143], v[88:91]
    v_mfma_f32_16x16x32_bf16 v[68:71], v[188:191], v[136:139], v[68:71]
    ds_read_b128 v[188:191], v217 offset:12288
    s_waitcnt lgkmcnt(4)
    v_mfma_f32_16x16x32_bf16 v[92:95], v[192:195], v[140:143], v[92:95]
    v_mfma_f32_16x16x32_bf16 v[72:75], v[192:195], v[136:139], v[72:75]
    ds_read_b128 v[192:195], v217 offset:13312
    s_waitcnt lgkmcnt(4)
    v_mfma_f32_16x16x32_bf16 v[96:99], v[196:199], v[140:143], v[96:99]
    v_mfma_f32_16x16x32_bf16 v[76:79], v[196:199], v[136:139], v[76:79]
    ds_read_b128 v[196:199], v217 offset:14336
    s_waitcnt lgkmcnt(4)
    v_mfma_f32_16x16x32_bf16 v[100:103], v[200:203], v[140:143], v[100:103]
    v_mfma_f32_16x16x32_bf16 v[80:83], v[200:203], v[136:139], v[80:83]
    ds_read_b128 v[200:203], v217 offset:15360
    s_waitcnt vmcnt(8)
    s_waitcnt lgkmcnt(4)
    v_mfma_f32_16x16x32_bf16 v[84:87], v[184:187], v[148:151], v[84:87]
    v_mfma_f32_16x16x32_bf16 v[64:67], v[184:187], v[144:147], v[64:67]
    ds_read_b128 v[184:187], v217 offset:16384
    s_waitcnt lgkmcnt(4)
    v_mfma_f32_16x16x32_bf16 v[88:91], v[188:191], v[148:151], v[88:91]
    v_mfma_f32_16x16x32_bf16 v[68:71], v[188:191], v[144:147], v[68:71]
    ds_read_b128 v[188:191], v217 offset:17408
    s_waitcnt lgkmcnt(4)
    v_mfma_f32_16x16x32_bf16 v[92:95], v[192:195], v[148:151], v[92:95]
    v_mfma_f32_16x16x32_bf16 v[72:75], v[192:195], v[144:147], v[72:75]
    ds_read_b128 v[192:195], v217 offset:18432
    s_waitcnt lgkmcnt(4)
    v_mfma_f32_16x16x32_bf16 v[96:99], v[196:199], v[148:151], v[96:99]
    v_mfma_f32_16x16x32_bf16 v[76:79], v[196:199], v[144:147], v[76:79]
    ds_read_b128 v[196:199], v217 offset:19456
    s_waitcnt lgkmcnt(4)
    v_mfma_f32_16x16x32_bf16 v[100:103], v[200:203], v[148:151], v[100:103]
    v_mfma_f32_16x16x32_bf16 v[80:83], v[200:203], v[144:147], v[80:83]
    ds_read_b128 v[200:203], v217 offset:20480
    s_waitcnt vmcnt(6)
    s_waitcnt lgkmcnt(4)
    v_mfma_f32_16x16x32_bf16 v[84:87], v[184:187], v[156:159], v[84:87]
    v_mfma_f32_16x16x32_bf16 v[64:67], v[184:187], v[152:155], v[64:67]
    ds_read_b128 v[184:187], v217 offset:21504
    s_waitcnt lgkmcnt(4)
    v_mfma_f32_16x16x32_bf16 v[88:91], v[188:191], v[156:159], v[88:91]
    v_mfma_f32_16x16x32_bf16 v[68:71], v[188:191], v[152:155], v[68:71]
    ds_read_b128 v[188:191], v217 offset:22528
    s_waitcnt lgkmcnt(4)
    v_mfma_f32_16x16x32_bf16 v[92:95], v[192:195], v[156:159], v[92:95]
    v_mfma_f32_16x16x32_bf16 v[72:75], v[192:195], v[152:155], v[72:75]
    ds_read_b128 v[192:195], v217 offset:23552
    s_waitcnt lgkmcnt(4)
    v_mfma_f32_16x16x32_bf16 v[96:99], v[196:199], v[156:159], v[96:99]
    v_mfma_f32_16x16x32_bf16 v[76:79], v[196:199], v[152:155], v[76:79]
    ds_read_b128 v[196:199], v217 offset:24576
    s_waitcnt lgkmcnt(4)
    v_mfma_f32_16x16x32_bf16 v[100:103], v[200:203], v[156:159], v[100:103]
    v_mfma_f32_16x16x32_bf16 v[80:83], v[200:203], v[152:155], v[80:83]
    ds_read_b128 v[200:203], v217 offset:25600
    s_waitcnt vmcnt(4)
    s_waitcnt lgkmcnt(4)
    v_mfma_f32_16x16x32_bf16 v[84:87], v[184:187], v[164:167], v[84:87]
    v_mfma_f32_16x16x32_bf16 v[64:67], v[184:187], v[160:163], v[64:67]
    ds_read_b128 v[184:187], v217 offset:26624
    s_waitcnt lgkmcnt(4)
    v_mfma_f32_16x16x32_bf16 v[88:91], v[188:191], v[164:167], v[88:91]
    v_mfma_f32_16x16x32_bf16 v[68:71], v[188:191], v[160:163], v[68:71]
    ds_read_b128 v[188:191], v217 offset:27648
    s_waitcnt lgkmcnt(4)
    v_mfma_f32_16x16x32_bf16 v[92:95], v[192:195], v[164:167], v[92:95]
    v_mfma_f32_16x16x32_bf16 v[72:75], v[192:195], v[160:163], v[72:75]
    ds_read_b128 v[192:195], v217 offset:28672
    s_waitcnt lgkmcnt(4)
    v_mfma_f32_16x16x32_bf16 v[96:99], v[196:199], v[164:167], v[96:99]
    v_mfma_f32_16x16x32_bf16 v[76:79], v[196:199], v[160:163], v[76:79]
    ds_read_b128 v[196:199], v217 offset:29696
    s_waitcnt lgkmcnt(4)
    v_mfma_f32_16x16x32_bf16 v[100:103], v[200:203], v[164:167], v[100:103]
    v_mfma_f32_16x16x32_bf16 v[80:83], v[200:203], v[160:163], v[80:83]
    ds_read_b128 v[200:203], v217 offset:30720
    s_waitcnt vmcnt(2)
    s_waitcnt lgkmcnt(4)
    v_mfma_f32_16x16x32_bf16 v[84:87], v[184:187], v[172:175], v[84:87]
    v_mfma_f32_16x16x32_bf16 v[64:67], v[184:187], v[168:171], v[64:67]
    ds_read_b128 v[184:187], v217 offset:31744
    s_waitcnt lgkmcnt(4)
    v_mfma_f32_16x16x32_bf16 v[88:91], v[188:191], v[172:175], v[88:91]
    v_mfma_f32_16x16x32_bf16 v[68:71], v[188:191], v[168:171], v[68:71]
    ds_read_b128 v[188:191], v217 offset:32768
    s_waitcnt lgkmcnt(4)
    v_mfma_f32_16x16x32_bf16 v[92:95], v[192:195], v[172:175], v[92:95]
    v_mfma_f32_16x16x32_bf16 v[72:75], v[192:195], v[168:171], v[72:75]
    ds_read_b128 v[192:195], v217 offset:33792
    s_waitcnt lgkmcnt(4)
    v_mfma_f32_16x16x32_bf16 v[96:99], v[196:199], v[172:175], v[96:99]
    v_mfma_f32_16x16x32_bf16 v[76:79], v[196:199], v[168:171], v[76:79]
    ds_read_b128 v[196:199], v217 offset:34816
    s_waitcnt lgkmcnt(4)
    v_mfma_f32_16x16x32_bf16 v[100:103], v[200:203], v[172:175], v[100:103]
    v_mfma_f32_16x16x32_bf16 v[80:83], v[200:203], v[168:171], v[80:83]
    ds_read_b128 v[200:203], v217 offset:35840
    s_waitcnt vmcnt(0)
    s_waitcnt lgkmcnt(4)
    v_mfma_f32_16x16x32_bf16 v[84:87], v[184:187], v[180:183], v[84:87]
    v_mfma_f32_16x16x32_bf16 v[64:67], v[184:187], v[176:179], v[64:67]
    s_waitcnt lgkmcnt(3)
    v_mfma_f32_16x16x32_bf16 v[88:91], v[188:191], v[180:183], v[88:91]
    v_mfma_f32_16x16x32_bf16 v[68:71], v[188:191], v[176:179], v[68:71]
    s_waitcnt lgkmcnt(2)
    v_mfma_f32_16x16x32_bf16 v[92:95], v[192:195], v[180:183], v[92:95]
    v_mfma_f32_16x16x32_bf16 v[72:75], v[192:195], v[176:179], v[72:75]
    s_waitcnt lgkmcnt(1)
    v_mfma_f32_16x16x32_bf16 v[96:99], v[196:199], v[180:183], v[96:99]
    v_mfma_f32_16x16x32_bf16 v[76:79], v[196:199], v[176:179], v[76:79]
    s_waitcnt lgkmcnt(0)
    v_mfma_f32_16x16x32_bf16 v[100:103], v[200:203], v[180:183], v[100:103]
    v_mfma_f32_16x16x32_bf16 v[80:83], v[200:203], v[176:179], v[80:83]
    s_nop 5
    ds_write_b128 v218, v[84:87] offset:0
    ds_write_b128 v218, v[88:91] offset:1024
    ds_write_b128 v218, v[92:95] offset:2048
    ds_write_b128 v218, v[96:99] offset:3072
    ds_write_b128 v218, v[100:103] offset:4096
    s_mov_b32 s59, 0x200000
L_xs_64:
    ds_read_b128 v[200:203], v219 offset:4096
    s_sub_u32 s59, s59, 1
    s_cbranch_scc1 L_xd_65
    s_waitcnt lgkmcnt(0)
    v_cmp_eq_u32 vcc, -1, v203
    s_cbranch_vccnz L_xs_64
L_xd_65:
    ds_read_b128 v[184:187], v219 offset:0
    ds_read_b128 v[188:191], v219 offset:1024
    ds_read_b128 v[192:195], v219 offset:2048
    ds_read_b128 v[196:199], v219 offset:3072
    s_waitcnt lgkmcnt(4)
    v_pk_add_f32 v[80:81], v[80:81], v[200:201]
    v_pk_add_f32 v[82:83], v[82:83], v[202:203]
    s_waitcnt lgkmcnt(3)
    v_pk_add_f32 v[64:65], v[64:65], v[184:185]
    v_pk_add_f32 v[66:67], v[66:67], v[186:187]
    s_waitcnt lgkmcnt(2)
    v_pk_add_f32 v[68:69], v[68:69], v[188:189]
    v_pk_add_f32 v[70:71], v[70:71], v[190:191]
    s_waitcnt lgkmcnt(1)
    v_pk_add_f32 v[72:73], v[72:73], v[192:193]
    v_pk_add_f32 v[74:75], v[74:75], v[194:195]
    s_waitcnt lgkmcnt(0)
    v_pk_add_f32 v[76:77], v[76:77], v[196:197]
    v_pk_add_f32 v[78:79], v[78:79], v[198:199]
    v_and_b32 v0, 15, v234
    v_lshrrev_b32 v1, 4, v234
    v_lshlrev_b32 v0, 3, v0
    v_lshl_add_u32 v0, v1, 7, v0
    s_lshl2_add_u32 s66, s51, s47
    s_mul_i32 s64, s66, 20480
    s_mul_i32 s65, s52, 2560
    s_add_u32 s64, s64, s65
    s_add_u32 s64, s64, 12582912
    v_cvt_pk_bf16_f32 v246, v64, v65
    v_cvt_pk_bf16_f32 v247, v66, v67
    buffer_store_dwordx2 v[246:247], v0, s[32:35], s64 offen offset:0 sc1
    v_cvt_pk_bf16_f32 v248, v68, v69
    v_cvt_pk_bf16_f32 v249, v70, v71
    buffer_store_dwordx2 v[248:249], v0, s[32:35], s64 offen offset:512 sc1
    v_cvt_pk_bf16_f32 v250, v72, v73
    v_cvt_pk_bf16_f32 v251, v74, v75
    buffer_store_dwordx2 v[250:251], v0, s[32:35], s64 offen offset:1024 sc1
    v_cvt_pk_bf16_f32 v252, v76, v77
    v_cvt_pk_bf16_f32 v253, v78, v79
    buffer_store_dwordx2 v[252:253], v0, s[32:35], s64 offen offset:1536 sc1
    v_cvt_pk_bf16_f32 v254, v80, v81
    v_cvt_pk_bf16_f32 v255, v82, v83
    buffer_store_dwordx2 v[254:255], v0, s[32:35], s64 offen offset:2048 sc1
    v_pk_add_f32 v[2:3], v[64:65], v[66:67]
    v_pk_mul_f32 v[4:5], v[64:65], v[64:65]
    v_pk_fma_f32 v[4:5], v[66:67], v[66:67], v[4:5]
    v_pk_add_f32 v[2:3], v[2:3], v[68:69]
    v_pk_fma_f32 v[4:5], v[68:69], v[68:69], v[4:5]
    v_pk_add_f32 v[2:3], v[2:3], v[70:71]
    v_pk_fma_f32 v[4:5], v[70:71], v[70:71], v[4:5]
    v_pk_add_f32 v[2:3], v[2:3], v[72:73]
    v_pk_fma_f32 v[4:5], v[72:73], v[72:73], v[4:5]
    v_pk_add_f32 v[2:3], v[2:3], v[74:75]
    v_pk_fma_f32 v[4:5], v[74:75], v[74:75], v[4:5]
    v_pk_add_f32 v[2:3], v[2:3], v[76:77]
    v_pk_fma_f32 v[4:5], v[76:77], v[76:77], v[4:5]
    v_pk_add_f32 v[2:3], v[2:3], v[78:79]
    v_pk_fma_f32 v[4:5], v[78:79], v[78:79], v[4:5]
    v_pk_add_f32 v[2:3], v[2:3], v[80:81]
    v_pk_fma_f32 v[4:5], v[80:81], v[80:81], v[4:5]
    v_pk_add_f32 v[2:3], v[2:3], v[82:83]
    v_pk_fma_f32 v[4:5], v[82:83], v[82:83], v[4:5]
    v_add_f32 v2, v2, v3
    v_add_f32 v3, v4, v5
    v_mov_b32 v4, v2
    v_mov_b32 v5, v3
    s_lshl_b32 s64, s66, 7
    v_permlane32_swap_b32 v2, v4
    v_permlane32_swap_b32 v3, v5
    v_add_f32 v2, v2, v4
    v_add_f32 v3, v3, v5
    v_mov_b32 v4, v2
    v_mov_b32 v5, v3
    s_lshl_b32 s65, s52, 14
    v_permlane16_swap_b32 v2, v4
    v_permlane16_swap_b32 v3, v5
    v_add_f32 v2, v2, v4
    v_add_f32 v3, v3, v5
    s_add_u32 s64, s64, s65
    s_add_u32 s64, s64, 1572864
    s_mov_b64 exec, 0xffff
    buffer_store_dwordx2 v[2:3], v0, s[32:35], s64 offen sc1
    s_mov_b64 exec, -1
    s_branch L_TA
L_T2_C:
    v_lshlrev_b32 v4, 4, v234
    s_mul_i32 s64, s63, 20
    s_add_u32 s65, s64, 19
    s_lshr_b32 s64, s64, 5
    s_lshr_b32 s65, s65, 5
    s_sub_u32 s65, s65, s64
    s_lshl_b32 s66, s62, 2
    s_sub_u32 s66, s66, 4
    v_and_b32 v0, 1, v234
    s_lshl1_add_u32 s67, s47, s66
    v_add_u32 v0, s67, v0
    s_add_u32 s67, s66, s55
    s_add_u32 s67, s67, 4
    v_mov_b32 v1, s67
    s_mov_b32 vcc_lo, 0xcccccccc
    s_mov_b32 vcc_hi, 0xcccccccc
    v_cndmask_b32 v0, v0, v1, vcc
    v_max_i32 v0, 0, v0
    v_lshlrev_b32 v0, 5, v0
    v_bfe_u32 v1, v234, 2, 1
    v_mul_u32_u24 v1, s65, v1
    v_add3_u32 v0, v0, v1, s64
    v_lshlrev_b32 v0, 7, v0
    v_add_u32 v0, 69632, v0
    s_waitcnt vmcnt(0)
    v_mov_b32 v2, s44
    v_mov_b32 v3, s45
    s_mov_b64 exec, 0xffff
    buffer_store_dwordx2 v[2:3], v233, s[32:35], s93 offen sc1
    s_mov_b64 exec, -1
    s_setprio 0
    s_cmp_eq_u32 s60, 0
    s_cbranch_scc1 L_nb_66
    s_barrier
    s_cmp_eq_u32 s93, 67108864
    s_cbranch_scc1 L_nb2_67
    s_mul_i32 s64, s48, 20
    s_lshl3_add_u32 s64, s49, s64
    s_add_u32 s64, s64, s50
    s_sub_u32 s64, s64, 20
    s_lshl2_add_u32 s64, s64, s47
    s_mul_i32 s64, s64, 2112
    s_add_u32 s64, s64, 1536000
    s_load_dword s10, s[18:19], s64
    s_add_u32 s64, s64, 64
    s_load_dword s10, s[18:19], s64
    s_add_u32 s64, s64, 64
    s_load_dword s10, s[18:19], s64
    s_add_u32 s64, s64, 64
    s_load_dword s10, s[18:19], s64
    s_add_u32 s64, s64, 64
    s_load_dword s10, s[18:19], s64
    s_add_u32 s64, s64, 64
    s_load_dword s10, s[18:19], s64
    s_add_u32 s64, s64, 64
    s_load_dword s10, s[18:19], s64
    s_add_u32 s64, s64, 64
    s_load_dword s10, s[18:19], s64
    s_add_u32 s64, s64, 64
    s_load_dword s10, s[18:19], s64
    s_add_u32 s64, s64, 64
    s_load_dword s10, s[18:19], s64
    s_add_u32 s64, s64, 64
    s_load_dword s10, s[18:19], s64
    s_add_u32 s64, s64, 64
    s_load_dword s10, s[18:19], s64
    s_add_u32 s64, s64, 64
    s_load_dword s10, s[18:19], s64
    s_add_u32 s64, s64, 64
    s_load_dword s10, s[18:19], s64
    s_add_u32 s64, s64, 64
    s_load_dword s10, s[18:19], s64
    s_add_u32 s64, s64, 64
    s_load_dword s10, s[18:19], s64
    s_add_u32 s64, s64, 64
    s_load_dword s10, s[18:19], s64
    s_add_u32 s64, s64, 64
    s_load_dword s10, s[18:19], s64
    s_add_u32 s64, s64, 64
    s_load_dword s10, s[18:19], s64
    s_add_u32 s64, s64, 64
    s_load_dword s10, s[18:19], s64
    s_add_u32 s64, s64, 64
    s_load_dword s10, s[18:19], s64
    s_add_u32 s64, s64, 64
    s_load_dword s10, s[18:19], s64
    s_add_u32 s64, s64, 64
    s_load_dword s10, s[18:19], s64
    s_add_u32 s64, s64, 64
    s_load_dword s10, s[18:19], s64
    s_add_u32 s64, s64, 64
    s_load_dword s10, s[18:19], s64
    s_add_u32 s64, s64, 64
    s_load_dword s10, s[18:19], s64
    s_add_u32 s64, s64, 64
    s_load_dword s10, s[18:19], s64
    s_add_u32 s64, s64, 64
    s_load_dword s10, s[18:19], s64
    s_add_u32 s64, s64, 64
    s_load_dword s10, s[18:19], s64
    s_add_u32 s64, s64, 64
    s_load_dword s10, s[18:19], s64
    s_add_u32 s64, s64, 64
    s_load_dword s10, s[18:19], s64
    s_add_u32 s64, s64, 64
    s_load_dword s10, s[18:19], s64
    s_add_u32 s64, s64, 64
    s_load_dword s10, s[18:19], s64
    s_add_u32 s64, s64, 64
    s_branch L_nb2_67
L_nb_66:
    s_lshl2_add_u32 s64, s2, s47
    s_mul_i32 s64, s64, 960
    s_add_u32 s64, s64, 921600
    s_load_dword s10, s[18:19], s64
    s_add_u32 s64, s64, 64
    s_load_dword s10, s[18:19], s64
    s_add_u32 s64, s64, 64
    s_load_dword s10, s[18:19], s64
    s_add_u32 s64, s64, 64
    s_load_dword s10, s[18:19], s64
    s_add_u32 s64, s64, 64
    s_load_dword s10, s[18:19], s64
    s_add_u32 s64, s64, 64
    s_load_dword s10, s[18:19], s64
    s_add_u32 s64, s64, 64
    s_load_dword s10, s[18:19], s64
    s_add_u32 s64, s64, 64
    s_load_dword s10, s[18:19], s64
    s_add_u32 s64, s64, 64
    s_load_dword s10, s[18:19], s64
    s_add_u32 s64, s64, 64
    s_load_dword s10, s[18:19], s64
    s_add_u32 s64, s64, 64
    s_load_dword s10, s[18:19], s64
    s_add_u32 s64, s64, 64
    s_load_dword s10, s[18:19], s64
    s_add_u32 s64, s64, 64
    s_load_dword s10, s[18:19], s64
    s_add_u32 s64, s64, 64
    s_load_dword s10, s[18:19], s64
    s_add_u32 s64, s64, 64
    s_load_dword s10, s[18:19], s64
    s_add_u32 s64, s64, 64
L_nb2_67:
    v_add_u32 v5, 0, v234
    v_mul_u32_u24 v6, 3277, v5
    v_lshrrev_b32 v6, 16, v6
    v_mul_u32_u24 v7, 20, v6
    v_sub_u32 v7, v5, v7
    v_mul_u32_u24 v6, 10240, v6
    v_lshl_add_u32 v8, v7, 4, v6
    v_add_u32 v5, 64, v234
    v_mul_u32_u24 v6, 3277, v5
    v_lshrrev_b32 v6, 16, v6
    v_mul_u32_u24 v7, 20, v6
    v_sub_u32 v7, v5, v7
    v_mul_u32_u24 v6, 10240, v6
    v_lshl_add_u32 v9, v7, 4, v6
    v_subrev_u32 v9, 1024, v9
    v_add_u32 v5, 128, v234
    v_mul_u32_u24 v6, 3277, v5
    v_lshrrev_b32 v6, 16, v6
    v_mul_u32_u24 v7, 20, v6
    v_sub_u32 v7, v5, v7
    v_mul_u32_u24 v6, 10240, v6
    v_lshl_add_u32 v10, v7, 4, v6
    v_subrev_u32 v10, 2048, v10
    v_add_u32 v5, 192, v234
    v_mul_u32_u24 v6, 3277, v5
    v_lshrrev_b32 v6, 16, v6
    v_mul_u32_u24 v7, 20, v6
    v_sub_u32 v7, v5, v7
    v_mul_u32_u24 v6, 10240, v6
    v_lshl_add_u32 v11, v7, 4, v6
    v_subrev_u32 v11, 3072, v11
    v_add_u32 v5, 256, v234
    v_mul_u32_u24 v6, 3277, v5
    v_lshrrev_b32 v6, 16, v6
    v_mul_u32_u24 v7, 20, v6
    v_sub_u32 v7, v5, v7
    v_mul_u32_u24 v6, 10240, v6
    v_lshl_add_u32 v12, v7, 4, v6
    s_lshr_b32 s64, s50, 2
    s_mul_i32 s54, s49, 7
    s_add_u32 s54, s54, s64
    s_mov_b32 s36, s16
    s_mov_b32 s37, s17
    s_mov_b32 s38, 2211840
    s_mov_b32 s39, 0x20000
    s_cmp_eq_u32 s61, 0
    s_cmov_b32 s38, 0
    v_lshrrev_b32 v1, 3, v234
    s_lshl_b32 s64, s47, 4
    v_add_u32 v1, s64, v1
    v_mul_u32_u24 v1, 3456, v1
    v_and_b32 v2, 7, v234
    v_bfe_u32 v3, v234, 4, 1
    v_lshlrev_b32 v3, 2, v3
    v_xor_b32 v2, v2, v3
    v_lshrrev_b32 v3, 5, v234
    v_lshlrev_b32 v3, 1, v3
    v_xor_b32 v2, v2, v3
    v_xor_b32 v3, 2, v2
    v_lshl_add_u32 v230, v2, 4, v1
    v_lshl_add_u32 v231, v3, 4, v1
    v_add_u32 v231, 26624, v231
    s_lshl_b32 s71, s54, 8
    s_lshl_b32 s73, s47, 11
    s_add_u32 s73, s73, 40960
    s_mov_b32 s75, 1
    v_lshlrev_b32 v226, 4, v234
    v_add_u32 v227, 18432, v226
    s_lshl2_add_u32 s64, s53, s47
    s_mul_i32 s70, s64, 40960
    s_add_u32 s70, s70, 12582912
    s_lshl_b32 s72, s47, 12
    s_add_u32 s72, s72, 131072
    s_mov_b32 s74, 1
    s_lshl2_add_u32 s64, s53, s47
    s_lshl_b32 s64, s64, 11
    s_add_u32 s64, s64, 200704
    v_and_b32 v232, 15, v234
    v_lshl_add_u32 v232, v232, 7, s64
    s_cmp_lt_u32 s46, 4
    s_cselect_b32 s64, 442368, 0
    s_add_u32 s71, s71, s64
    s_cmp_lt_u32 s46, 4
    s_cselect_b32 s64, 32768, 0
    s_add_u32 s73, s73, s64
    v_and_b32 v30, 31, v234
    v_lshrrev_b32 v31, 5, v234
    s_lshl_b32 s64, s46, 8
    v_lshl_add_u32 v25, v30, 3, s64
    v_lshl_add_u32 v24, v31, 13, v25
    v_lshl_add_u32 v27, v31, 15, v25
    s_mul_i32 s65, s46, 1280
    s_add_u32 s65, s65, 20480
    v_lshl_add_u32 v26, v30, 4, s65
    v_mul_u32_u24 v31, 320, v31
    v_add_u32 v26, v26, v31
    v_mov_b32 v30, 0xf149f2ca
    v_mov_b32 v20, 0
    v_mov_b32 v21, 0
    v_mov_b32 v22, 0
    v_mov_b32 v23, 0
    s_mov_b32 exec_hi, 0
    v_mov_b32 v22, 0x3f80
    s_mov_b32 exec_hi, -1
    s_sub_u32 s96, 8, s46
    s_cmp_eq_u32 s62, 0
    s_cselect_b32 s96, s96, 0
    s_mul_i32 s97, s63, 81920
    s_lshl_b32 s65, s62, 11
    s_add_u32 s97, s97, s65
    v_and_b32 v210, 15, v234
    v_bfe_u32 v211, v234, 4, 1
    v_mul_u32_u24 v211, 20480, v211
    v_lshrrev_b32 v209, 5, v234
    v_lshl_add_u32 v208, v209, 26, v211
    v_lshl_add_u32 v208, v210, 3, v208
    v_lshl_add_u32 v211, v209, 8, v211
    v_lshl_add_u32 v210, v210, 4, v211
    s_lshl3_add_u32 s64, s62, s46
    s_mul_i32 s64, s64, 40960
    s_lshr_b32 s65, s63, 3
    s_mul_i32 s65, s65, 5120
    s_add_u32 s64, s64, s65
    s_add_u32 s64, s64, 15204352
    s_and_b32 s65, s63, 7
    s_lshl_b32 s66, s65, 7
    s_lshl_b32 s65, s65, 9
    s_add_u32 s87, s65, s64
    s_add_u32 s66, s64, s66
    s_add_u32 s86, s66, 4096
    s_mov_b32 vcc_lo, 0x0
    s_mov_b32 vcc_hi, 0xf
    v_cndmask_b32 v48, 0, v30, vcc
    v_cndmask_b32_e64 v32, v30, 0, vcc
    s_mov_b32 vcc_lo, 0x1
    s_mov_b32 vcc_hi, 0x1f
    v_cndmask_b32 v49, 0, v30, vcc
    v_cndmask_b32_e64 v33, v30, 0, vcc
    s_mov_b32 vcc_lo, 0x3
    s_mov_b32 vcc_hi, 0x3f
    v_cndmask_b32 v50, 0, v30, vcc
    v_cndmask_b32_e64 v34, v30, 0, vcc
    s_mov_b32 vcc_lo, 0x7
    s_mov_b32 vcc_hi, 0x7f
    v_cndmask_b32 v51, 0, v30, vcc
    v_cndmask_b32_e64 v35, v30, 0, vcc
    s_mov_b32 vcc_lo, 0xff
    s_mov_b32 vcc_hi, 0xfff
    v_cndmask_b32 v52, 0, v30, vcc
    v_cndmask_b32_e64 v36, v30, 0, vcc
    s_mov_b32 vcc_lo, 0x1ff
    s_mov_b32 vcc_hi, 0x1fff
    v_cndmask_b32 v53, 0, v30, vcc
    v_cndmask_b32_e64 v37, v30, 0, vcc
    s_mov_b32 vcc_lo, 0x3ff
    s_mov_b32 vcc_hi, 0x3fff
    v_cndmask_b32 v54, 0, v30, vcc
    v_cndmask_b32_e64 v38, v30, 0, vcc
    s_mov_b32 vcc_lo, 0x7ff
    s_mov_b32 vcc_hi, 0x7fff
    v_cndmask_b32 v55, 0, v30, vcc
    v_cndmask_b32_e64 v39, v30, 0, vcc
    s_mov_b32 vcc_lo, 0xffff
    s_mov_b32 vcc_hi, 0xfffff
    v_cndmask_b32 v56, 0, v30, vcc
    v_cndmask_b32_e64 v40, v30, 0, vcc
    s_mov_b32 vcc_lo, 0x1ffff
    s_mov_b32 vcc_hi, 0x1fffff
    v_cndmask_b32 v57, 0, v30, vcc
    v_cndmask_b32_e64 v41, v30, 0, vcc
    s_mov_b32 vcc_lo, 0x3ffff
    s_mov_b32 vcc_hi, 0x3fffff
    v_cndmask_b32 v58, 0, v30, vcc
    v_cndmask_b32_e64 v42, v30, 0, vcc
    s_mov_b32 vcc_lo, 0x7ffff
    s_mov_b32 vcc_hi, 0x7fffff
    v_cndmask_b32 v59, 0, v30, vcc
    v_cndmask_b32_e64 v43, v30, 0, vcc
    s_mov_b32 vcc_lo, 0xffffff
    s_mov_b32 vcc_hi, 0xfffffff
    v_cndmask_b32 v60, 0, v30, vcc
    v_cndmask_b32_e64 v44, v30, 0, vcc
    s_mov_b32 vcc_lo, 0x1ffffff
    s_mov_b32 vcc_hi, 0x1fffffff
    v_cndmask_b32 v61, 0, v30, vcc
    v_cndmask_b32_e64 v45, v30, 0, vcc
    s_mov_b32 vcc_lo, 0x3ffffff
    s_mov_b32 vcc_hi, 0x3fffffff
    v_cndmask_b32 v62, 0, v30, vcc
    v_cndmask_b32_e64 v46, v30, 0, vcc
    s_mov_b32 vcc_lo, 0x7ffffff
    s_mov_b32 vcc_hi, 0x7fffffff
    v_cndmask_b32 v63, 0, v30, vcc
    v_cndmask_b32_e64 v47, v30, 0, vcc
    v_and_b32 v5, 15, v234
    v_lshlrev_b32 v6, 7, v5
    v_add_u32 v6, 727040, v6
    v_bfe_u32 v7, v234, 4, 1
    v_lshl_add_u32 v5, v7, 4, v5
    v_lshlrev_b32 v5, 2, v5
    v_lshrrev_b32 v7, 5, v234
    v_mul_u32_u24 v7, 2560, v7
    v_add_u32 v5, v5, v7
    s_lshl_b32 s64, s54, 1
    s_min_u32 s64, s64, 26
    s_mul_i32 s64, s64, 2560
    s_lshl_b32 s65, s56, 7
    s_add_u32 s64, s64, s65
    s_add_u32 s64, s64, 1478656
    s_mov_b32 s95, s64
    v_mov_b32 v248, v5
    v_cmp_gt_u32 vcc, 16, v234
    s_nop 1
    v_cndmask_b32 v0, v6, v0, vcc
    v_and_b32 v164, 15, v234
    v_lshrrev_b32 v165, 4, v234
    s_lshl_b32 s64, s55, 13
    s_add_u32 s64, s64, 131072
    v_lshl_add_u32 v160, v164, 3, s64
    v_lshl_add_u32 v160, v165, 7, v160
    v_bfe_u32 v166, v234, 2, 2
    v_lshl_add_u32 v162, v165, 2, v166
    v_lshrrev_b32 v163, 1, v165
    v_xor_b32 v163, v163, v165
    v_and_b32 v163, 1, v163
    v_lshlrev_b32 v162, 7, v162
    v_lshl_add_u32 v162, v163, 5, v162
    v_lshrrev_b32 v166, 1, v166
    v_xor_b32 v166, s56, v166
    v_lshl_add_u32 v162, v166, 6, v162
    v_and_b32 v166, 3, v234
    v_lshl_add_u32 v162, v166, 3, v162
    v_xor_b32 v163, 32, v162
    v_add_u32 v162, 40960, v162
    v_add_u32 v163, 40960, v163
    s_lshl_b32 s64, s55, 8
    s_add_u32 s64, s64, 108544
    v_lshl_add_u32 v166, v165, 4, s64
    s_lshl_b32 s64, s56, 8
    s_add_u32 s64, s64, 109056
    v_lshl_add_u32 v165, v164, 3, s64
    s_lshl_b32 s64, s55, 10
    s_add_u32 s64, s64, 106496
    v_lshl_add_u32 v164, v164, 4, s64
    v_mov_b32 v66, 0
    v_mov_b32 v67, 0
    v_mov_b32 v70, 0
    v_mov_b32 v71, 0
    v_mov_b32 v74, 0
    v_mov_b32 v75, 0
    v_mov_b32 v78, 0
    v_mov_b32 v79, 0
    v_mov_b32 v82, 0
    v_mov_b32 v83, 0
    v_mov_b32 v86, 0
    v_mov_b32 v87, 0
    v_mov_b32 v90, 0
    v_mov_b32 v91, 0
    v_mov_b32 v94, 0
    v_mov_b32 v95, 0
    s_mov_b32 s59, 0x40000
L_poll_68:
    buffer_load_dwordx2 v[2:3], v0, s[32:35], 0 offen sc1
    s_waitcnt vmcnt(0)
    v_cmp_ne_u64 vcc, s[44:45], v[2:3]
    s_cbranch_vccz L_pdone_69
    s_sleep 4
    s_sub_u32 s59, s59, 1
    s_cbranch_scc0 L_poll_68
    s_or_b32 s58, s58, 4
L_pdone_69:
    s_lshl_b32 s66, s47, 10
    s_add_u32 s67, s97, s66
    s_add_u32 s67, s67, 7337984
    s_lshl1_add_u32 s68, s62, s55
    s_cmp_eq_u32 s68, 0
    s_cmov_b32 s67, 67108864
    s_add_u32 m0, s66, 0
    s_add_u32 s65, s67, 0
    buffer_load_dwordx4 v4, s[32:35], s65 offen sc1 lds
    s_add_u32 m0, s66, 4096
    s_add_u32 s65, s67, 16384
    buffer_load_dwordx4 v4, s[32:35], s65 offen sc1 lds
    s_add_u32 m0, s66, 8192
    s_add_u32 s65, s67, 32768
    buffer_load_dwordx4 v4, s[32:35], s65 offen sc1 lds
    s_add_u32 m0, s66, 12288
    s_add_u32 s65, s67, 49152
    buffer_load_dwordx4 v4, s[32:35], s65 offen sc1 lds
    s_add_u32 m0, s66, 16384
    s_add_u32 s65, s67, 65536
    buffer_load_dwordx4 v4, s[32:35], s65 offen sc1 lds
    s_lshl_b32 s64, s62, 1
    s_sub_u32 s64, s64, 2
    s_add_u32 s64, s64, s47
    s_mul_i32 s64, s64, 163840
    s_mul_i32 s65, s63, 320
    s_add_u32 s64, s64, s65
    s_add_u32 s64, s64, 9961472
    s_cmp_eq_u32 s68, 0
    s_cmov_b32 s64, 67108864
    s_mul_i32 s65, s47, 5120
    s_add_u32 s65, s65, 20480
    s_mov_b32 m0, s65
    s_nop 0
    buffer_load_dwordx4 v8, s[32:35], s64 offen offset:0 sc1 lds
    buffer_load_dwordx4 v9, s[32:35], s64 offen offset:1024 sc1 lds
    buffer_load_dwordx4 v10, s[32:35], s64 offen offset:2048 sc1 lds
    buffer_load_dwordx4 v11, s[32:35], s64 offen offset:3072 sc1 lds
    s_add_u32 m0, s65, 4096
    s_nop 0
    buffer_load_dwordx4 v12, s[32:35], s64 offen sc1 lds
    s_add_u32 s64, s97, 4718592
    s_add_u32 s65, s97, 4734976
    s_add_u32 s66, s97, 4784128
    buffer_load_dwordx2 v[16:17], v27, s[32:35], s64 offen sc1
    buffer_load_dwordx2 v[18:19], v27, s[32:35], s65 offen sc1
    s_mov_b32 exec_hi, 0
    buffer_load_dwordx2 v[20:21], v25, s[32:35], s66 offen sc1
    s_mov_b32 exec_hi, -1
    s_waitcnt vmcnt(0) lgkmcnt(0)
L_TA:
    v_mov_b32 v192, s98
    v_mov_b32 v193, s98
    v_mov_b32 v194, s98
    v_mov_b32 v195, s98
    v_mov_b32 v196, s98
    v_mov_b32 v197, s98
    v_mov_b32 v198, s98
    v_mov_b32 v199, s98
    v_mov_b32 v200, s98
    v_mov_b32 v201, s98
    v_mov_b32 v202, s98
    v_mov_b32 v203, s98
    v_mov_b32 v204, s98
    v_mov_b32 v205, s98
    v_mov_b32 v206, s98
    v_mov_b32 v207, s98
    v_mov_b32 v183, 0
    v_mov_b32 v191, 0
    s_barrier
    ds_read_b64 v[176:177], v24 offset:0
    ds_read_b64 v[178:179], v24 offset:4096
    ds_read_b64 v[180:181], v25 offset:16384
    s_cmp_lt_u32 s46, 4
    s_cbranch_scc1 L_h1_70
    s_add_u32 s64, s97, 4718592
    s_add_u32 s65, s97, 4734976
    s_add_u32 s66, s97, 4784128
    buffer_load_dwordx2 v[16:17], v27, s[32:35], s64 offen sc1
    buffer_load_dwordx2 v[18:19], v27, s[32:35], s65 offen sc1
    s_mov_b32 exec_hi, 0
    buffer_load_dwordx2 v[20:21], v25, s[32:35], s66 offen sc1
    s_mov_b32 exec_hi, -1
    s_lshl2_add_u32 s64, s51, s47
    s_lshl3_add_u32 s64, s64, s52
    s_lshl_b32 s64, s64, 7
    s_add_u32 s64, s64, 200704
    s_waitcnt vmcnt(3)
    v_mov_b32 v212, s44
    v_mov_b32 v213, s45
    s_mov_b64 exec, 0xffff
    buffer_store_dwordx2 v[212:213], v233, s[32:35], s64 offen sc1
    s_mov_b64 exec, -1
    s_waitcnt vmcnt(1)
    s_branch L_h1b_71
L_h1_70:
    buffer_load_dword v238, v248, s[32:35], s95 offen offset:0 sc1
    buffer_load_dword v239, v248, s[32:35], s95 offen offset:256 sc1
    buffer_load_dword v240, v248, s[32:35], s95 offen offset:512 sc1
    buffer_load_dword v241, v248, s[32:35], s95 offen offset:768 sc1
    buffer_load_dword v242, v248, s[32:35], s95 offen offset:1024 sc1
    buffer_load_dword v243, v248, s[32:35], s95 offen offset:1280 sc1
    buffer_load_dword v244, v248, s[32:35], s95 offen offset:1536 sc1
    buffer_load_dword v245, v248, s[32:35], s95 offen offset:1792 sc1
    buffer_load_dword v246, v248, s[32:35], s95 offen offset:2048 sc1
    buffer_load_dword v247, v248, s[32:35], s95 offen offset:2304 sc1
L_h1b_71:
    s_cmp_gt_u32 s96, 0
    s_cselect_b32 s64, 0xf149, 0
    v_mov_b32 v182, s64
    ds_read_b64 v[184:185], v24 offset:256
    ds_read_b64 v[186:187], v24 offset:4352
    ds_read_b64 v[188:189], v25 offset:16640
    s_cmp_gt_u32 s96, 1
    s_cselect_b32 s64, 0xf149, 0
    v_mov_b32 v190, s64
    s_mov_b32 exec_lo, 0xfffff
    s_mov_b32 exec_hi, 0xfffff
    ds_read_b128 v[192:195], v26 offset:0
    ds_read_b128 v[196:199], v26 offset:640
    s_mov_b64 exec, -1
    s_waitcnt lgkmcnt(5)
    v_mfma_f32_32x32x16_bf16 v[32:47], v[176:179], v[16:19], v[32:47]
    v_mfma_f32_32x32x16_bf16 v[32:47], v[180:183], v[20:23], v[32:47]
    s_waitcnt lgkmcnt(2)
    v_mfma_f32_32x32x16_bf16 v[96:111], v[184:187], v[16:19], 0
    v_mfma_f32_32x32x16_bf16 v[96:111], v[188:191], v[20:23], v[96:111]
    ds_read_b64 v[176:177], v24 offset:512
    ds_read_b64 v[178:179], v24 offset:4608
    ds_read_b64 v[180:181], v25 offset:16896
    s_cmp_gt_u32 s96, 2
    s_cselect_b32 s64, 0xf149, 0
    v_mov_b32 v182, s64
    s_nop 2
    v_exp_f32 v32, v32
    v_exp_f32 v33, v33
    v_exp_f32 v34, v34
    v_exp_f32 v35, v35
    v_exp_f32 v36, v36
    v_exp_f32 v37, v37
    v_exp_f32 v38, v38
    v_exp_f32 v39, v39
    v_exp_f32 v40, v40
    v_exp_f32 v41, v41
    v_exp_f32 v42, v42
    s_mov_b32 exec_lo, 0xfffff
    s_mov_b32 exec_hi, 0xfffff
    ds_read_b128 v[200:203], v26 offset:1280
    ds_read_b128 v[204:207], v26 offset:1920
    s_mov_b64 exec, -1
    v_exp_f32 v43, v43
    v_exp_f32 v44, v44
    v_exp_f32 v45, v45
    v_exp_f32 v46, v46
    v_exp_f32 v47, v47
    s_waitcnt lgkmcnt(2)
    v_mfma_f32_32x32x16_bf16 v[112:127], v[176:179], v[16:19], 0
    v_cvt_pk_bf16_f32 v32, v32, v33
    v_cvt_pk_bf16_f32 v33, v34, v35
    v_cvt_pk_bf16_f32 v34, v36, v37
    v_cvt_pk_bf16_f32 v35, v38, v39
    v_mfma_f32_32x32x16_bf16 v[112:127], v[180:183], v[20:23], v[112:127]
    v_cvt_pk_bf16_f32 v36, v40, v41
    v_cvt_pk_bf16_f32 v37, v42, v43
    v_cvt_pk_bf16_f32 v38, v44, v45
    v_cvt_pk_bf16_f32 v39, v46, v47
    ds_read_b64 v[184:185], v24 offset:768
    ds_read_b64 v[186:187], v24 offset:4864
    ds_read_b64 v[188:189], v25 offset:17152
    s_cmp_gt_u32 s96, 3
    s_cselect_b32 s64, 0xf149, 0
    v_mov_b32 v190, s64
    s_add_u32 m0, s73, 0
    s_add_u32 s64, s71, 0
    buffer_load_dwordx4 v230, s[36:39], s64 offen offset:0 lds
    v_exp_f32 v96, v96
    v_exp_f32 v97, v97
    v_exp_f32 v98, v98
    v_exp_f32 v99, v99
    v_exp_f32 v100, v100
    v_exp_f32 v101, v101
    v_mfma_f32_32x32x16_bf16 v[0:15], v[192:195], v[32:35], 0
    v_exp_f32 v102, v102
    v_exp_f32 v103, v103
    v_exp_f32 v104, v104
    v_exp_f32 v105, v105
    v_exp_f32 v106, v106
    v_mfma_f32_32x32x16_bf16 v[0:15], v[196:199], v[36:39], v[0:15]
    s_mov_b32 exec_lo, 0xfffff
    s_mov_b32 exec_hi, 0xfffff
    ds_read_b128 v[192:195], v26 offset:2560
    ds_read_b128 v[196:199], v26 offset:3200
    s_mov_b64 exec, -1
    v_exp_f32 v107, v107
    v_exp_f32 v108, v108
    v_exp_f32 v109, v109
    v_exp_f32 v110, v110
    v_exp_f32 v111, v111
    s_waitcnt lgkmcnt(2)
    v_mfma_f32_32x32x16_bf16 v[128:143], v[184:187], v[16:19], 0
    v_cvt_pk_bf16_f32 v96, v96, v97
    v_cvt_pk_bf16_f32 v97, v98, v99
    v_cvt_pk_bf16_f32 v98, v100, v101
    v_cvt_pk_bf16_f32 v99, v102, v103
    v_mfma_f32_32x32x16_bf16 v[128:143], v[188:191], v[20:23], v[128:143]
    v_cvt_pk_bf16_f32 v100, v104, v105
    v_cvt_pk_bf16_f32 v101, v106, v107
    v_cvt_pk_bf16_f32 v102, v108, v109
    v_cvt_pk_bf16_f32 v103, v110, v111
    ds_read_b64 v[176:177], v24 offset:1024
    ds_read_b64 v[178:179], v24 offset:5120
    ds_read_b64 v[180:181], v25 offset:17408
    s_cmp_gt_u32 s96, 4
    s_cselect_b32 s64, 0xf149, 0
    v_mov_b32 v182, s64
    s_add_u32 m0, s73, 0
    s_add_u32 s64, s71, 0
    buffer_load_dwordx4 v231, s[36:39], s64 offen offset:1024 lds
    v_exp_f32 v112, v112
    v_exp_f32 v113, v113
    v_exp_f32 v114, v114
    v_exp_f32 v115, v115
    v_exp_f32 v116, v116
    v_exp_f32 v117, v117
    v_mfma_f32_32x32x16_bf16 v[0:15], v[200:203], v[96:99], v[0:15]
    v_exp_f32 v118, v118
    v_exp_f32 v119, v119
    v_exp_f32 v120, v120
    v_exp_f32 v121, v121
    v_exp_f32 v122, v122
    v_mfma_f32_32x32x16_bf16 v[0:15], v[204:207], v[100:103], v[0:15]
    s_mov_b32 exec_lo, 0xfffff
    s_mov_b32 exec_hi, 0xfffff
    ds_read_b128 v[200:203], v26 offset:3840
    ds_read_b128 v[204:207], v26 offset:4480
    s_mov_b64 exec, -1
    v_exp_f32 v123, v123
    v_exp_f32 v124, v124
    v_exp_f32 v125, v125
    v_exp_f32 v126, v126
    v_exp_f32 v127, v127
    s_waitcnt lgkmcnt(2)
    v_mfma_f32_32x32x16_bf16 v[144:159], v[176:179], v[16:19], 0
    v_cvt_pk_bf16_f32 v112, v112, v113
    v_cvt_pk_bf16_f32 v113, v114, v115
    v_cvt_pk_bf16_f32 v114, v116, v117
    v_cvt_pk_bf16_f32 v115, v118, v119
    v_mfma_f32_32x32x16_bf16 v[144:159], v[180:183], v[20:23], v[144:159]
    v_cvt_pk_bf16_f32 v116, v120, v121
    v_cvt_pk_bf16_f32 v117, v122, v123
    v_cvt_pk_bf16_f32 v118, v124, v125
    v_cvt_pk_bf16_f32 v119, v126, v127
    ds_read_b64 v[184:185], v24 offset:1280
    ds_read_b64 v[186:187], v24 offset:5376
    ds_read_b64 v[188:189], v25 offset:17664
    s_cmp_gt_u32 s96, 5
    s_cselect_b32 s64, 0xf149, 0
    v_mov_b32 v190, s64
    s_add_u32 m0, s73, 8192
    s_add_u32 s64, s71, 128
    buffer_load_dwordx4 v230, s[36:39], s64 offen offset:0 lds
    v_exp_f32 v128, v128
    v_exp_f32 v129, v129
    v_exp_f32 v130, v130
    v_exp_f32 v131, v131
    v_exp_f32 v132, v132
    v_exp_f32 v133, v133
    v_mfma_f32_32x32x16_bf16 v[0:15], v[192:195], v[112:115], v[0:15]
    v_exp_f32 v134, v134
    v_exp_f32 v135, v135
    v_exp_f32 v136, v136
    v_exp_f32 v137, v137
    v_exp_f32 v138, v138
    v_mfma_f32_32x32x16_bf16 v[0:15], v[196:199], v[116:119], v[0:15]
    s_mov_b32 exec_lo, 0xfffff
    s_mov_b32 exec_hi, 0xfffff
    ds_read_b128 v[192:195], v26 offset:5120
    ds_read_b128 v[196:199], v26 offset:5760
    s_mov_b64 exec, -1
    v_exp_f32 v139, v139
    v_exp_f32 v140, v140
    v_exp_f32 v141, v141
    v_exp_f32 v142, v142
    v_exp_f32 v143, v143
    s_waitcnt lgkmcnt(2)
    v_mfma_f32_32x32x16_bf16 v[96:111], v[184:187], v[16:19], 0
    v_cvt_pk_bf16_f32 v128, v128, v129
    v_cvt_pk_bf16_f32 v129, v130, v131
    v_cvt_pk_bf16_f32 v130, v132, v133
    v_cvt_pk_bf16_f32 v131, v134, v135
    v_mfma_f32_32x32x16_bf16 v[96:111], v[188:191], v[20:23], v[96:111]
    v_cvt_pk_bf16_f32 v132, v136, v137
    v_cvt_pk_bf16_f32 v133, v138, v139
    v_cvt_pk_bf16_f32 v134, v140, v141
    v_cvt_pk_bf16_f32 v135, v142, v143
    ds_read_b64 v[176:177], v24 offset:1536
    ds_read_b64 v[178:179], v24 offset:5632
    ds_read_b64 v[180:181], v25 offset:17920
    s_cmp_gt_u32 s96, 6
    s_cselect_b32 s64, 0xf149, 0
    v_mov_b32 v182, s64
    s_add_u32 m0, s73, 8192
    s_add_u32 s64, s71, 128
    buffer_load_dwordx4 v231, s[36:39], s64 offen offset:1024 lds
    v_exp_f32 v144, v144
    v_exp_f32 v145, v145
    v_exp_f32 v146, v146
    v_exp_f32 v147, v147
    v_exp_f32 v148, v148
    v_exp_f32 v149, v149
    v_mfma_f32_32x32x16_bf16 v[0:15], v[200:203], v[128:131], v[0:15]
    v_exp_f32 v150, v150
    v_exp_f32 v151, v151
    v_exp_f32 v152, v152
    v_exp_f32 v153, v153
    v_exp_f32 v154, v154
    v_mfma_f32_32x32x16_bf16 v[0:15], v[204:207], v[132:135], v[0:15]
    s_mov_b32 exec_lo, 0xfffff
    s_mov_b32 exec_hi, 0xfffff
    ds_read_b128 v[200:203], v26 offset:6400
    ds_read_b128 v[204:207], v26 offset:7040
    s_mov_b64 exec, -1
    v_exp_f32 v155, v155
    v_exp_f32 v156, v156
    v_exp_f32 v157, v157
    v_exp_f32 v158, v158
    v_exp_f32 v159, v159
    s_waitcnt lgkmcnt(2)
    v_mfma_f32_32x32x16_bf16 v[112:127], v[176:179], v[16:19], 0
    v_cvt_pk_bf16_f32 v144, v144, v145
    v_cvt_pk_bf16_f32 v145, v146, v147
    v_cvt_pk_bf16_f32 v146, v148, v149
    v_cvt_pk_bf16_f32 v147, v150, v151
    v_mfma_f32_32x32x16_bf16 v[112:127], v[180:183], v[20:23], v[112:127]
    v_cvt_pk_bf16_f32 v148, v152, v153
    v_cvt_pk_bf16_f32 v149, v154, v155
    v_cvt_pk_bf16_f32 v150, v156, v157
    v_cvt_pk_bf16_f32 v151, v158, v159
    ds_read_b64 v[184:185], v24 offset:1792
    ds_read_b64 v[186:187], v24 offset:5888
    ds_read_b64 v[188:189], v25 offset:18176
    s_cmp_gt_u32 s96, 7
    s_cselect_b32 s64, 0xf149, 0
    v_mov_b32 v190, s64
    s_add_u32 m0, s73, 16384
    s_add_u32 s64, s71, 221184
    buffer_load_dwordx4 v230, s[36:39], s64 offen offset:0 lds
    s_cmp_lt_u32 s46, 4
    s_cbranch_scc1 L_h2_72
    s_cmp_eq_u32 s61, 0
    s_cbranch_scc1 L_h2_72
    buffer_load_dwordx2 v[214:215], v232, s[32:35], 0 offen sc1
L_h2_72:
    v_exp_f32 v96, v96
    v_exp_f32 v97, v97
    v_exp_f32 v98, v98
    v_exp_f32 v99, v99
    v_exp_f32 v100, v100
    v_exp_f32 v101, v101
    v_mfma_f32_32x32x16_bf16 v[0:15], v[192:195], v[144:147], v[0:15]
    v_exp_f32 v102, v102
    v_exp_f32 v103, v103
    v_exp_f32 v104, v104
    v_exp_f32 v105, v105
    v_exp_f32 v106, v106
    v_mfma_f32_32x32x16_bf16 v[0:15], v[196:199], v[148:151], v[0:15]
    s_mov_b32 exec_lo, 0xfffff
    s_mov_b32 exec_hi, 0xfffff
    ds_read_b128 v[192:195], v26 offset:7680
    ds_read_b128 v[196:199], v26 offset:8320
    s_mov_b64 exec, -1
    v_exp_f32 v107, v107
    v_exp_f32 v108, v108
    v_exp_f32 v109, v109
    v_exp_f32 v110, v110
    v_exp_f32 v111, v111
    s_waitcnt lgkmcnt(2)
    v_mfma_f32_32x32x16_bf16 v[128:143], v[184:187], v[16:19], 0
    v_cvt_pk_bf16_f32 v96, v96, v97
    v_cvt_pk_bf16_f32 v97, v98, v99
    v_cvt_pk_bf16_f32 v98, v100, v101
    v_cvt_pk_bf16_f32 v99, v102, v103
    v_mfma_f32_32x32x16_bf16 v[128:143], v[188:191], v[20:23], v[128:143]
    v_cvt_pk_bf16_f32 v100, v104, v105
    v_cvt_pk_bf16_f32 v101, v106, v107
    v_cvt_pk_bf16_f32 v102, v108, v109
    v_cvt_pk_bf16_f32 v103, v110, v111
    ds_read_b64 v[176:177], v24 offset:2048
    ds_read_b64 v[178:179], v24 offset:6144
    ds_read_b64 v[180:181], v25 offset:18432
    s_cmp_gt_u32 s96, 8
    s_cselect_b32 s64, 0xf149, 0
    v_mov_b32 v182, s64
    s_add_u32 m0, s73, 16384
    s_add_u32 s64, s71, 221184
    buffer_load_dwordx4 v231, s[36:39], s64 offen offset:1024 lds
    v_exp_f32 v112, v112
    v_exp_f32 v113, v113
    v_exp_f32 v114, v114
    v_exp_f32 v115, v115
    v_exp_f32 v116, v116
    v_exp_f32 v117, v117
    v_mfma_f32_32x32x16_bf16 v[0:15], v[200:203], v[96:99], v[0:15]
    v_exp_f32 v118, v118
    v_exp_f32 v119, v119
    v_exp_f32 v120, v120
    v_exp_f32 v121, v121
    v_exp_f32 v122, v122
    v_mfma_f32_32x32x16_bf16 v[0:15], v[204:207], v[100:103], v[0:15]
    s_mov_b32 exec_lo, 0xfffff
    s_mov_b32 exec_hi, 0xfffff
    ds_read_b128 v[200:203], v26 offset:8960
    ds_read_b128 v[204:207], v26 offset:9600
    s_mov_b64 exec, -1
    v_exp_f32 v123, v123
    v_exp_f32 v124, v124
    v_exp_f32 v125, v125
    v_exp_f32 v126, v126
    v_exp_f32 v127, v127
    s_waitcnt lgkmcnt(2)
    v_mfma_f32_32x32x16_bf16 v[48:63], v[176:179], v[16:19], v[48:63]
    v_cvt_pk_bf16_f32 v112, v112, v113
    v_cvt_pk_bf16_f32 v113, v114, v115
    v_cvt_pk_bf16_f32 v114, v116, v117
    v_cvt_pk_bf16_f32 v115, v118, v119
    v_mfma_f32_32x32x16_bf16 v[48:63], v[180:183], v[20:23], v[48:63]
    v_cvt_pk_bf16_f32 v116, v120, v121
    v_cvt_pk_bf16_f32 v117, v122, v123
    v_cvt_pk_bf16_f32 v118, v124, v125
    v_cvt_pk_bf16_f32 v119, v126, v127
    s_add_u32 m0, s73, 24576
    s_add_u32 s64, s71, 221312
    buffer_load_dwordx4 v230, s[36:39], s64 offen offset:0 lds
    s_cmp_lt_u32 s46, 4
    s_cbranch_scc1 L_h2_73
    s_cmp_eq_u32 s61, 0
    s_cbranch_scc1 L_h2_73
    s_waitcnt vmcnt(2)
    v_cmp_ne_u64 vcc, s[44:45], v[214:215]
    s_cbranch_vccz L_h2ok_74
    s_mov_b32 s59, 0x40000
L_poll_75:
    buffer_load_dwordx2 v[214:215], v232, s[32:35], 0 offen sc1
    s_waitcnt vmcnt(0)
    v_cmp_ne_u64 vcc, s[44:45], v[214:215]
    s_cbranch_vccz L_pdone_76
    s_sleep 4
    s_sub_u32 s59, s59, 1
    s_cbranch_scc0 L_poll_75
    s_or_b32 s58, s58, 8
L_pdone_76:
L_h2ok_74:
    s_mov_b32 m0, s72
    s_add_u32 s74, s74, 1
    s_cmp_eq_u32 s74, 3
    s_mov_b32 s64, 16384
    s_cmov_b32 s64, 4294934528
    s_cmov_b32 s74, 0
    buffer_load_dwordx4 v226, s[32:35], s70 offen offset:0 sc1 lds
    buffer_load_dwordx4 v226, s[32:35], s70 offen offset:1024 sc1 lds
    buffer_load_dwordx4 v227, s[32:35], s70 offen offset:2048 sc1 lds
    buffer_load_dwordx4 v227, s[32:35], s70 offen offset:3072 sc1 lds
    s_add_u32 s72, s72, s64
    s_add_u32 s70, s70, 2048
    s_mov_b32 m0, s72
    s_add_u32 s74, s74, 1
    s_cmp_eq_u32 s74, 3
    s_mov_b32 s64, 16384
    s_cmov_b32 s64, 4294934528
    s_cmov_b32 s74, 0
    buffer_load_dwordx4 v226, s[32:35], s70 offen offset:0 sc1 lds
    buffer_load_dwordx4 v226, s[32:35], s70 offen offset:1024 sc1 lds
    buffer_load_dwordx4 v227, s[32:35], s70 offen offset:2048 sc1 lds
    buffer_load_dwordx4 v227, s[32:35], s70 offen offset:3072 sc1 lds
    s_add_u32 s72, s72, s64
    s_add_u32 s70, s70, 2048
    s_lshr_b32 s64, s50, 2
    s_mul_i32 s64, s64, 37
    v_min_u32 v212, 36, v234
    v_add_u32 v212, s64, v212
    v_min_u32 v212, 255, v212
    v_lshrrev_b32 v213, 7, v212
    v_mul_u32_u24 v213, 4096, v213
    v_lshl_add_u32 v212, v212, 7, v213
    buffer_load_dword v213, v212, s[32:35], s70 offen sc1
    s_lshl2_add_u32 s64, s53, s47
    s_lshl_b32 s64, s64, 8
    s_add_u32 s64, s64, 1572864
    v_and_b32 v212, 31, v234
    v_lshrrev_b32 v214, 5, v234
    v_lshlrev_b32 v214, 16, v214
    v_lshl_add_u32 v212, v212, 3, v214
    buffer_load_dwordx2 v[216:217], v212, s[32:35], s64 offen sc1
    s_add_u32 s64, s64, 16384
    buffer_load_dwordx2 v[218:219], v212, s[32:35], s64 offen sc1
    s_add_u32 s64, s64, 16384
    buffer_load_dwordx2 v[220:221], v212, s[32:35], s64 offen sc1
    s_add_u32 s64, s64, 16384
    buffer_load_dwordx2 v[222:223], v212, s[32:35], s64 offen sc1
L_h2_73:
    v_exp_f32 v128, v128
    v_exp_f32 v129, v129
    v_exp_f32 v130, v130
    v_exp_f32 v131, v131
    v_exp_f32 v132, v132
    v_exp_f32 v133, v133
    v_mfma_f32_32x32x16_bf16 v[0:15], v[192:195], v[112:115], v[0:15]
    v_exp_f32 v134, v134
    v_exp_f32 v135, v135
    v_exp_f32 v136, v136
    v_exp_f32 v137, v137
    v_exp_f32 v138, v138
    v_mfma_f32_32x32x16_bf16 v[0:15], v[196:199], v[116:119], v[0:15]
    s_mov_b32 exec_lo, 0xfffff
    s_mov_b32 exec_hi, 0xfffff
    ds_read_b128 v[192:195], v26 offset:10240
    ds_read_b128 v[196:199], v26 offset:10880
    s_mov_b64 exec, -1
    v_exp_f32 v139, v139
    v_exp_f32 v140, v140
    v_exp_f32 v141, v141
    v_exp_f32 v142, v142
    v_exp_f32 v143, v143
    v_cvt_pk_bf16_f32 v128, v128, v129
    v_cvt_pk_bf16_f32 v129, v130, v131
    v_cvt_pk_bf16_f32 v130, v132, v133
    v_cvt_pk_bf16_f32 v131, v134, v135
    v_cvt_pk_bf16_f32 v132, v136, v137
    v_cvt_pk_bf16_f32 v133, v138, v139
    v_cvt_pk_bf16_f32 v134, v140, v141
    v_cvt_pk_bf16_f32 v135, v142, v143
    s_waitcnt lgkmcnt(2)
    s_add_u32 m0, s73, 24576
    s_add_u32 s64, s71, 221312
    buffer_load_dwordx4 v231, s[36:39], s64 offen offset:1024 lds
    v_exp_f32 v48, v48
    v_exp_f32 v49, v49
    v_exp_f32 v50, v50
    v_exp_f32 v51, v51
    v_exp_f32 v52, v52
    v_exp_f32 v53, v53
    v_mfma_f32_32x32x16_bf16 v[0:15], v[200:203], v[128:131], v[0:15]
    v_exp_f32 v54, v54
    v_exp_f32 v55, v55
    v_exp_f32 v56, v56
    v_exp_f32 v57, v57
    v_exp_f32 v58, v58
    v_mfma_f32_32x32x16_bf16 v[0:15], v[204:207], v[132:135], v[0:15]
    v_exp_f32 v59, v59
    v_exp_f32 v60, v60
    v_exp_f32 v61, v61
    v_exp_f32 v62, v62
    v_exp_f32 v63, v63
    v_cvt_pk_bf16_f32 v48, v48, v49
    v_cvt_pk_bf16_f32 v49, v50, v51
    v_cvt_pk_bf16_f32 v50, v52, v53
    v_cvt_pk_bf16_f32 v51, v54, v55
    v_cvt_pk_bf16_f32 v52, v56, v57
    v_cvt_pk_bf16_f32 v53, v58, v59
    v_cvt_pk_bf16_f32 v54, v60, v61
    v_cvt_pk_bf16_f32 v55, v62, v63
    s_waitcnt lgkmcnt(0)
    v_mfma_f32_32x32x16_bf16 v[0:15], v[192:195], v[48:51], v[0:15]
    v_mfma_f32_32x32x16_bf16 v[0:15], v[196:199], v[52:55], v[0:15]
    s_nop 9
    s_mov_b32 s64, 0x26800000
    s_mov_b32 s65, 0x71800000
    v_cmp_nle_f32 vcc, s64, v12
    v_cmp_nge_f32 s[68:69], s65, v12
    s_or_b64 vcc, vcc, s[68:69]
    s_cbranch_scc1 L_TA_EXACT
L_TA_OUT:
    v_rcp_f32 v28, v12
    s_nop 0
    v_pk_mul_f32 v[0:1], v[0:1], v[28:29] op_sel_hi:[1,0]
    v_pk_mul_f32 v[2:3], v[2:3], v[28:29] op_sel_hi:[1,0]
    v_pk_mul_f32 v[4:5], v[4:5], v[28:29] op_sel_hi:[1,0]
    v_pk_mul_f32 v[6:7], v[6:7], v[28:29] op_sel_hi:[1,0]
    v_pk_mul_f32 v[8:9], v[8:9], v[28:29] op_sel_hi:[1,0]
    v_pk_mul_f32 v[10:11], v[10:11], v[28:29] op_sel_hi:[1,0]
    v_cvt_pk_bf16_f32 v16, v0, v1
    v_cvt_pk_bf16_f32 v17, v2, v3
    v_cvt_pk_bf16_f32 v18, v4, v5
    v_cvt_pk_bf16_f32 v19, v6, v7
    v_cvt_pk_bf16_f32 v20, v8, v9
    v_cvt_pk_bf16_f32 v21, v10, v11
    buffer_store_dwordx2 v[20:21], v208, s[32:35], s86 offen sc1
    buffer_store_dwordx4 v[16:19], v210, s[32:35], s87 offen sc1
    s_cmp_ge_u32 s46, 4
    s_cbranch_scc1 L_T3_L
    v_and_b32 v170, 31, v234
    v_lshlrev_b32 v170, 7, v170
    v_add_u32 v170, 729088, v170
    s_cmp_eq_u32 s61, 0
    s_cbranch_scc1 L_no3c_77
    s_cmp_eq_u32 s60, 2
    s_cbranch_scc1 L_T3_REDO
L_T3_GO:
    s_waitcnt vmcnt(10)
    v_add_f32 v238, v238, v239
    v_add_f32 v240, v240, v241
    v_add_f32 v242, v242, v243
    v_add_f32 v244, v244, v245
    v_add_f32 v246, v246, v247
    v_add_f32 v238, v238, v240
    v_add_f32 v242, v242, v244
    v_add_f32 v238, v238, v246
    v_add_f32 v238, v238, v242
    v_cvt_pk_bf16_f32 v237, v238, 0
    v_lshlrev_b32 v239, 16, v237
    v_sub_f32 v239, v238, v239
    v_cvt_pk_bf16_f32 v236, v238, v239
    s_mov_b32 vcc_lo, 0xffff
    s_mov_b32 vcc_hi, 0x0
    v_cndmask_b32 v80, 0, v236, vcc
    v_cndmask_b32 v81, 0, v237, vcc
    s_mov_b32 vcc_lo, 0xffff0000
    s_mov_b32 vcc_hi, 0x0
    v_cndmask_b32 v84, 0, v236, vcc
    v_cndmask_b32 v85, 0, v237, vcc
    s_mov_b32 vcc_lo, 0x0
    s_mov_b32 vcc_hi, 0xffff
    v_cndmask_b32 v88, 0, v236, vcc
    v_cndmask_b32 v89, 0, v237, vcc
    s_mov_b32 vcc_lo, 0x0
    s_mov_b32 vcc_hi, 0xffff0000
    v_cndmask_b32 v92, 0, v236, vcc
    v_cndmask_b32 v93, 0, v237, vcc
    s_mov_b32 s57, 0
    s_mov_b32 s76, 1
    s_mov_b32 s77, 1
    s_setprio 0
    s_barrier
    ds_read_b64 v[96:97], v160 offset:0
    ds_read_b64 v[98:99], v160 offset:512
    ds_read_b64_tr_b16 v[112:113], v162 offset:0
    ds_read_b64_tr_b16 v[114:115], v162 offset:2048
    ds_read_b64 v[100:101], v160 offset:2048
    ds_read_b64 v[102:103], v160 offset:2560
    ds_read_b64 v[104:105], v160 offset:4096
    ds_read_b64 v[106:107], v160 offset:4608
    ds_read_b64 v[108:109], v160 offset:6144
    ds_read_b64 v[110:111], v160 offset:6656
    ds_read_b64_tr_b16 v[116:117], v163 offset:0
    ds_read_b64_tr_b16 v[118:119], v163 offset:2048
    ds_read_b64_tr_b16 v[120:121], v162 offset:8192
    ds_read_b64_tr_b16 v[122:123], v162 offset:10240
    ds_read_b64_tr_b16 v[124:125], v163 offset:8192
    ds_read_b64_tr_b16 v[126:127], v163 offset:10240
    s_waitcnt lgkmcnt(0)
    v_mfma_f32_16x16x32_bf16 v[0:3], v[112:115], v[96:99], 0
    ds_read_b64 v[128:129], v160 offset:1024
    v_mfma_f32_16x16x32_bf16 v[16:19], v[112:115], v[100:103], 0
    ds_read_b64 v[130:131], v160 offset:1536
    v_mfma_f32_16x16x32_bf16 v[32:35], v[112:115], v[104:107], 0
    ds_read_b64_tr_b16 v[144:145], v162 offset:4096
    v_mfma_f32_16x16x32_bf16 v[48:51], v[112:115], v[108:111], 0
    ds_read_b64_tr_b16 v[146:147], v162 offset:6144
    v_mfma_f32_16x16x32_bf16 v[4:7], v[116:119], v[96:99], 0
    ds_read_b64 v[132:133], v160 offset:3072
    v_mfma_f32_16x16x32_bf16 v[20:23], v[116:119], v[100:103], 0
    ds_read_b64 v[134:135], v160 offset:3584
    s_add_u32 s77, s77, 1
    v_mfma_f32_16x16x32_bf16 v[36:39], v[116:119], v[104:107], 0
    ds_read_b64 v[136:137], v160 offset:5120
    s_cmp_eq_u32 s77, 5
    v_mfma_f32_16x16x32_bf16 v[52:55], v[116:119], v[108:111], 0
    ds_read_b64 v[138:139], v160 offset:5632
    s_mov_b32 s79, 16384
    v_mfma_f32_16x16x32_bf16 v[8:11], v[120:123], v[96:99], 0
    ds_read_b64 v[140:141], v160 offset:7168
    s_cmov_b32 s79, 4294901760
    v_mfma_f32_16x16x32_bf16 v[24:27], v[120:123], v[100:103], 0
    ds_read_b64 v[142:143], v160 offset:7680
    s_cmov_b32 s77, 0
    v_mfma_f32_16x16x32_bf16 v[40:43], v[120:123], v[104:107], 0
    ds_read_b64_tr_b16 v[148:149], v163 offset:4096
    s_add_u32 s76, s76, 1
    v_mfma_f32_16x16x32_bf16 v[56:59], v[120:123], v[108:111], 0
    ds_read_b64_tr_b16 v[150:151], v163 offset:6144
    s_cmp_eq_u32 s76, 3
    v_mfma_f32_16x16x32_bf16 v[12:15], v[124:127], v[96:99], 0
    ds_read_b64_tr_b16 v[152:153], v162 offset:12288
    s_mov_b32 s78, 16384
    v_mfma_f32_16x16x32_bf16 v[28:31], v[124:127], v[100:103], 0
    ds_read_b64_tr_b16 v[154:155], v162 offset:14336
    s_cmov_b32 s78, 4294934528
    v_mfma_f32_16x16x32_bf16 v[44:47], v[124:127], v[104:107], 0
    ds_read_b64_tr_b16 v[156:157], v163 offset:12288
    s_cmov_b32 s76, 0
    v_mfma_f32_16x16x32_bf16 v[60:63], v[124:127], v[108:111], 0
    ds_read_b64_tr_b16 v[158:159], v163 offset:14336
    s_branch L_cstep1_80
L_cloop_79:
    s_waitcnt lgkmcnt(0)
    v_mfma_f32_16x16x32_bf16 v[0:3], v[112:115], v[96:99], v[0:3]
    ds_read_b64 v[128:129], v160 offset:1024
    v_mfma_f32_16x16x32_bf16 v[16:19], v[112:115], v[100:103], v[16:19]
    ds_read_b64 v[130:131], v160 offset:1536
    v_mfma_f32_16x16x32_bf16 v[32:35], v[112:115], v[104:107], v[32:35]
    ds_read_b64_tr_b16 v[144:145], v162 offset:4096
    v_mfma_f32_16x16x32_bf16 v[48:51], v[112:115], v[108:111], v[48:51]
    ds_read_b64_tr_b16 v[146:147], v162 offset:6144
    v_mfma_f32_16x16x32_bf16 v[4:7], v[116:119], v[96:99], v[4:7]
    ds_read_b64 v[132:133], v160 offset:3072
    v_mfma_f32_16x16x32_bf16 v[20:23], v[116:119], v[100:103], v[20:23]
    ds_read_b64 v[134:135], v160 offset:3584
    s_add_u32 s77, s77, 1
    v_mfma_f32_16x16x32_bf16 v[36:39], v[116:119], v[104:107], v[36:39]
    ds_read_b64 v[136:137], v160 offset:5120
    s_cmp_eq_u32 s77, 5
    v_mfma_f32_16x16x32_bf16 v[52:55], v[116:119], v[108:111], v[52:55]
    ds_read_b64 v[138:139], v160 offset:5632
    s_mov_b32 s79, 16384
    v_mfma_f32_16x16x32_bf16 v[8:11], v[120:123], v[96:99], v[8:11]
    ds_read_b64 v[140:141], v160 offset:7168
    s_cmov_b32 s79, 4294901760
    v_mfma_f32_16x16x32_bf16 v[24:27], v[120:123], v[100:103], v[24:27]
    ds_read_b64 v[142:143], v160 offset:7680
    s_cmov_b32 s77, 0
    v_mfma_f32_16x16x32_bf16 v[40:43], v[120:123], v[104:107], v[40:43]
    ds_read_b64_tr_b16 v[148:149], v163 offset:4096
    s_add_u32 s76, s76, 1
    v_mfma_f32_16x16x32_bf16 v[56:59], v[120:123], v[108:111], v[56:59]
    ds_read_b64_tr_b16 v[150:151], v163 offset:6144
    s_cmp_eq_u32 s76, 3
    v_mfma_f32_16x16x32_bf16 v[12:15], v[124:127], v[96:99], v[12:15]
    ds_read_b64_tr_b16 v[152:153], v162 offset:12288
    s_mov_b32 s78, 16384
    v_mfma_f32_16x16x32_bf16 v[28:31], v[124:127], v[100:103], v[28:31]
    ds_read_b64_tr_b16 v[154:155], v162 offset:14336
    s_cmov_b32 s78, 4294934528
    v_mfma_f32_16x16x32_bf16 v[44:47], v[124:127], v[104:107], v[44:47]
    ds_read_b64_tr_b16 v[156:157], v163 offset:12288
    s_cmov_b32 s76, 0
    v_mfma_f32_16x16x32_bf16 v[60:63], v[124:127], v[108:111], v[60:63]
    ds_read_b64_tr_b16 v[158:159], v163 offset:14336
    s_cmp_lg_u32 s57, 1
    s_cbranch_scc1 L_hk_82
    s_waitcnt vmcnt(0)
    s_lshl3_add_u32 s64, s62, s46
    s_lshl_b32 s64, s64, 5
    s_add_u32 s64, s64, s63
    s_lshl_b32 s64, s64, 7
    s_add_u32 s64, s64, 331776
    v_mov_b32 v174, s44
    v_mov_b32 v175, s45
    s_mov_b64 exec, 0xffff
    buffer_store_dwordx2 v[174:175], v233, s[32:35], s64 offen sc1
    s_mov_b64 exec, -1
L_hk_82:
L_cstep1_80:
    s_waitcnt lgkmcnt(0)
    v_mfma_f32_16x16x32_bf16 v[0:3], v[144:147], v[128:131], v[0:3]
    v_add_u32 v160, s78, v160
    v_mfma_f32_16x16x32_bf16 v[16:19], v[144:147], v[132:135], v[16:19]
    v_add_u32 v162, s79, v162
    v_add_u32 v163, s79, v163
    s_cmp_eq_u32 s57, 9
    v_mfma_f32_16x16x32_bf16 v[32:35], v[144:147], v[136:139], v[32:35]
    s_barrier
    s_cbranch_scc1 L_clast_81
    ds_read_b64 v[96:97], v160 offset:0
    v_mfma_f32_16x16x32_bf16 v[48:51], v[144:147], v[140:143], v[48:51]
    ds_read_b64 v[98:99], v160 offset:512
    v_mfma_f32_16x16x32_bf16 v[4:7], v[148:151], v[128:131], v[4:7]
    ds_read_b64_tr_b16 v[112:113], v162 offset:0
    v_mfma_f32_16x16x32_bf16 v[20:23], v[148:151], v[132:135], v[20:23]
    ds_read_b64_tr_b16 v[114:115], v162 offset:2048
    ds_read_b64 v[100:101], v160 offset:2048
    v_mfma_f32_16x16x32_bf16 v[36:39], v[148:151], v[136:139], v[36:39]
    ds_read_b64 v[102:103], v160 offset:2560
    v_mfma_f32_16x16x32_bf16 v[52:55], v[148:151], v[140:143], v[52:55]
    ds_read_b64 v[104:105], v160 offset:4096
    v_mfma_f32_16x16x32_bf16 v[8:11], v[152:155], v[128:131], v[8:11]
    ds_read_b64 v[106:107], v160 offset:4608
    v_mfma_f32_16x16x32_bf16 v[24:27], v[152:155], v[132:135], v[24:27]
    ds_read_b64 v[108:109], v160 offset:6144
    v_mfma_f32_16x16x32_bf16 v[40:43], v[152:155], v[136:139], v[40:43]
    ds_read_b64 v[110:111], v160 offset:6656
    v_mfma_f32_16x16x32_bf16 v[56:59], v[152:155], v[140:143], v[56:59]
    ds_read_b64_tr_b16 v[116:117], v163 offset:0
    v_mfma_f32_16x16x32_bf16 v[12:15], v[156:159], v[128:131], v[12:15]
    ds_read_b64_tr_b16 v[118:119], v163 offset:2048
    ds_read_b64_tr_b16 v[120:121], v162 offset:8192
    v_mfma_f32_16x16x32_bf16 v[28:31], v[156:159], v[132:135], v[28:31]
    ds_read_b64_tr_b16 v[122:123], v162 offset:10240
    s_add_u32 s57, s57, 1
    v_mfma_f32_16x16x32_bf16 v[44:47], v[156:159], v[136:139], v[44:47]
    ds_read_b64_tr_b16 v[124:125], v163 offset:8192
    v_mfma_f32_16x16x32_bf16 v[60:63], v[156:159], v[140:143], v[60:63]
    ds_read_b64_tr_b16 v[126:127], v163 offset:10240
    s_branch L_cloop_79
L_clast_81:
    v_mfma_f32_16x16x32_bf16 v[48:51], v[144:147], v[140:143], v[48:51]
    ds_read_b64 v[64:65], v164 offset:0
    v_mfma_f32_16x16x32_bf16 v[4:7], v[148:151], v[128:131], v[4:7]
    ds_read_b64 v[68:69], v164 offset:256
    v_mfma_f32_16x16x32_bf16 v[20:23], v[148:151], v[132:135], v[20:23]
    ds_read_b64 v[72:73], v164 offset:512
    v_mfma_f32_16x16x32_bf16 v[36:39], v[148:151], v[136:139], v[36:39]
    ds_read_b64 v[76:77], v164 offset:768
    v_mfma_f32_16x16x32_bf16 v[52:55], v[148:151], v[140:143], v[52:55]
    ds_read_b64 v[208:209], v164 offset:8
    v_mfma_f32_16x16x32_bf16 v[8:11], v[152:155], v[128:131], v[8:11]
    ds_read_b64 v[210:211], v164 offset:264
    v_mfma_f32_16x16x32_bf16 v[24:27], v[152:155], v[132:135], v[24:27]
    ds_read_b64 v[212:213], v164 offset:520
    v_mfma_f32_16x16x32_bf16 v[40:43], v[152:155], v[136:139], v[40:43]
    ds_read_b64 v[214:215], v164 offset:776
    v_mfma_f32_16x16x32_bf16 v[56:59], v[152:155], v[140:143], v[56:59]
    v_mfma_f32_16x16x32_bf16 v[12:15], v[156:159], v[128:131], v[12:15]
    v_mfma_f32_16x16x32_bf16 v[28:31], v[156:159], v[132:135], v[28:31]
    v_mfma_f32_16x16x32_bf16 v[44:47], v[156:159], v[136:139], v[44:47]
    v_mfma_f32_16x16x32_bf16 v[60:63], v[156:159], v[140:143], v[60:63]
    s_waitcnt lgkmcnt(0)
    v_mfma_f32_16x16x32_bf16 v[0:3], v[80:83], v[64:67], v[0:3]
    s_barrier
    v_mfma_f32_16x16x32_bf16 v[16:19], v[80:83], v[68:71], v[16:19]
    v_mfma_f32_16x16x32_bf16 v[32:35], v[80:83], v[72:75], v[32:35]
    v_mfma_f32_16x16x32_bf16 v[48:51], v[80:83], v[76:79], v[48:51]
    v_mfma_f32_16x16x32_bf16 v[4:7], v[84:87], v[64:67], v[4:7]
    v_mfma_f32_16x16x32_bf16 v[20:23], v[84:87], v[68:71], v[20:23]
    v_mfma_f32_16x16x32_bf16 v[36:39], v[84:87], v[72:75], v[36:39]
    v_mfma_f32_16x16x32_bf16 v[52:55], v[84:87], v[76:79], v[52:55]
    v_mfma_f32_16x16x32_bf16 v[8:11], v[88:91], v[64:67], v[8:11]
    v_mfma_f32_16x16x32_bf16 v[24:27], v[88:91], v[68:71], v[24:27]
    v_mfma_f32_16x16x32_bf16 v[40:43], v[88:91], v[72:75], v[40:43]
    v_mfma_f32_16x16x32_bf16 v[56:59], v[88:91], v[76:79], v[56:59]
    v_mfma_f32_16x16x32_bf16 v[12:15], v[92:95], v[64:67], v[12:15]
    v_mfma_f32_16x16x32_bf16 v[28:31], v[92:95], v[68:71], v[28:31]
    v_mfma_f32_16x16x32_bf16 v[44:47], v[92:95], v[72:75], v[44:47]
    v_mfma_f32_16x16x32_bf16 v[60:63], v[92:95], v[76:79], v[60:63]
    s_setprio 2
    v_mul_f32 v216, 0xc0135761, v209
    v_mul_f32 v217, v209, v209
    v_rcp_f32 v218, v209
    v_mul_f32 v217, v217, v209
    v_mul_f32 v217, 0xbdd2d3e8, v217
    v_mul_f32 v220, 0xc0135761, v211
    v_mul_f32 v221, v211, v211
    v_rcp_f32 v222, v211
    v_mul_f32 v221, v221, v211
    v_mul_f32 v221, 0xbdd2d3e8, v221
    v_mul_f32 v224, 0xc0135761, v213
    v_mul_f32 v225, v213, v213
    v_rcp_f32 v226, v213
    v_mul_f32 v225, v225, v213
    v_mul_f32 v225, 0xbdd2d3e8, v225
    v_mul_f32 v228, 0xc0135761, v215
    v_mul_f32 v229, v215, v215
    v_rcp_f32 v230, v215
    v_mul_f32 v229, v229, v215
    v_mul_f32 v229, 0xbdd2d3e8, v229
    v_lshlrev_b32 v204, 4, v234
    s_lshl1_add_u32 s65, s53, s55
    s_mul_i32 s66, s65, 221184
    s_lshl2_add_u32 s67, s54, s56
    s_lshl_b32 s67, s67, 10
    s_add_u32 s66, s66, s67
    s_add_u32 s66, s66, 17825792
    s_add_u32 s67, s66, 2048
    s_cmp_eq_u32 s54, 13
    s_cselect_b32 s67, 67108864, s67
    buffer_load_dwordx2 v[172:173], v170, s[32:35], 0 offen sc1
    v_pk_mul_f32 v[176:177], v[0:1], v[0:1]
    v_pk_mul_f32 v[178:179], v[2:3], v[2:3]
    v_pk_mul_f32 v[180:181], v[4:5], v[4:5]
    v_pk_mul_f32 v[182:183], v[6:7], v[6:7]
    v_pk_fma_f32 v[176:177], v[176:177], v[216:217], v[216:217] op_sel:[0,1,0] op_sel_hi:[1,1,0]
    v_pk_fma_f32 v[178:179], v[178:179], v[216:217], v[216:217] op_sel:[0,1,0] op_sel_hi:[1,1,0]
    v_pk_fma_f32 v[180:181], v[180:181], v[216:217], v[216:217] op_sel:[0,1,0] op_sel_hi:[1,1,0]
    v_pk_fma_f32 v[182:183], v[182:183], v[216:217], v[216:217] op_sel:[0,1,0] op_sel_hi:[1,1,0]
    v_pk_mul_f32 v[176:177], v[176:177], v[0:1]
    v_pk_mul_f32 v[178:179], v[178:179], v[2:3]
    v_pk_mul_f32 v[180:181], v[180:181], v[4:5]
    v_pk_mul_f32 v[182:183], v[182:183], v[6:7]
    v_exp_f32 v176, v176
    v_exp_f32 v177, v177
    v_exp_f32 v178, v178
    v_exp_f32 v179, v179
    v_exp_f32 v180, v180
    v_exp_f32 v181, v181
    v_exp_f32 v182, v182
    v_exp_f32 v183, v183
    s_add_u32 s68, s66, 0
    v_pk_fma_f32 v[176:177], v[176:177], v[218:219], v[218:219] op_sel_hi:[1,0,0]
    v_pk_fma_f32 v[178:179], v[178:179], v[218:219], v[218:219] op_sel_hi:[1,0,0]
    v_pk_fma_f32 v[180:181], v[180:181], v[218:219], v[218:219] op_sel_hi:[1,0,0]
    v_pk_fma_f32 v[182:183], v[182:183], v[218:219], v[218:219] op_sel_hi:[1,0,0]
    v_rcp_f32 v176, v176
    v_rcp_f32 v177, v177
    v_rcp_f32 v178, v178
    v_rcp_f32 v179, v179
    v_rcp_f32 v180, v180
    v_rcp_f32 v181, v181
    v_rcp_f32 v182, v182
    v_rcp_f32 v183, v183
    v_pk_mul_f32 v[176:177], v[176:177], v[0:1]
    v_pk_mul_f32 v[178:179], v[178:179], v[2:3]
    v_pk_mul_f32 v[180:181], v[180:181], v[4:5]
    v_pk_mul_f32 v[182:183], v[182:183], v[6:7]
    v_cvt_pk_bf16_f32 v192, v176, v177
    v_cvt_pk_bf16_f32 v193, v178, v179
    v_cvt_pk_bf16_f32 v194, v180, v181
    v_cvt_pk_bf16_f32 v195, v182, v183
    buffer_store_dwordx4 v[192:195], v204, s[32:35], s68 offen sc1
    v_pk_mul_f32 v[184:185], v[16:17], v[16:17]
    v_pk_mul_f32 v[186:187], v[18:19], v[18:19]
    v_pk_mul_f32 v[188:189], v[20:21], v[20:21]
    v_pk_mul_f32 v[190:191], v[22:23], v[22:23]
    v_pk_fma_f32 v[184:185], v[184:185], v[220:221], v[220:221] op_sel:[0,1,0] op_sel_hi:[1,1,0]
    v_pk_fma_f32 v[186:187], v[186:187], v[220:221], v[220:221] op_sel:[0,1,0] op_sel_hi:[1,1,0]
    v_pk_fma_f32 v[188:189], v[188:189], v[220:221], v[220:221] op_sel:[0,1,0] op_sel_hi:[1,1,0]
    v_pk_fma_f32 v[190:191], v[190:191], v[220:221], v[220:221] op_sel:[0,1,0] op_sel_hi:[1,1,0]
    v_pk_mul_f32 v[184:185], v[184:185], v[16:17]
    v_pk_mul_f32 v[186:187], v[186:187], v[18:19]
    v_pk_mul_f32 v[188:189], v[188:189], v[20:21]
    v_pk_mul_f32 v[190:191], v[190:191], v[22:23]
    v_exp_f32 v184, v184
    v_exp_f32 v185, v185
    v_exp_f32 v186, v186
    v_exp_f32 v187, v187
    v_exp_f32 v188, v188
    v_exp_f32 v189, v189
    v_exp_f32 v190, v190
    v_exp_f32 v191, v191
    s_add_u32 s68, s66, 55296
    v_pk_fma_f32 v[184:185], v[184:185], v[222:223], v[222:223] op_sel_hi:[1,0,0]
    v_pk_fma_f32 v[186:187], v[186:187], v[222:223], v[222:223] op_sel_hi:[1,0,0]
    v_pk_fma_f32 v[188:189], v[188:189], v[222:223], v[222:223] op_sel_hi:[1,0,0]
    v_pk_fma_f32 v[190:191], v[190:191], v[222:223], v[222:223] op_sel_hi:[1,0,0]
    v_rcp_f32 v184, v184
    v_rcp_f32 v185, v185
    v_rcp_f32 v186, v186
    v_rcp_f32 v187, v187
    v_rcp_f32 v188, v188
    v_rcp_f32 v189, v189
    v_rcp_f32 v190, v190
    v_rcp_f32 v191, v191
    v_pk_mul_f32 v[184:185], v[184:185], v[16:17]
    v_pk_mul_f32 v[186:187], v[186:187], v[18:19]
    v_pk_mul_f32 v[188:189], v[188:189], v[20:21]
    v_pk_mul_f32 v[190:191], v[190:191], v[22:23]
    v_cvt_pk_bf16_f32 v196, v184, v185
    v_cvt_pk_bf16_f32 v197, v186, v187
    v_cvt_pk_bf16_f32 v198, v188, v189
    v_cvt_pk_bf16_f32 v199, v190, v191
    buffer_store_dwordx4 v[196:199], v204, s[32:35], s68 offen sc1
    v_pk_mul_f32 v[176:177], v[32:33], v[32:33]
    v_pk_mul_f32 v[178:179], v[34:35], v[34:35]
    v_pk_mul_f32 v[180:181], v[36:37], v[36:37]
    v_pk_mul_f32 v[182:183], v[38:39], v[38:39]
    v_pk_fma_f32 v[176:177], v[176:177], v[224:225], v[224:225] op_sel:[0,1,0] op_sel_hi:[1,1,0]
    v_pk_fma_f32 v[178:179], v[178:179], v[224:225], v[224:225] op_sel:[0,1,0] op_sel_hi:[1,1,0]
    v_pk_fma_f32 v[180:181], v[180:181], v[224:225], v[224:225] op_sel:[0,1,0] op_sel_hi:[1,1,0]
    v_pk_fma_f32 v[182:183], v[182:183], v[224:225], v[224:225] op_sel:[0,1,0] op_sel_hi:[1,1,0]
    v_pk_mul_f32 v[176:177], v[176:177], v[32:33]
    v_pk_mul_f32 v[178:179], v[178:179], v[34:35]
    v_pk_mul_f32 v[180:181], v[180:181], v[36:37]
    v_pk_mul_f32 v[182:183], v[182:183], v[38:39]
    v_exp_f32 v176, v176
    v_exp_f32 v177, v177
    v_exp_f32 v178, v178
    v_exp_f32 v179, v179
    v_exp_f32 v180, v180
    v_exp_f32 v181, v181
    v_exp_f32 v182, v182
    v_exp_f32 v183, v183
    s_add_u32 s68, s66, 110592
    v_pk_fma_f32 v[176:177], v[176:177], v[226:227], v[226:227] op_sel_hi:[1,0,0]
    v_pk_fma_f32 v[178:179], v[178:179], v[226:227], v[226:227] op_sel_hi:[1,0,0]
    v_pk_fma_f32 v[180:181], v[180:181], v[226:227], v[226:227] op_sel_hi:[1,0,0]
    v_pk_fma_f32 v[182:183], v[182:183], v[226:227], v[226:227] op_sel_hi:[1,0,0]
    v_rcp_f32 v176, v176
    v_rcp_f32 v177, v177
    v_rcp_f32 v178, v178
    v_rcp_f32 v179, v179
    v_rcp_f32 v180, v180
    v_rcp_f32 v181, v181
    v_rcp_f32 v182, v182
    v_rcp_f32 v183, v183
    v_pk_mul_f32 v[176:177], v[176:177], v[32:33]
    v_pk_mul_f32 v[178:179], v[178:179], v[34:35]
    v_pk_mul_f32 v[180:181], v[180:181], v[36:37]
    v_pk_mul_f32 v[182:183], v[182:183], v[38:39]
    v_cvt_pk_bf16_f32 v200, v176, v177
    v_cvt_pk_bf16_f32 v201, v178, v179
    v_cvt_pk_bf16_f32 v202, v180, v181
    v_cvt_pk_bf16_f32 v203, v182, v183
    buffer_store_dwordx4 v[200:203], v204, s[32:35], s68 offen sc1
    v_pk_mul_f32 v[184:185], v[48:49], v[48:49]
    v_pk_mul_f32 v[186:187], v[50:51], v[50:51]
    v_pk_mul_f32 v[188:189], v[52:53], v[52:53]
    v_pk_mul_f32 v[190:191], v[54:55], v[54:55]
    v_pk_fma_f32 v[184:185], v[184:185], v[228:229], v[228:229] op_sel:[0,1,0] op_sel_hi:[1,1,0]
    v_pk_fma_f32 v[186:187], v[186:187], v[228:229], v[228:229] op_sel:[0,1,0] op_sel_hi:[1,1,0]
    v_pk_fma_f32 v[188:189], v[188:189], v[228:229], v[228:229] op_sel:[0,1,0] op_sel_hi:[1,1,0]
    v_pk_fma_f32 v[190:191], v[190:191], v[228:229], v[228:229] op_sel:[0,1,0] op_sel_hi:[1,1,0]
    v_pk_mul_f32 v[184:185], v[184:185], v[48:49]
    v_pk_mul_f32 v[186:187], v[186:187], v[50:51]
    v_pk_mul_f32 v[188:189], v[188:189], v[52:53]
    v_pk_mul_f32 v[190:191], v[190:191], v[54:55]
    v_exp_f32 v184, v184
    v_exp_f32 v185, v185
    v_exp_f32 v186, v186
    v_exp_f32 v187, v187
    v_exp_f32 v188, v188
    v_exp_f32 v189, v189
    v_exp_f32 v190, v190
    v_exp_f32 v191, v191
    s_add_u32 s68, s66, 165888
    v_pk_fma_f32 v[184:185], v[184:185], v[230:231], v[230:231] op_sel_hi:[1,0,0]
    v_pk_fma_f32 v[186:187], v[186:187], v[230:231], v[230:231] op_sel_hi:[1,0,0]
    v_pk_fma_f32 v[188:189], v[188:189], v[230:231], v[230:231] op_sel_hi:[1,0,0]
    v_pk_fma_f32 v[190:191], v[190:191], v[230:231], v[230:231] op_sel_hi:[1,0,0]
    v_rcp_f32 v184, v184
    v_rcp_f32 v185, v185
    v_rcp_f32 v186, v186
    v_rcp_f32 v187, v187
    v_rcp_f32 v188, v188
    v_rcp_f32 v189, v189
    v_rcp_f32 v190, v190
    v_rcp_f32 v191, v191
    v_pk_mul_f32 v[184:185], v[184:185], v[48:49]
    v_pk_mul_f32 v[186:187], v[186:187], v[50:51]
    v_pk_mul_f32 v[188:189], v[188:189], v[52:53]
    v_pk_mul_f32 v[190:191], v[190:191], v[54:55]
    v_cvt_pk_bf16_f32 v192, v184, v185
    v_cvt_pk_bf16_f32 v193, v186, v187
    v_cvt_pk_bf16_f32 v194, v188, v189
    v_cvt_pk_bf16_f32 v195, v190, v191
    buffer_store_dwordx4 v[192:195], v204, s[32:35], s68 offen sc1
    v_pk_mul_f32 v[176:177], v[8:9], v[8:9]
    v_pk_mul_f32 v[178:179], v[10:11], v[10:11]
    v_pk_mul_f32 v[180:181], v[12:13], v[12:13]
    v_pk_mul_f32 v[182:183], v[14:15], v[14:15]
    v_pk_fma_f32 v[176:177], v[176:177], v[216:217], v[216:217] op_sel:[0,1,0] op_sel_hi:[1,1,0]
    v_pk_fma_f32 v[178:179], v[178:179], v[216:217], v[216:217] op_sel:[0,1,0] op_sel_hi:[1,1,0]
    v_pk_fma_f32 v[180:181], v[180:181], v[216:217], v[216:217] op_sel:[0,1,0] op_sel_hi:[1,1,0]
    v_pk_fma_f32 v[182:183], v[182:183], v[216:217], v[216:217] op_sel:[0,1,0] op_sel_hi:[1,1,0]
    v_pk_mul_f32 v[176:177], v[176:177], v[8:9]
    v_pk_mul_f32 v[178:179], v[178:179], v[10:11]
    v_pk_mul_f32 v[180:181], v[180:181], v[12:13]
    v_pk_mul_f32 v[182:183], v[182:183], v[14:15]
    v_exp_f32 v176, v176
    v_exp_f32 v177, v177
    v_exp_f32 v178, v178
    v_exp_f32 v179, v179
    v_exp_f32 v180, v180
    v_exp_f32 v181, v181
    v_exp_f32 v182, v182
    v_exp_f32 v183, v183
    s_add_u32 s68, s67, 0
    v_pk_fma_f32 v[176:177], v[176:177], v[218:219], v[218:219] op_sel_hi:[1,0,0]
    v_pk_fma_f32 v[178:179], v[178:179], v[218:219], v[218:219] op_sel_hi:[1,0,0]
    v_pk_fma_f32 v[180:181], v[180:181], v[218:219], v[218:219] op_sel_hi:[1,0,0]
    v_pk_fma_f32 v[182:183], v[182:183], v[218:219], v[218:219] op_sel_hi:[1,0,0]
    v_rcp_f32 v176, v176
    v_rcp_f32 v177, v177
    v_rcp_f32 v178, v178
    v_rcp_f32 v179, v179
    v_rcp_f32 v180, v180
    v_rcp_f32 v181, v181
    v_rcp_f32 v182, v182
    v_rcp_f32 v183, v183
    v_pk_mul_f32 v[176:177], v[176:177], v[8:9]
    v_pk_mul_f32 v[178:179], v[178:179], v[10:11]
    v_pk_mul_f32 v[180:181], v[180:181], v[12:13]
    v_pk_mul_f32 v[182:183], v[182:183], v[14:15]
    v_cvt_pk_bf16_f32 v196, v176, v177
    v_cvt_pk_bf16_f32 v197, v178, v179
    v_cvt_pk_bf16_f32 v198, v180, v181
    v_cvt_pk_bf16_f32 v199, v182, v183
    buffer_store_dwordx4 v[196:199], v204, s[32:35], s68 offen sc1
    v_pk_mul_f32 v[184:185], v[24:25], v[24:25]
    v_pk_mul_f32 v[186:187], v[26:27], v[26:27]
    v_pk_mul_f32 v[188:189], v[28:29], v[28:29]
    v_pk_mul_f32 v[190:191], v[30:31], v[30:31]
    v_pk_fma_f32 v[184:185], v[184:185], v[220:221], v[220:221] op_sel:[0,1,0] op_sel_hi:[1,1,0]
    v_pk_fma_f32 v[186:187], v[186:187], v[220:221], v[220:221] op_sel:[0,1,0] op_sel_hi:[1,1,0]
    v_pk_fma_f32 v[188:189], v[188:189], v[220:221], v[220:221] op_sel:[0,1,0] op_sel_hi:[1,1,0]
    v_pk_fma_f32 v[190:191], v[190:191], v[220:221], v[220:221] op_sel:[0,1,0] op_sel_hi:[1,1,0]
    v_pk_mul_f32 v[184:185], v[184:185], v[24:25]
    v_pk_mul_f32 v[186:187], v[186:187], v[26:27]
    v_pk_mul_f32 v[188:189], v[188:189], v[28:29]
    v_pk_mul_f32 v[190:191], v[190:191], v[30:31]
    v_exp_f32 v184, v184
    v_exp_f32 v185, v185
    v_exp_f32 v186, v186
    v_exp_f32 v187, v187
    v_exp_f32 v188, v188
    v_exp_f32 v189, v189
    v_exp_f32 v190, v190
    v_exp_f32 v191, v191
    s_add_u32 s68, s67, 55296
    v_pk_fma_f32 v[184:185], v[184:185], v[222:223], v[222:223] op_sel_hi:[1,0,0]
    v_pk_fma_f32 v[186:187], v[186:187], v[222:223], v[222:223] op_sel_hi:[1,0,0]
    v_pk_fma_f32 v[188:189], v[188:189], v[222:223], v[222:223] op_sel_hi:[1,0,0]
    v_pk_fma_f32 v[190:191], v[190:191], v[222:223], v[222:223] op_sel_hi:[1,0,0]
    v_rcp_f32 v184, v184
    v_rcp_f32 v185, v185
    v_rcp_f32 v186, v186
    v_rcp_f32 v187, v187
    v_rcp_f32 v188, v188
    v_rcp_f32 v189, v189
    v_rcp_f32 v190, v190
    v_rcp_f32 v191, v191
    v_pk_mul_f32 v[184:185], v[184:185], v[24:25]
    v_pk_mul_f32 v[186:187], v[186:187], v[26:27]
    v_pk_mul_f32 v[188:189], v[188:189], v[28:29]
    v_pk_mul_f32 v[190:191], v[190:191], v[30:31]
    v_cvt_pk_bf16_f32 v200, v184, v185
    v_cvt_pk_bf16_f32 v201, v186, v187
    v_cvt_pk_bf16_f32 v202, v188, v189
    v_cvt_pk_bf16_f32 v203, v190, v191
    buffer_store_dwordx4 v[200:203], v204, s[32:35], s68 offen sc1
    v_pk_mul_f32 v[176:177], v[40:41], v[40:41]
    v_pk_mul_f32 v[178:179], v[42:43], v[42:43]
    v_pk_mul_f32 v[180:181], v[44:45], v[44:45]
    v_pk_mul_f32 v[182:183], v[46:47], v[46:47]
    v_pk_fma_f32 v[176:177], v[176:177], v[224:225], v[224:225] op_sel:[0,1,0] op_sel_hi:[1,1,0]
    v_pk_fma_f32 v[178:179], v[178:179], v[224:225], v[224:225] op_sel:[0,1,0] op_sel_hi:[1,1,0]
    v_pk_fma_f32 v[180:181], v[180:181], v[224:225], v[224:225] op_sel:[0,1,0] op_sel_hi:[1,1,0]
    v_pk_fma_f32 v[182:183], v[182:183], v[224:225], v[224:225] op_sel:[0,1,0] op_sel_hi:[1,1,0]
    v_pk_mul_f32 v[176:177], v[176:177], v[40:41]
    v_pk_mul_f32 v[178:179], v[178:179], v[42:43]
    v_pk_mul_f32 v[180:181], v[180:181], v[44:45]
    v_pk_mul_f32 v[182:183], v[182:183], v[46:47]
    v_exp_f32 v176, v176
    v_exp_f32 v177, v177
    v_exp_f32 v178, v178
    v_exp_f32 v179, v179
    v_exp_f32 v180, v180
    v_exp_f32 v181, v181
    v_exp_f32 v182, v182
    v_exp_f32 v183, v183
    s_add_u32 s68, s67, 110592
    v_pk_fma_f32 v[176:177], v[176:177], v[226:227], v[226:227] op_sel_hi:[1,0,0]
    v_pk_fma_f32 v[178:179], v[178:179], v[226:227], v[226:227] op_sel_hi:[1,0,0]
    v_pk_fma_f32 v[180:181], v[180:181], v[226:227], v[226:227] op_sel_hi:[1,0,0]
    v_pk_fma_f32 v[182:183], v[182:183], v[226:227], v[226:227] op_sel_hi:[1,0,0]
    v_rcp_f32 v176, v176
    v_rcp_f32 v177, v177
    v_rcp_f32 v178, v178
    v_rcp_f32 v179, v179
    v_rcp_f32 v180, v180
    v_rcp_f32 v181, v181
    v_rcp_f32 v182, v182
    v_rcp_f32 v183, v183
    v_pk_mul_f32 v[176:177], v[176:177], v[40:41]
    v_pk_mul_f32 v[178:179], v[178:179], v[42:43]
    v_pk_mul_f32 v[180:181], v[180:181], v[44:45]
    v_pk_mul_f32 v[182:183], v[182:183], v[46:47]
    v_cvt_pk_bf16_f32 v192, v176, v177
    v_cvt_pk_bf16_f32 v193, v178, v179
    v_cvt_pk_bf16_f32 v194, v180, v181
    v_cvt_pk_bf16_f32 v195, v182, v183
    buffer_store_dwordx4 v[192:195], v204, s[32:35], s68 offen sc1
    v_pk_mul_f32 v[184:185], v[56:57], v[56:57]
    v_pk_mul_f32 v[186:187], v[58:59], v[58:59]
    v_pk_mul_f32 v[188:189], v[60:61], v[60:61]
    v_pk_mul_f32 v[190:191], v[62:63], v[62:63]
    v_pk_fma_f32 v[184:185], v[184:185], v[228:229], v[228:229] op_sel:[0,1,0] op_sel_hi:[1,1,0]
    v_pk_fma_f32 v[186:187], v[186:187], v[228:229], v[228:229] op_sel:[0,1,0] op_sel_hi:[1,1,0]
    v_pk_fma_f32 v[188:189], v[188:189], v[228:229], v[228:229] op_sel:[0,1,0] op_sel_hi:[1,1,0]
    v_pk_fma_f32 v[190:191], v[190:191], v[228:229], v[228:229] op_sel:[0,1,0] op_sel_hi:[1,1,0]
    v_pk_mul_f32 v[184:185], v[184:185], v[56:57]
    v_pk_mul_f32 v[186:187], v[186:187], v[58:59]
    v_pk_mul_f32 v[188:189], v[188:189], v[60:61]
    v_pk_mul_f32 v[190:191], v[190:191], v[62:63]
    v_exp_f32 v184, v184
    v_exp_f32 v185, v185
    v_exp_f32 v186, v186
    v_exp_f32 v187, v187
    v_exp_f32 v188, v188
    v_exp_f32 v189, v189
    v_exp_f32 v190, v190
    v_exp_f32 v191, v191
    s_add_u32 s68, s67, 165888
    v_pk_fma_f32 v[184:185], v[184:185], v[230:231], v[230:231] op_sel_hi:[1,0,0]
    v_pk_fma_f32 v[186:187], v[186:187], v[230:231], v[230:231] op_sel_hi:[1,0,0]
    v_pk_fma_f32 v[188:189], v[188:189], v[230:231], v[230:231] op_sel_hi:[1,0,0]
    v_pk_fma_f32 v[190:191], v[190:191], v[230:231], v[230:231] op_sel_hi:[1,0,0]
    v_rcp_f32 v184, v184
    v_rcp_f32 v185, v185
    v_rcp_f32 v186, v186
    v_rcp_f32 v187, v187
    v_rcp_f32 v188, v188
    v_rcp_f32 v189, v189
    v_rcp_f32 v190, v190
    v_rcp_f32 v191, v191
    v_pk_mul_f32 v[184:185], v[184:185], v[56:57]
    v_pk_mul_f32 v[186:187], v[186:187], v[58:59]
    v_pk_mul_f32 v[188:189], v[188:189], v[60:61]
    v_pk_mul_f32 v[190:191], v[190:191], v[62:63]
    v_cvt_pk_bf16_f32 v196, v184, v185
    v_cvt_pk_bf16_f32 v197, v186, v187
    v_cvt_pk_bf16_f32 v198, v188, v189
    v_cvt_pk_bf16_f32 v199, v190, v191
    buffer_store_dwordx4 v[196:199], v204, s[32:35], s68 offen sc1
    s_lshl_b32 s65, s65, 5
    s_lshl1_add_u32 s64, s54, s56
    s_add_u32 s65, s65, s64
    s_lshl_b32 s65, s65, 7
    s_add_u32 s93, s65, 593920
    s_branch L_t4l0_78
L_no3c_77:
    s_sub_u32 s73, s2, 224
    s_lshl3_add_u32 s86, s73, s46
    s_add_u32 s86, s86, 200
    s_lshl_b32 s87, s46, 12
    s_waitcnt vmcnt(2)
    s_barrier
    v_and_b32 v71, 7, v234
    v_lshlrev_b32 v71, 4, v71
    v_lshlrev_b32 v66, 4, v234
    v_bfe_u32 v67, v234, 2, 2
    v_and_b32 v68, 3, v234
    v_lshlrev_b32 v68, 3, v68
    v_lshl_add_u32 v67, v67, 7, v68
    v_add_u32 v67, s87, v67
    v_lshrrev_b32 v68, 4, v234
    v_lshl_add_u32 v69, v68, 9, v67
    v_and_b32 v70, 1, v68
    v_lshl_add_u32 v70, v70, 9, v67
    v_lshrrev_b32 v68, 1, v68
    v_lshl_add_u32 v70, v68, 11, v70
    s_cmp_lt_u32 s86, 200
    s_cselect_b32 s36, s14, s8
    s_cselect_b32 s37, s15, s9
    s_mov_b64 vcc, 0
    s_mov_b32 s64, 200
    s_cmov_b32 s64, 0
    s_mov_b32 s88, 25722880
    s_cmov_b32 s88, 24903680
    s_mov_b32 s67, 2048
    s_mov_b32 s38, 819200
    s_mov_b32 s39, 0x20000
    s_mov_b32 s89, 20
    s_cmp_ge_u32 s86, 400
    s_cselect_b32 s36, s18, s36
    s_cselect_b32 s37, s19, s37
    s_cmov_b32 s38, 2211840
    s_cmov_b32 s64, 400
    s_cmov_b32 s88, 26542080
    s_cmov_b32 s89, 54
    s_sub_u32 s64, s86, s64
    s_mul_i32 s90, s64, 52429
    s_lshr_b32 s90, s90, 19
    s_mul_i32 s91, s90, 10
    s_sub_u32 s91, s64, s91
    s_lshl_b32 s64, s90, 5
    s_mov_b32 s65, 0
    s_mov_b32 s66, 4
    s_cmp_lg_u32 s88, 25722880
    s_cbranch_scc1 L_pkn_83
    s_mul_i32 s68, s90, 52
    s_lshr_b32 s68, s68, 8
    s_mul_i32 s64, s68, 160
    s_mul_i32 s68, s68, 5
    s_sub_u32 s68, s90, s68
    s_cmp_eq_u32 s68, 4
    s_cbranch_scc1 L_pk4_84
    s_mul_i32 s68, s68, 40
    s_add_u32 s64, s64, s68
    s_mov_b32 s65, 4
    s_mov_b64 vcc, -1
    s_mov_b32 s67, 1024
    s_branch L_pkn_83
L_pk4_84:
    s_add_u32 s64, s64, 16
    s_mov_b32 s65, 16
    s_mov_b32 s66, 2
L_pkn_83:
    s_mov_b32 s68, 1280
    v_lshrrev_b32 v28, 3, v234
    v_add_u32 v28, 0, v28
    v_lshrrev_b32 v65, s66, v28
    v_mad_u32_u24 v28, v65, s65, v28
    v_mad_u32_u24 v28, v28, s68, v71
    v_lshrrev_b32 v29, 3, v234
    v_add_u32 v29, 8, v29
    v_lshrrev_b32 v65, s66, v29
    v_mad_u32_u24 v29, v65, s65, v29
    v_mad_u32_u24 v29, v29, s68, v71
    v_subrev_u32 v29, 1024, v29
    v_lshrrev_b32 v30, 3, v234
    v_add_u32 v30, 16, v30
    v_lshrrev_b32 v65, s66, v30
    v_mad_u32_u24 v30, v65, s65, v30
    v_mad_u32_u24 v30, v30, s68, v71
    v_subrev_u32 v30, 2048, v30
    v_lshrrev_b32 v31, 3, v234
    v_add_u32 v31, 24, v31
    v_lshrrev_b32 v65, s66, v31
    v_mad_u32_u24 v31, v65, s65, v31
    v_mad_u32_u24 v31, v31, s68, v71
    v_subrev_u32 v31, 3072, v31
    s_mul_i32 s64, s64, 1280
    s_lshl_b32 s65, s91, 7
    s_add_u32 s64, s64, s65
    s_mov_b32 m0, s87
    v_cndmask_b32 v64, v69, v70, vcc
    buffer_load_dwordx4 v28, s[36:39], s64 offen offset:0 lds
    buffer_load_dwordx4 v29, s[36:39], s64 offen offset:1024 lds
    buffer_load_dwordx4 v30, s[36:39], s64 offen offset:2048 lds
    buffer_load_dwordx4 v31, s[36:39], s64 offen offset:3072 lds
    v_add_u32 v65, s67, v64
    s_waitcnt vmcnt(4)
    s_lshl3_add_u32 s64, s62, s46
    s_lshl_b32 s64, s64, 5
    s_add_u32 s64, s64, s63
    s_lshl_b32 s64, s64, 7
    s_add_u32 s64, s64, 331776
    v_mov_b32 v32, s44
    v_mov_b32 v33, s45
    s_mov_b64 exec, 0xffff
    buffer_store_dwordx2 v[32:33], v233, s[32:35], s64 offen sc1
    s_mov_b64 exec, -1
    s_waitcnt vmcnt(0)
    ds_read_b64_tr_b16 v[72:73], v64 offset:0
    ds_read_b64_tr_b16 v[74:75], v65 offset:0
    ds_read_b64_tr_b16 v[76:77], v64 offset:32
    ds_read_b64_tr_b16 v[78:79], v65 offset:32
    ds_read_b64_tr_b16 v[80:81], v64 offset:64
    ds_read_b64_tr_b16 v[82:83], v65 offset:64
    ds_read_b64_tr_b16 v[84:85], v64 offset:96
    ds_read_b64_tr_b16 v[86:87], v65 offset:96
    s_mul_i32 s67, s90, 5120
    s_add_u32 s67, s67, s88
    s_lshl2_add_u32 s64, s91, 0
    s_mul_i32 s65, s64, 52429
    s_lshr_b32 s65, s65, 18
    s_mul_i32 s66, s65, 5
    s_sub_u32 s64, s64, s66
    s_mul_i32 s66, s66, s89
    s_add_u32 s64, s64, s66
    s_lshl_b32 s64, s64, 10
    s_add_u32 s64, s64, s67
    s_waitcnt lgkmcnt(6)
    buffer_store_dwordx4 v[72:75], v66, s[32:35], s64 offen sc1
    s_lshl2_add_u32 s64, s91, 1
    s_mul_i32 s65, s64, 52429
    s_lshr_b32 s65, s65, 18
    s_mul_i32 s66, s65, 5
    s_sub_u32 s64, s64, s66
    s_mul_i32 s66, s66, s89
    s_add_u32 s64, s64, s66
    s_lshl_b32 s64, s64, 10
    s_add_u32 s64, s64, s67
    s_waitcnt lgkmcnt(4)
    buffer_store_dwordx4 v[76:79], v66, s[32:35], s64 offen sc1
    s_lshl2_add_u32 s64, s91, 2
    s_mul_i32 s65, s64, 52429
    s_lshr_b32 s65, s65, 18
    s_mul_i32 s66, s65, 5
    s_sub_u32 s64, s64, s66
    s_mul_i32 s66, s66, s89
    s_add_u32 s64, s64, s66
    s_lshl_b32 s64, s64, 10
    s_add_u32 s64, s64, s67
    s_waitcnt lgkmcnt(2)
    buffer_store_dwordx4 v[80:83], v66, s[32:35], s64 offen sc1
    s_lshl2_add_u32 s64, s91, 3
    s_mul_i32 s65, s64, 52429
    s_lshr_b32 s65, s65, 18
    s_mul_i32 s66, s65, 5
    s_sub_u32 s64, s64, s66
    s_mul_i32 s66, s66, s89
    s_add_u32 s64, s64, s66
    s_lshl_b32 s64, s64, 10
    s_add_u32 s64, s64, s67
    s_waitcnt lgkmcnt(0)
    buffer_store_dwordx4 v[84:87], v66, s[32:35], s64 offen sc1
    s_add_u32 s86, s86, 256
    s_cmp_lt_u32 s86, 200
    s_cselect_b32 s36, s14, s8
    s_cselect_b32 s37, s15, s9
    s_mov_b64 vcc, 0
    s_mov_b32 s64, 200
    s_cmov_b32 s64, 0
    s_mov_b32 s88, 25722880
    s_cmov_b32 s88, 24903680
    s_mov_b32 s67, 2048
    s_mov_b32 s38, 819200
    s_mov_b32 s39, 0x20000
    s_mov_b32 s89, 20
    s_cmp_ge_u32 s86, 400
    s_cselect_b32 s36, s18, s36
    s_cselect_b32 s37, s19, s37
    s_cmov_b32 s38, 2211840
    s_cmov_b32 s64, 400
    s_cmov_b32 s88, 26542080
    s_cmov_b32 s89, 54
    s_sub_u32 s64, s86, s64
    s_mul_i32 s90, s64, 52429
    s_lshr_b32 s90, s90, 19
    s_mul_i32 s91, s90, 10
    s_sub_u32 s91, s64, s91
    s_lshl_b32 s64, s90, 5
    s_mov_b32 s65, 0
    s_mov_b32 s66, 4
    s_cmp_lg_u32 s88, 25722880
    s_cbranch_scc1 L_pkn_85
    s_mul_i32 s68, s90, 52
    s_lshr_b32 s68, s68, 8
    s_mul_i32 s64, s68, 160
    s_mul_i32 s68, s68, 5
    s_sub_u32 s68, s90, s68
    s_cmp_eq_u32 s68, 4
    s_cbranch_scc1 L_pk4_86
    s_mul_i32 s68, s68, 40
    s_add_u32 s64, s64, s68
    s_mov_b32 s65, 4
    s_mov_b64 vcc, -1
    s_mov_b32 s67, 1024
    s_branch L_pkn_85
L_pk4_86:
    s_add_u32 s64, s64, 16
    s_mov_b32 s65, 16
    s_mov_b32 s66, 2
L_pkn_85:
    s_mov_b32 s68, 1280
    v_lshrrev_b32 v28, 3, v234
    v_add_u32 v28, 0, v28
    v_lshrrev_b32 v65, s66, v28
    v_mad_u32_u24 v28, v65, s65, v28
    v_mad_u32_u24 v28, v28, s68, v71
    v_lshrrev_b32 v29, 3, v234
    v_add_u32 v29, 8, v29
    v_lshrrev_b32 v65, s66, v29
    v_mad_u32_u24 v29, v65, s65, v29
    v_mad_u32_u24 v29, v29, s68, v71
    v_subrev_u32 v29, 1024, v29
    v_lshrrev_b32 v30, 3, v234
    v_add_u32 v30, 16, v30
    v_lshrrev_b32 v65, s66, v30
    v_mad_u32_u24 v30, v65, s65, v30
    v_mad_u32_u24 v30, v30, s68, v71
    v_subrev_u32 v30, 2048, v30
    v_lshrrev_b32 v31, 3, v234
    v_add_u32 v31, 24, v31
    v_lshrrev_b32 v65, s66, v31
    v_mad_u32_u24 v31, v65, s65, v31
    v_mad_u32_u24 v31, v31, s68, v71
    v_subrev_u32 v31, 3072, v31
    s_mul_i32 s64, s64, 1280
    s_lshl_b32 s65, s91, 7
    s_add_u32 s64, s64, s65
    s_mov_b32 m0, s87
    v_cndmask_b32 v64, v69, v70, vcc
    buffer_load_dwordx4 v28, s[36:39], s64 offen offset:0 lds
    buffer_load_dwordx4 v29, s[36:39], s64 offen offset:1024 lds
    buffer_load_dwordx4 v30, s[36:39], s64 offen offset:2048 lds
    buffer_load_dwordx4 v31, s[36:39], s64 offen offset:3072 lds
    v_add_u32 v65, s67, v64
    s_lshl_b32 s71, s73, 7
    s_add_u32 s71, s71, 733184
    s_cmp_lg_u32 s46, 0
    s_cmov_b32 s71, 67108864
    s_waitcnt vmcnt(4) lgkmcnt(0)
    s_barrier
    v_mov_b32 v12, s44
    v_mov_b32 v13, s45
    s_mov_b64 exec, 0xffff
    buffer_store_dwordx2 v[12:13], v233, s[32:35], s71 offen sc1
    s_mov_b64 exec, -1
L_pk_87:
    s_waitcnt vmcnt(0)
    ds_read_b64_tr_b16 v[72:73], v64 offset:0
    ds_read_b64_tr_b16 v[74:75], v65 offset:0
    ds_read_b64_tr_b16 v[76:77], v64 offset:32
    ds_read_b64_tr_b16 v[78:79], v65 offset:32
    ds_read_b64_tr_b16 v[80:81], v64 offset:64
    ds_read_b64_tr_b16 v[82:83], v65 offset:64
    ds_read_b64_tr_b16 v[84:85], v64 offset:96
    ds_read_b64_tr_b16 v[86:87], v65 offset:96
    s_mul_i32 s67, s90, 5120
    s_add_u32 s67, s67, s88
    s_lshl2_add_u32 s64, s91, 0
    s_mul_i32 s65, s64, 52429
    s_lshr_b32 s65, s65, 18
    s_mul_i32 s66, s65, 5
    s_sub_u32 s64, s64, s66
    s_mul_i32 s66, s66, s89
    s_add_u32 s64, s64, s66
    s_lshl_b32 s64, s64, 10
    s_add_u32 s64, s64, s67
    s_waitcnt lgkmcnt(6)
    buffer_store_dwordx4 v[72:75], v66, s[32:35], s64 offen sc1
    s_lshl2_add_u32 s64, s91, 1
    s_mul_i32 s65, s64, 52429
    s_lshr_b32 s65, s65, 18
    s_mul_i32 s66, s65, 5
    s_sub_u32 s64, s64, s66
    s_mul_i32 s66, s66, s89
    s_add_u32 s64, s64, s66
    s_lshl_b32 s64, s64, 10
    s_add_u32 s64, s64, s67
    s_waitcnt lgkmcnt(4)
    buffer_store_dwordx4 v[76:79], v66, s[32:35], s64 offen sc1
    s_lshl2_add_u32 s64, s91, 2
    s_mul_i32 s65, s64, 52429
    s_lshr_b32 s65, s65, 18
    s_mul_i32 s66, s65, 5
    s_sub_u32 s64, s64, s66
    s_mul_i32 s66, s66, s89
    s_add_u32 s64, s64, s66
    s_lshl_b32 s64, s64, 10
    s_add_u32 s64, s64, s67
    s_waitcnt lgkmcnt(2)
    buffer_store_dwordx4 v[80:83], v66, s[32:35], s64 offen sc1
    s_lshl2_add_u32 s64, s91, 3
    s_mul_i32 s65, s64, 52429
    s_lshr_b32 s65, s65, 18
    s_mul_i32 s66, s65, 5
    s_sub_u32 s64, s64, s66
    s_mul_i32 s66, s66, s89
    s_add_u32 s64, s64, s66
    s_lshl_b32 s64, s64, 10
    s_add_u32 s64, s64, s67
    s_waitcnt lgkmcnt(0)
    buffer_store_dwordx4 v[84:87], v66, s[32:35], s64 offen sc1
    s_add_u32 s86, s86, 256
    s_cmp_ge_u32 s86, 940
    s_cbranch_scc1 L_pk2_88
    s_cmp_lt_u32 s86, 200
    s_cselect_b32 s36, s14, s8
    s_cselect_b32 s37, s15, s9
    s_mov_b64 vcc, 0
    s_mov_b32 s64, 200
    s_cmov_b32 s64, 0
    s_mov_b32 s88, 25722880
    s_cmov_b32 s88, 24903680
    s_mov_b32 s67, 2048
    s_mov_b32 s38, 819200
    s_mov_b32 s39, 0x20000
    s_mov_b32 s89, 20
    s_cmp_ge_u32 s86, 400
    s_cselect_b32 s36, s18, s36
    s_cselect_b32 s37, s19, s37
    s_cmov_b32 s38, 2211840
    s_cmov_b32 s64, 400
    s_cmov_b32 s88, 26542080
    s_cmov_b32 s89, 54
    s_sub_u32 s64, s86, s64
    s_mul_i32 s90, s64, 52429
    s_lshr_b32 s90, s90, 19
    s_mul_i32 s91, s90, 10
    s_sub_u32 s91, s64, s91
    s_lshl_b32 s64, s90, 5
    s_mov_b32 s65, 0
    s_mov_b32 s66, 4
    s_cmp_lg_u32 s88, 25722880
    s_cbranch_scc1 L_pkn_89
    s_mul_i32 s68, s90, 52
    s_lshr_b32 s68, s68, 8
    s_mul_i32 s64, s68, 160
    s_mul_i32 s68, s68, 5
    s_sub_u32 s68, s90, s68
    s_cmp_eq_u32 s68, 4
    s_cbranch_scc1 L_pk4_90
    s_mul_i32 s68, s68, 40
    s_add_u32 s64, s64, s68
    s_mov_b32 s65, 4
    s_mov_b64 vcc, -1
    s_mov_b32 s67, 1024
    s_branch L_pkn_89
L_pk4_90:
    s_add_u32 s64, s64, 16
    s_mov_b32 s65, 16
    s_mov_b32 s66, 2
L_pkn_89:
    s_mov_b32 s68, 1280
    v_lshrrev_b32 v28, 3, v234
    v_add_u32 v28, 0, v28
    v_lshrrev_b32 v65, s66, v28
    v_mad_u32_u24 v28, v65, s65, v28
    v_mad_u32_u24 v28, v28, s68, v71
    v_lshrrev_b32 v29, 3, v234
    v_add_u32 v29, 8, v29
    v_lshrrev_b32 v65, s66, v29
    v_mad_u32_u24 v29, v65, s65, v29
    v_mad_u32_u24 v29, v29, s68, v71
    v_subrev_u32 v29, 1024, v29
    v_lshrrev_b32 v30, 3, v234
    v_add_u32 v30, 16, v30
    v_lshrrev_b32 v65, s66, v30
    v_mad_u32_u24 v30, v65, s65, v30
    v_mad_u32_u24 v30, v30, s68, v71
    v_subrev_u32 v30, 2048, v30
    v_lshrrev_b32 v31, 3, v234
    v_add_u32 v31, 24, v31
    v_lshrrev_b32 v65, s66, v31
    v_mad_u32_u24 v31, v65, s65, v31
    v_mad_u32_u24 v31, v31, s68, v71
    v_subrev_u32 v31, 3072, v31
    s_mul_i32 s64, s64, 1280
    s_lshl_b32 s65, s91, 7
    s_add_u32 s64, s64, s65
    s_mov_b32 m0, s87
    v_cndmask_b32 v64, v69, v70, vcc
    buffer_load_dwordx4 v28, s[36:39], s64 offen offset:0 lds
    buffer_load_dwordx4 v29, s[36:39], s64 offen offset:1024 lds
    buffer_load_dwordx4 v30, s[36:39], s64 offen offset:2048 lds
    buffer_load_dwordx4 v31, s[36:39], s64 offen offset:3072 lds
    v_add_u32 v65, s67, v64
    s_branch L_pk_87
L_pk2_88:
    v_mov_b32 v14, 51200
    v_mov_b32 v15, 0
    ds_write_b32 v14, v15
    s_lshl_b32 s71, s73, 7
    s_add_u32 s71, s71, 729088
    s_cmp_lg_u32 s46, 0
    s_cmov_b32 s71, 67108864
    s_waitcnt vmcnt(0) lgkmcnt(0)
    s_barrier
    v_mov_b32 v12, s44
    v_mov_b32 v13, s45
    s_mov_b64 exec, 0xffff
    buffer_store_dwordx2 v[12:13], v233, s[32:35], s71 offen sc1
    s_mov_b64 exec, -1
    s_lshl2_add_u32 s64, s2, s47
    s_cmp_lg_u32 s64, 1020
    s_cbranch_scc1 L_noep_91
    v_add_u32 v0, 0, v234
    v_lshrrev_b32 v1, 3, v0
    v_and_b32 v0, 7, v0
    v_lshl_add_u32 v0, v1, 5, v0
    v_lshlrev_b32 v0, 7, v0
    v_add_u32 v0, 200704, v0
    s_mov_b32 s59, 0x40000
L_poll_92:
    buffer_load_dwordx2 v[2:3], v0, s[32:35], 0 offen sc1
    s_waitcnt vmcnt(0)
    v_cmp_ne_u64 vcc, s[44:45], v[2:3]
    s_cbranch_vccz L_pdone_93
    s_sleep 4
    s_sub_u32 s59, s59, 1
    s_cbranch_scc0 L_poll_92
    s_or_b32 s58, s58, 256
L_pdone_93:
    v_add_u32 v0, 64, v234
    v_lshrrev_b32 v1, 3, v0
    v_and_b32 v0, 7, v0
    v_lshl_add_u32 v0, v1, 5, v0
    v_lshlrev_b32 v0, 7, v0
    v_add_u32 v0, 200704, v0
    s_mov_b32 s59, 0x40000
L_poll_94:
    buffer_load_dwordx2 v[2:3], v0, s[32:35], 0 offen sc1
    s_waitcnt vmcnt(0)
    v_cmp_ne_u64 vcc, s[44:45], v[2:3]
    s_cbranch_vccz L_pdone_95
    s_sleep 4
    s_sub_u32 s59, s59, 1
    s_cbranch_scc0 L_poll_94
    s_or_b32 s58, s58, 256
L_pdone_95:
    v_add_u32 v0, 128, v234
    v_lshrrev_b32 v1, 3, v0
    v_and_b32 v0, 7, v0
    v_lshl_add_u32 v0, v1, 5, v0
    v_lshlrev_b32 v0, 7, v0
    v_add_u32 v0, 200704, v0
    s_mov_b32 s59, 0x40000
L_poll_96:
    buffer_load_dwordx2 v[2:3], v0, s[32:35], 0 offen sc1
    s_waitcnt vmcnt(0)
    v_cmp_ne_u64 vcc, s[44:45], v[2:3]
    s_cbranch_vccz L_pdone_97
    s_sleep 4
    s_sub_u32 s59, s59, 1
    s_cbranch_scc0 L_poll_96
    s_or_b32 s58, s58, 256
L_pdone_97:
    v_add_u32 v0, 192, v234
    v_lshrrev_b32 v1, 3, v0
    v_and_b32 v0, 7, v0
    v_lshl_add_u32 v0, v1, 5, v0
    v_lshlrev_b32 v0, 7, v0
    v_add_u32 v0, 200704, v0
    s_mov_b32 s59, 0x40000
L_poll_98:
    buffer_load_dwordx2 v[2:3], v0, s[32:35], 0 offen sc1
    s_waitcnt vmcnt(0)
    v_cmp_ne_u64 vcc, s[44:45], v[2:3]
    s_cbranch_vccz L_pdone_99
    s_sleep 4
    s_sub_u32 s59, s59, 1
    s_cbranch_scc0 L_poll_98
    s_or_b32 s58, s58, 256
L_pdone_99:
    s_mov_b32 s64, 0
    v_mov_b32 v2, s44
    v_mov_b32 v3, s45
    s_mov_b64 exec, 0xffff
    buffer_store_dwordx2 v[2:3], v233, s[32:35], s64 offen sc1
    s_mov_b64 exec, -1
L_noep_91:
    s_mov_b32 s93, 67108864
    v_mov_b32 v172, 0
    v_mov_b32 v173, 0
L_t4l0_78:
    s_setprio 0
    s_barrier
    v_lshlrev_b32 v4, 4, v234
    s_waitcnt vmcnt(8)
    v_cmp_ne_u64 vcc, s[44:45], v[172:173]
    s_cbranch_vccz L_w4ok_100
    s_waitcnt vmcnt(0)
    v_mov_b32 v2, s44
    v_mov_b32 v3, s45
    s_mov_b64 exec, 0xffff
    buffer_store_dwordx2 v[2:3], v233, s[32:35], s93 offen sc1
    s_mov_b64 exec, -1
    s_mov_b32 s93, 67108864
    s_mov_b32 s59, 0x40000
L_poll_101:
    buffer_load_dwordx2 v[172:173], v170, s[32:35], 0 offen sc1
    s_waitcnt vmcnt(0)
    v_cmp_ne_u64 vcc, s[44:45], v[172:173]
    s_cbranch_vccz L_pdone_102
    s_sleep 4
    s_sub_u32 s59, s59, 1
    s_cbranch_scc0 L_poll_101
    s_or_b32 s58, s58, 128
L_pdone_102:
L_w4ok_100:
    s_mul_i32 s70, s52, 276480
    s_mul_i32 s64, s47, 7680
    s_add_u32 s70, s70, s64
    s_add_u32 s70, s70, 26542080
    s_mov_b32 s71, s64
    s_mov_b32 s75, 0
    s_mov_b32 s72, 0
    s_mul_i32 s64, s72, 30720
    s_add_u32 s70, s70, s64
    v_add_u32 v6, s71, v4
    s_mov_b32 m0, s71
    s_add_u32 s65, s70, 4096
    buffer_load_dwordx4 v4, s[32:35], s70 offen offset:0 sc1 lds
    buffer_load_dwordx4 v4, s[32:35], s70 offen offset:1024 sc1 lds
    buffer_load_dwordx4 v4, s[32:35], s70 offen offset:2048 sc1 lds
    buffer_load_dwordx4 v4, s[32:35], s70 offen offset:3072 sc1 lds
    s_add_u32 m0, s71, 4096
    s_add_u32 s75, s75, 1
    s_cmp_eq_u32 s75, 5
    s_mov_b32 s64, 30720
    s_cmov_b32 s64, 4294844416
    s_cmov_b32 s75, 0
    buffer_load_dwordx4 v4, s[32:35], s65 offen offset:0 sc1 lds
    buffer_load_dwordx4 v4, s[32:35], s65 offen offset:1024 sc1 lds
    buffer_load_dwordx4 v4, s[32:35], s65 offen offset:2048 sc1 lds
    s_mov_b32 exec_hi, 0
    buffer_load_dwordx4 v4, s[32:35], s65 offen offset:3072 sc1 lds
    s_mov_b32 exec_hi, -1
    s_add_u32 s71, s71, s64
    s_add_u32 s72, s72, 1
    s_cmp_eq_u32 s72, 9
    s_mov_b32 s65, 30720
    s_cmov_b32 s65, 4294721536
    s_add_u32 s70, s70, s65
    s_waitcnt vmcnt(8)
    v_mov_b32 v2, s44
    v_mov_b32 v3, s45
    s_mov_b64 exec, 0xffff
    buffer_store_dwordx2 v[2:3], v233, s[32:35], s93 offen sc1
    s_mov_b64 exec, -1
    s_add_u32 s65, s70, 4096
    buffer_load_dwordx4 v[8:11], v4, s[32:35], s70 offen offset:0 sc1
    buffer_load_dwordx4 v[12:15], v4, s[32:35], s70 offen offset:1024 sc1
    buffer_load_dwordx4 v[16:19], v4, s[32:35], s70 offen offset:2048 sc1
    buffer_load_dwordx4 v[20:23], v4, s[32:35], s70 offen offset:3072 sc1
    buffer_load_dwordx4 v[24:27], v4, s[32:35], s65 offen offset:0 sc1
    buffer_load_dwordx4 v[28:31], v4, s[32:35], s65 offen offset:1024 sc1
    buffer_load_dwordx4 v[32:35], v4, s[32:35], s65 offen offset:2048 sc1
    s_mov_b32 exec_hi, 0
    buffer_load_dwordx4 v[36:39], v4, s[32:35], s65 offen offset:3072 sc1
    s_mov_b32 exec_hi, -1
    s_add_u32 s75, s75, 1
    s_cmp_eq_u32 s75, 5
    s_mov_b32 s64, 30720
    s_cmov_b32 s64, 4294844416
    s_cmov_b32 s75, 0
    s_add_u32 s71, s71, s64
    s_add_u32 s72, s72, 1
    s_cmp_eq_u32 s72, 9
    s_mov_b32 s65, 30720
    s_cmov_b32 s65, 4294721536
    s_add_u32 s70, s70, s65
    s_add_u32 s65, s70, 4096
    buffer_load_dwordx4 v[40:43], v4, s[32:35], s70 offen offset:0 sc1
    buffer_load_dwordx4 v[44:47], v4, s[32:35], s70 offen offset:1024 sc1
    buffer_load_dwordx4 v[48:51], v4, s[32:35], s70 offen offset:2048 sc1
    buffer_load_dwordx4 v[52:55], v4, s[32:35], s70 offen offset:3072 sc1
    buffer_load_dwordx4 v[56:59], v4, s[32:35], s65 offen offset:0 sc1
    buffer_load_dwordx4 v[60:63], v4, s[32:35], s65 offen offset:1024 sc1
    buffer_load_dwordx4 v[64:67], v4, s[32:35], s65 offen offset:2048 sc1
    s_mov_b32 exec_hi, 0
    buffer_load_dwordx4 v[68:71], v4, s[32:35], s65 offen offset:3072 sc1
    s_mov_b32 exec_hi, -1
    s_add_u32 s75, s75, 1
    s_cmp_eq_u32 s75, 5
    s_mov_b32 s64, 30720
    s_cmov_b32 s64, 4294844416
    s_cmov_b32 s75, 0
    s_add_u32 s71, s71, s64
    s_add_u32 s72, s72, 1
    s_cmp_eq_u32 s72, 9
    s_mov_b32 s65, 30720
    s_cmov_b32 s65, 4294721536
    s_add_u32 s70, s70, s65
    s_add_u32 s65, s70, 4096
    buffer_load_dwordx4 v[72:75], v4, s[32:35], s70 offen offset:0 sc1
    buffer_load_dwordx4 v[76:79], v4, s[32:35], s70 offen offset:1024 sc1
    buffer_load_dwordx4 v[80:83], v4, s[32:35], s70 offen offset:2048 sc1
    buffer_load_dwordx4 v[84:87], v4, s[32:35], s70 offen offset:3072 sc1
    buffer_load_dwordx4 v[88:91], v4, s[32:35], s65 offen offset:0 sc1
    buffer_load_dwordx4 v[92:95], v4, s[32:35], s65 offen offset:1024 sc1
    buffer_load_dwordx4 v[96:99], v4, s[32:35], s65 offen offset:2048 sc1
    s_mov_b32 exec_hi, 0
    buffer_load_dwordx4 v[100:103], v4, s[32:35], s65 offen offset:3072 sc1
    s_mov_b32 exec_hi, -1
    s_add_u32 s75, s75, 1
    s_cmp_eq_u32 s75, 5
    s_mov_b32 s64, 30720
    s_cmov_b32 s64, 4294844416
    s_cmov_b32 s75, 0
    s_add_u32 s71, s71, s64
    s_add_u32 s72, s72, 1
    s_cmp_eq_u32 s72, 9
    s_mov_b32 s65, 30720
    s_cmov_b32 s65, 4294721536
    s_add_u32 s70, s70, s65
    s_barrier
    s_mov_b32 m0, s71
    s_add_u32 s65, s70, 4096
    buffer_load_dwordx4 v4, s[32:35], s70 offen offset:0 sc1 lds
    buffer_load_dwordx4 v4, s[32:35], s70 offen offset:1024 sc1 lds
    buffer_load_dwordx4 v4, s[32:35], s70 offen offset:2048 sc1 lds
    buffer_load_dwordx4 v4, s[32:35], s70 offen offset:3072 sc1 lds
    s_add_u32 m0, s71, 4096
    s_add_u32 s75, s75, 1
    s_cmp_eq_u32 s75, 5
    s_mov_b32 s64, 30720
    s_cmov_b32 s64, 4294844416
    s_cmov_b32 s75, 0
    buffer_load_dwordx4 v4, s[32:35], s65 offen offset:0 sc1 lds
    buffer_load_dwordx4 v4, s[32:35], s65 offen offset:1024 sc1 lds
    buffer_load_dwordx4 v4, s[32:35], s65 offen offset:2048 sc1 lds
    s_mov_b32 exec_hi, 0
    buffer_load_dwordx4 v4, s[32:35], s65 offen offset:3072 sc1 lds
    s_mov_b32 exec_hi, -1
    s_add_u32 s71, s71, s64
    s_add_u32 s72, s72, 1
    s_cmp_eq_u32 s72, 9
    s_mov_b32 s65, 30720
    s_cmov_b32 s65, 4294721536
    s_add_u32 s70, s70, s65
    s_waitcnt vmcnt(24)
    v_add_u32 v5, 30720, v6
    ds_write_b128 v5, v[8:11] offset:0
    ds_write_b128 v5, v[12:15] offset:1024
    ds_write_b128 v5, v[16:19] offset:2048
    ds_write_b128 v5, v[20:23] offset:3072
    ds_write_b128 v5, v[24:27] offset:4096
    ds_write_b128 v5, v[28:31] offset:5120
    ds_write_b128 v5, v[32:35] offset:6144
    s_mov_b32 exec_hi, 0
    ds_write_b128 v5, v[36:39] offset:7168
    s_mov_b32 exec_hi, -1
    s_barrier
    s_waitcnt vmcnt(16)
    v_add_u32 v5, 61440, v6
    ds_write_b128 v5, v[40:43] offset:0
    ds_write_b128 v5, v[44:47] offset:1024
    ds_write_b128 v5, v[48:51] offset:2048
    ds_write_b128 v5, v[52:55] offset:3072
    ds_write_b128 v5, v[56:59] offset:4096
    ds_write_b128 v5, v[60:63] offset:5120
    ds_write_b128 v5, v[64:67] offset:6144
    s_mov_b32 exec_hi, 0
    ds_write_b128 v5, v[68:71] offset:7168
    s_mov_b32 exec_hi, -1
    s_waitcnt vmcnt(8)
    v_add_u32 v5, 92160, v6
    ds_write_b128 v5, v[72:75] offset:0
    ds_write_b128 v5, v[76:79] offset:1024
    ds_write_b128 v5, v[80:83] offset:2048
    ds_write_b128 v5, v[84:87] offset:3072
    ds_write_b128 v5, v[88:91] offset:4096
    ds_write_b128 v5, v[92:95] offset:5120
    ds_write_b128 v5, v[96:99] offset:6144
    s_mov_b32 exec_hi, 0
    ds_write_b128 v5, v[100:103] offset:7168
    s_mov_b32 exec_hi, -1
    s_waitcnt lgkmcnt(0)
    s_mov_b32 s57, 1
L_t4l_103:
    s_cmp_ge_u32 s57, 8
    s_cbranch_scc1 L_t4w_105
    s_cmp_eq_u32 s57, 7
    s_cbranch_scc1 L_t4w_106
    s_waitcnt vmcnt(16)
    s_branch L_t4w_108
L_t4w_106:
    s_waitcnt vmcnt(8)
    s_branch L_t4w_108
L_t4w_105:
    s_waitcnt vmcnt(0)
L_t4w_108:
    s_barrier
    s_sub_u32 s64, s57, 2
    s_cmp_ge_u32 s64, 4
    s_cbranch_scc1 L_t4ni_104
    s_mov_b32 m0, s71
    s_add_u32 s65, s70, 4096
    buffer_load_dwordx4 v4, s[32:35], s70 offen offset:0 sc1 lds
    buffer_load_dwordx4 v4, s[32:35], s70 offen offset:1024 sc1 lds
    buffer_load_dwordx4 v4, s[32:35], s70 offen offset:2048 sc1 lds
    buffer_load_dwordx4 v4, s[32:35], s70 offen offset:3072 sc1 lds
    s_add_u32 m0, s71, 4096
    s_add_u32 s75, s75, 1
    s_cmp_eq_u32 s75, 5
    s_mov_b32 s64, 30720
    s_cmov_b32 s64, 4294844416
    s_cmov_b32 s75, 0
    buffer_load_dwordx4 v4, s[32:35], s65 offen offset:0 sc1 lds
    buffer_load_dwordx4 v4, s[32:35], s65 offen offset:1024 sc1 lds
    buffer_load_dwordx4 v4, s[32:35], s65 offen offset:2048 sc1 lds
    s_mov_b32 exec_hi, 0
    buffer_load_dwordx4 v4, s[32:35], s65 offen offset:3072 sc1 lds
    s_mov_b32 exec_hi, -1
    s_add_u32 s71, s71, s64
    s_add_u32 s72, s72, 1
    s_cmp_eq_u32 s72, 9
    s_mov_b32 s65, 30720
    s_cmov_b32 s65, 4294721536
    s_add_u32 s70, s70, s65
L_t4ni_104:
    s_add_u32 s57, s57, 1
    s_cmp_lt_u32 s57, 10
    s_cbranch_scc1 L_t4l_103
    s_barrier
    s_branch L_FIN
L_T3_L:
    s_setprio 0
    s_lshl_b32 s64, s54, 1
    s_add_u32 s64, s64, 40
    s_lshl2_add_u32 s65, s51, s47
    s_lshr_b32 s65, s65, 1
    s_lshl_b32 s65, s65, 12
    s_add_u32 s65, s65, 331776
    v_and_b32 v0, 31, v234
    v_lshl_add_u32 v0, v0, 7, s65
    s_min_u32 s65, s47, 1
    s_mul_i32 s66, s65, 1
    s_add_u32 s64, s64, s66
    s_mul_i32 s64, s64, 2560
    s_add_u32 s64, s64, 1376256
    v_lshl_add_u32 v5, v234, 2, s64
    s_lshl_b32 s65, s65, 9
    s_add_u32 s65, s65, 109056
    v_lshl_add_u32 v7, v234, 3, s65
    s_lshl2_add_u32 s64, s53, s47
    s_lshl_b32 s64, s64, 5
    v_and_b32 v6, 31, v234
    v_add_u32 v4, s64, v6
    v_lshlrev_b32 v4, 3, v4
    v_lshrrev_b32 v3, 5, v234
    v_lshl_add_u32 v4, v3, 16, v4
    v_add_u32 v4, 1572864, v4
    s_lshl_b32 s64, s47, 5
    v_add_u32 v6, s64, v6
    s_mov_b32 s57, 0
    v_and_b32 v26, 31, v234
    v_lshlrev_b32 v26, 7, v26
    v_add_u32 v26, 733184, v26
    s_cmp_eq_u32 s61, 0
    s_cbranch_scc1 L_no3l_109
    s_add_u32 s71, s71, 884736
    s_sub_u32 s73, s73, 16384
    s_mov_b32 s75, 0
    s_waitcnt vmcnt(12)
    s_barrier
L_lloop_111:
    s_cmp_lg_u32 s57, 7
    s_cbranch_scc1 L_lh_113
    buffer_load_dwordx2 v[2:3], v0, s[32:35], 0 offen sc1
    buffer_load_dwordx2 v[28:29], v26, s[32:35], 0 offen sc1
L_lh_113:
    s_mov_b32 m0, s72
    s_add_u32 s74, s74, 1
    s_cmp_eq_u32 s74, 3
    s_mov_b32 s64, 16384
    s_cmov_b32 s64, 4294934528
    s_cmov_b32 s74, 0
    buffer_load_dwordx4 v226, s[32:35], s70 offen offset:0 sc1 lds
    buffer_load_dwordx4 v226, s[32:35], s70 offen offset:1024 sc1 lds
    buffer_load_dwordx4 v227, s[32:35], s70 offen offset:2048 sc1 lds
    buffer_load_dwordx4 v227, s[32:35], s70 offen offset:3072 sc1 lds
    s_add_u32 s72, s72, s64
    s_add_u32 s70, s70, 2048
    s_cmp_ge_u32 s57, 6
    s_cbranch_scc1 L_lh_114
    s_mov_b32 m0, s73
    s_add_u32 s75, s75, 1
    s_cmp_eq_u32 s75, 5
    s_mov_b32 s64, 16384
    s_cmov_b32 s64, 4294901760
    s_cmov_b32 s75, 0
    buffer_load_dwordx4 v230, s[36:39], s71 offen offset:0 lds
    buffer_load_dwordx4 v231, s[36:39], s71 offen offset:1024 lds
    s_add_u32 m0, s73, 8192
    s_add_u32 s65, s71, 128
    buffer_load_dwordx4 v230, s[36:39], s65 offen offset:0 lds
    buffer_load_dwordx4 v231, s[36:39], s65 offen offset:1024 lds
    s_add_u32 s73, s73, s64
    s_add_u32 s71, s71, 221184
    s_waitcnt vmcnt(10)
    s_cmp_lg_u32 s57, 1
    s_cbranch_scc1 L_lwd_112
    s_lshl3_add_u32 s64, s62, s46
    s_lshl_b32 s64, s64, 5
    s_add_u32 s64, s64, s63
    s_lshl_b32 s64, s64, 7
    s_add_u32 s64, s64, 331776
    v_mov_b32 v32, s44
    v_mov_b32 v33, s45
    s_mov_b64 exec, 0xffff
    buffer_store_dwordx2 v[32:33], v233, s[32:35], s64 offen sc1
    s_mov_b64 exec, -1
    s_branch L_lwd_112
L_lh_114:
    s_cmp_eq_u32 s57, 7
    s_cbranch_scc1 L_lh_115
    s_waitcnt vmcnt(8)
    s_branch L_lwd_112
L_lh_115:
    s_waitcnt vmcnt(6)
L_lwd_112:
    s_barrier
    s_add_u32 s57, s57, 1
    s_cmp_lt_u32 s57, 8
    s_cbranch_scc1 L_lloop_111
    s_waitcnt vmcnt(4)
    v_cmp_ne_u64 vcc, s[44:45], v[2:3]
    s_cbranch_vccz L_lok_121
    s_mov_b32 s59, 0x40000
L_poll_122:
    buffer_load_dwordx2 v[2:3], v0, s[32:35], 0 offen sc1
    s_waitcnt vmcnt(0)
    v_cmp_ne_u64 vcc, s[44:45], v[2:3]
    s_cbranch_vccz L_pdone_123
    s_sleep 4
    s_sub_u32 s59, s59, 1
    s_cbranch_scc0 L_poll_122
    s_or_b32 s58, s58, 512
L_pdone_123:
L_lok_121:
    v_cmp_ne_u64 vcc, s[44:45], v[28:29]
    s_cbranch_vccz L_lok_124
    s_mov_b32 s59, 0x40000
L_poll_125:
    buffer_load_dwordx2 v[28:29], v26, s[32:35], 0 offen sc1
    s_waitcnt vmcnt(0)
    v_cmp_ne_u64 vcc, s[44:45], v[28:29]
    s_cbranch_vccz L_pdone_126
    s_sleep 4
    s_sub_u32 s59, s59, 1
    s_cbranch_scc0 L_poll_125
    s_or_b32 s58, s58, 2
L_pdone_126:
L_lok_124:
    v_add_f32 v8, v216, v218
    v_add_f32 v9, v217, v219
    v_add_f32 v12, v220, v222
    v_add_f32 v13, v221, v223
    v_add_f32 v12, v8, v12
    v_add_f32 v14, v9, v13
    v_mov_b32 v13, v12
    v_mov_b32 v15, v14
    s_nop 0
    v_permlane32_swap_b32 v12, v13
    v_permlane32_swap_b32 v14, v15
    v_add_f32 v12, v12, v13
    v_add_f32 v14, v14, v15
    v_mul_f32 v12, 0x3acccccd, v12
    v_mul_f32 v14, 0x3acccccd, v14
    v_fma_f32 v14, -v12, v12, v14
    v_max_f32 v14, 0, v14
    v_add_f32 v13, 0x3727c5ac, v14
    v_rsq_f32 v10, v13
    v_cvt_pk_bf16_f32 v8, -v12, -v12
    v_lshlrev_b32 v13, 16, v8
    v_add_f32_e64 v13, -v12, -v13
    v_cvt_pk_bf16_f32 v9, v13, 0
    v_mov_b32 v11, v10
    v_and_b32 v222, 15, v234
    v_lshrrev_b32 v221, 4, v234
    v_lshlrev_b32 v222, 3, v222
    v_lshl_add_u32 v222, v221, 7, v222
    v_lshlrev_b32 v223, 4, v234
    s_lshl2_add_u32 s94, s51, s47
    s_mul_i32 s94, s94, 20480
    s_mul_i32 s64, s56, 10240
    s_add_u32 s94, s94, s64
    s_add_u32 s94, s94, 15204352
    s_mul_i32 s64, s56, 4294926336
    s_add_u32 s64, s64, 20480
    s_add_u32 s95, s94, s64
    v_mov_b32 v27, 106496
    v_lshl_add_u32 v30, v6, 4, v27
    ds_write_b128 v30, v[8:11] offset:0
    v_lshlrev_b32 v4, 4, v234
    s_mul_i32 s64, s52, 102400
    s_mul_i32 s65, s47, 7168
    s_add_u32 s64, s64, s65
    s_add_u32 s64, s64, 25722880
    s_add_u32 s65, s65, 61440
    s_mov_b32 m0, s65
    s_nop 0
    buffer_load_dwordx4 v4, s[32:35], s64 offen offset:0 sc1 lds
    buffer_load_dwordx4 v4, s[32:35], s64 offen offset:1024 sc1 lds
    buffer_load_dwordx4 v4, s[32:35], s64 offen offset:2048 sc1 lds
    buffer_load_dwordx4 v4, s[32:35], s64 offen offset:3072 sc1 lds
    s_add_u32 s64, s64, 4096
    s_add_u32 s65, s65, 4096
    s_mov_b32 m0, s65
    s_nop 0
    buffer_load_dwordx4 v4, s[32:35], s64 offen offset:0 sc1 lds
    buffer_load_dwordx4 v4, s[32:35], s64 offen offset:1024 sc1 lds
    buffer_load_dwordx4 v4, s[32:35], s64 offen offset:2048 sc1 lds
    s_waitcnt vmcnt(7)
    s_barrier
    s_mul_i32 s64, s52, 102400
    s_mul_i32 s65, s47, 4096
    s_add_u32 s64, s64, s65
    s_add_u32 s64, s64, 25808896
    s_add_u32 s65, s65, 147456
    s_mov_b32 m0, s65
    s_nop 0
    buffer_load_dwordx4 v4, s[32:35], s64 offen offset:0 sc1 lds
    buffer_load_dwordx4 v4, s[32:35], s64 offen offset:1024 sc1 lds
    buffer_load_dwordx4 v4, s[32:35], s64 offen offset:2048 sc1 lds
    buffer_load_dwordx4 v4, s[32:35], s64 offen offset:3072 sc1 lds
    s_mul_i32 s64, s52, 102400
    s_mul_i32 s65, s47, 4096
    s_add_u32 s64, s64, s65
    s_add_u32 s64, s64, 25751552
    s_add_u32 s65, s65, 90112
    s_mov_b32 m0, s65
    s_nop 0
    buffer_load_dwordx4 v4, s[32:35], s64 offen offset:0 sc1 lds
    buffer_load_dwordx4 v4, s[32:35], s64 offen offset:1024 sc1 lds
    buffer_load_dwordx4 v4, s[32:35], s64 offen offset:2048 sc1 lds
    buffer_load_dwordx4 v4, s[32:35], s64 offen offset:3072 sc1 lds
    s_waitcnt lgkmcnt(0)
    s_barrier
    s_mul_i32 s64, s52, 102400
    s_mul_i32 s65, s47, 4096
    s_add_u32 s64, s64, s65
    s_add_u32 s64, s64, 25776128
    s_add_u32 s65, s65, 114688
    s_mov_b32 m0, s65
    s_nop 0
    buffer_load_dwordx4 v4, s[32:35], s64 offen offset:0 sc1 lds
    buffer_load_dwordx4 v4, s[32:35], s64 offen offset:1024 sc1 lds
    buffer_load_dwordx4 v4, s[32:35], s64 offen offset:2048 sc1 lds
    buffer_load_dwordx4 v4, s[32:35], s64 offen offset:3072 sc1 lds
    s_barrier
    s_mul_i32 s64, s52, 102400
    s_mul_i32 s65, s47, 2048
    s_add_u32 s64, s64, s65
    s_add_u32 s64, s64, 25767936
    s_add_u32 s65, s65, 106496
    s_mov_b32 m0, s65
    s_nop 0
    buffer_load_dwordx4 v4, s[32:35], s64 offen offset:0 sc1 lds
    buffer_load_dwordx4 v4, s[32:35], s64 offen offset:1024 sc1 lds
    s_mul_i32 s64, s52, 102400
    s_mul_i32 s65, s47, 4096
    s_add_u32 s64, s64, s65
    s_add_u32 s64, s64, 25792512
    s_add_u32 s65, s65, 131072
    s_mov_b32 m0, s65
    s_nop 0
    buffer_load_dwordx4 v4, s[32:35], s64 offen offset:0 sc1 lds
    buffer_load_dwordx4 v4, s[32:35], s64 offen offset:1024 sc1 lds
    buffer_load_dwordx4 v4, s[32:35], s64 offen offset:2048 sc1 lds
    buffer_load_dwordx4 v4, s[32:35], s64 offen offset:3072 sc1 lds
    s_branch L_tol_110
L_no3l_109:
    s_sub_u32 s73, s2, 224
    s_lshl3_add_u32 s86, s73, s46
    s_add_u32 s86, s86, 200
    s_lshl_b32 s87, s46, 12
    s_waitcnt vmcnt(2)
    s_barrier
    v_and_b32 v71, 7, v234
    v_lshlrev_b32 v71, 4, v71
    v_lshlrev_b32 v66, 4, v234
    v_bfe_u32 v67, v234, 2, 2
    v_and_b32 v68, 3, v234
    v_lshlrev_b32 v68, 3, v68
    v_lshl_add_u32 v67, v67, 7, v68
    v_add_u32 v67, s87, v67
    v_lshrrev_b32 v68, 4, v234
    v_lshl_add_u32 v69, v68, 9, v67
    v_and_b32 v70, 1, v68
    v_lshl_add_u32 v70, v70, 9, v67
    v_lshrrev_b32 v68, 1, v68
    v_lshl_add_u32 v70, v68, 11, v70
    s_cmp_lt_u32 s86, 200
    s_cselect_b32 s36, s14, s8
    s_cselect_b32 s37, s15, s9
    s_mov_b64 vcc, 0
    s_mov_b32 s64, 200
    s_cmov_b32 s64, 0
    s_mov_b32 s88, 25722880
    s_cmov_b32 s88, 24903680
    s_mov_b32 s67, 2048
    s_mov_b32 s38, 819200
    s_mov_b32 s39, 0x20000
    s_mov_b32 s89, 20
    s_cmp_ge_u32 s86, 400
    s_cselect_b32 s36, s18, s36
    s_cselect_b32 s37, s19, s37
    s_cmov_b32 s38, 2211840
    s_cmov_b32 s64, 400
    s_cmov_b32 s88, 26542080
    s_cmov_b32 s89, 54
    s_sub_u32 s64, s86, s64
    s_mul_i32 s90, s64, 52429
    s_lshr_b32 s90, s90, 19
    s_mul_i32 s91, s90, 10
    s_sub_u32 s91, s64, s91
    s_lshl_b32 s64, s90, 5
    s_mov_b32 s65, 0
    s_mov_b32 s66, 4
    s_cmp_lg_u32 s88, 25722880
    s_cbranch_scc1 L_pkn_127
    s_mul_i32 s68, s90, 52
    s_lshr_b32 s68, s68, 8
    s_mul_i32 s64, s68, 160
    s_mul_i32 s68, s68, 5
    s_sub_u32 s68, s90, s68
    s_cmp_eq_u32 s68, 4
    s_cbranch_scc1 L_pk4_128
    s_mul_i32 s68, s68, 40
    s_add_u32 s64, s64, s68
    s_mov_b32 s65, 4
    s_mov_b64 vcc, -1
    s_mov_b32 s67, 1024
    s_branch L_pkn_127
L_pk4_128:
    s_add_u32 s64, s64, 16
    s_mov_b32 s65, 16
    s_mov_b32 s66, 2
L_pkn_127:
    s_mov_b32 s68, 1280
    v_lshrrev_b32 v28, 3, v234
    v_add_u32 v28, 0, v28
    v_lshrrev_b32 v65, s66, v28
    v_mad_u32_u24 v28, v65, s65, v28
    v_mad_u32_u24 v28, v28, s68, v71
    v_lshrrev_b32 v29, 3, v234
    v_add_u32 v29, 8, v29
    v_lshrrev_b32 v65, s66, v29
    v_mad_u32_u24 v29, v65, s65, v29
    v_mad_u32_u24 v29, v29, s68, v71
    v_subrev_u32 v29, 1024, v29
    v_lshrrev_b32 v30, 3, v234
    v_add_u32 v30, 16, v30
    v_lshrrev_b32 v65, s66, v30
    v_mad_u32_u24 v30, v65, s65, v30
    v_mad_u32_u24 v30, v30, s68, v71
    v_subrev_u32 v30, 2048, v30
    v_lshrrev_b32 v31, 3, v234
    v_add_u32 v31, 24, v31
    v_lshrrev_b32 v65, s66, v31
    v_mad_u32_u24 v31, v65, s65, v31
    v_mad_u32_u24 v31, v31, s68, v71
    v_subrev_u32 v31, 3072, v31
    s_mul_i32 s64, s64, 1280
    s_lshl_b32 s65, s91, 7
    s_add_u32 s64, s64, s65
    s_mov_b32 m0, s87
    v_cndmask_b32 v64, v69, v70, vcc
    buffer_load_dwordx4 v28, s[36:39], s64 offen offset:0 lds
    buffer_load_dwordx4 v29, s[36:39], s64 offen offset:1024 lds
    buffer_load_dwordx4 v30, s[36:39], s64 offen offset:2048 lds
    buffer_load_dwordx4 v31, s[36:39], s64 offen offset:3072 lds
    v_add_u32 v65, s67, v64
    s_waitcnt vmcnt(4)
    s_lshl3_add_u32 s64, s62, s46
    s_lshl_b32 s64, s64, 5
    s_add_u32 s64, s64, s63
    s_lshl_b32 s64, s64, 7
    s_add_u32 s64, s64, 331776
    v_mov_b32 v32, s44
    v_mov_b32 v33, s45
    s_mov_b64 exec, 0xffff
    buffer_store_dwordx2 v[32:33], v233, s[32:35], s64 offen sc1
    s_mov_b64 exec, -1
    s_waitcnt vmcnt(0)
    ds_read_b64_tr_b16 v[72:73], v64 offset:0
    ds_read_b64_tr_b16 v[74:75], v65 offset:0
    ds_read_b64_tr_b16 v[76:77], v64 offset:32
    ds_read_b64_tr_b16 v[78:79], v65 offset:32
    ds_read_b64_tr_b16 v[80:81], v64 offset:64
    ds_read_b64_tr_b16 v[82:83], v65 offset:64
    ds_read_b64_tr_b16 v[84:85], v64 offset:96
    ds_read_b64_tr_b16 v[86:87], v65 offset:96
    s_mul_i32 s67, s90, 5120
    s_add_u32 s67, s67, s88
    s_lshl2_add_u32 s64, s91, 0
    s_mul_i32 s65, s64, 52429
    s_lshr_b32 s65, s65, 18
    s_mul_i32 s66, s65, 5
    s_sub_u32 s64, s64, s66
    s_mul_i32 s66, s66, s89
    s_add_u32 s64, s64, s66
    s_lshl_b32 s64, s64, 10
    s_add_u32 s64, s64, s67
    s_waitcnt lgkmcnt(6)
    buffer_store_dwordx4 v[72:75], v66, s[32:35], s64 offen sc1
    s_lshl2_add_u32 s64, s91, 1
    s_mul_i32 s65, s64, 52429
    s_lshr_b32 s65, s65, 18
    s_mul_i32 s66, s65, 5
    s_sub_u32 s64, s64, s66
    s_mul_i32 s66, s66, s89
    s_add_u32 s64, s64, s66
    s_lshl_b32 s64, s64, 10
    s_add_u32 s64, s64, s67
    s_waitcnt lgkmcnt(4)
    buffer_store_dwordx4 v[76:79], v66, s[32:35], s64 offen sc1
    s_lshl2_add_u32 s64, s91, 2
    s_mul_i32 s65, s64, 52429
    s_lshr_b32 s65, s65, 18
    s_mul_i32 s66, s65, 5
    s_sub_u32 s64, s64, s66
    s_mul_i32 s66, s66, s89
    s_add_u32 s64, s64, s66
    s_lshl_b32 s64, s64, 10
    s_add_u32 s64, s64, s67
    s_waitcnt lgkmcnt(2)
    buffer_store_dwordx4 v[80:83], v66, s[32:35], s64 offen sc1
    s_lshl2_add_u32 s64, s91, 3
    s_mul_i32 s65, s64, 52429
    s_lshr_b32 s65, s65, 18
    s_mul_i32 s66, s65, 5
    s_sub_u32 s64, s64, s66
    s_mul_i32 s66, s66, s89
    s_add_u32 s64, s64, s66
    s_lshl_b32 s64, s64, 10
    s_add_u32 s64, s64, s67
    s_waitcnt lgkmcnt(0)
    buffer_store_dwordx4 v[84:87], v66, s[32:35], s64 offen sc1
    s_add_u32 s86, s86, 256
    s_cmp_lt_u32 s86, 200
    s_cselect_b32 s36, s14, s8
    s_cselect_b32 s37, s15, s9
    s_mov_b64 vcc, 0
    s_mov_b32 s64, 200
    s_cmov_b32 s64, 0
    s_mov_b32 s88, 25722880
    s_cmov_b32 s88, 24903680
    s_mov_b32 s67, 2048
    s_mov_b32 s38, 819200
    s_mov_b32 s39, 0x20000
    s_mov_b32 s89, 20
    s_cmp_ge_u32 s86, 400
    s_cselect_b32 s36, s18, s36
    s_cselect_b32 s37, s19, s37
    s_cmov_b32 s38, 2211840
    s_cmov_b32 s64, 400
    s_cmov_b32 s88, 26542080
    s_cmov_b32 s89, 54
    s_sub_u32 s64, s86, s64
    s_mul_i32 s90, s64, 52429
    s_lshr_b32 s90, s90, 19
    s_mul_i32 s91, s90, 10
    s_sub_u32 s91, s64, s91
    s_lshl_b32 s64, s90, 5
    s_mov_b32 s65, 0
    s_mov_b32 s66, 4
    s_cmp_lg_u32 s88, 25722880
    s_cbranch_scc1 L_pkn_129
    s_mul_i32 s68, s90, 52
    s_lshr_b32 s68, s68, 8
    s_mul_i32 s64, s68, 160
    s_mul_i32 s68, s68, 5
    s_sub_u32 s68, s90, s68
    s_cmp_eq_u32 s68, 4
    s_cbranch_scc1 L_pk4_130
    s_mul_i32 s68, s68, 40
    s_add_u32 s64, s64, s68
    s_mov_b32 s65, 4
    s_mov_b64 vcc, -1
    s_mov_b32 s67, 1024
    s_branch L_pkn_129
L_pk4_130:
    s_add_u32 s64, s64, 16
    s_mov_b32 s65, 16
    s_mov_b32 s66, 2
L_pkn_129:
    s_mov_b32 s68, 1280
    v_lshrrev_b32 v28, 3, v234
    v_add_u32 v28, 0, v28
    v_lshrrev_b32 v65, s66, v28
    v_mad_u32_u24 v28, v65, s65, v28
    v_mad_u32_u24 v28, v28, s68, v71
    v_lshrrev_b32 v29, 3, v234
    v_add_u32 v29, 8, v29
    v_lshrrev_b32 v65, s66, v29
    v_mad_u32_u24 v29, v65, s65, v29
    v_mad_u32_u24 v29, v29, s68, v71
    v_subrev_u32 v29, 1024, v29
    v_lshrrev_b32 v30, 3, v234
    v_add_u32 v30, 16, v30
    v_lshrrev_b32 v65, s66, v30
    v_mad_u32_u24 v30, v65, s65, v30
    v_mad_u32_u24 v30, v30, s68, v71
    v_subrev_u32 v30, 2048, v30
    v_lshrrev_b32 v31, 3, v234
    v_add_u32 v31, 24, v31
    v_lshrrev_b32 v65, s66, v31
    v_mad_u32_u24 v31, v65, s65, v31
    v_mad_u32_u24 v31, v31, s68, v71
    v_subrev_u32 v31, 3072, v31
    s_mul_i32 s64, s64, 1280
    s_lshl_b32 s65, s91, 7
    s_add_u32 s64, s64, s65
    s_mov_b32 m0, s87
    v_cndmask_b32 v64, v69, v70, vcc
    buffer_load_dwordx4 v28, s[36:39], s64 offen offset:0 lds
    buffer_load_dwordx4 v29, s[36:39], s64 offen offset:1024 lds
    buffer_load_dwordx4 v30, s[36:39], s64 offen offset:2048 lds
    buffer_load_dwordx4 v31, s[36:39], s64 offen offset:3072 lds
    v_add_u32 v65, s67, v64
    s_lshl_b32 s71, s73, 7
    s_add_u32 s71, s71, 733184
    s_cmp_lg_u32 s46, 0
    s_cmov_b32 s71, 67108864
    s_waitcnt vmcnt(4) lgkmcnt(0)
    s_barrier
    v_mov_b32 v12, s44
    v_mov_b32 v13, s45
    s_mov_b64 exec, 0xffff
    buffer_store_dwordx2 v[12:13], v233, s[32:35], s71 offen sc1
    s_mov_b64 exec, -1
L_pk_131:
    s_waitcnt vmcnt(0)
    ds_read_b64_tr_b16 v[72:73], v64 offset:0
    ds_read_b64_tr_b16 v[74:75], v65 offset:0
    ds_read_b64_tr_b16 v[76:77], v64 offset:32
    ds_read_b64_tr_b16 v[78:79], v65 offset:32
    ds_read_b64_tr_b16 v[80:81], v64 offset:64
    ds_read_b64_tr_b16 v[82:83], v65 offset:64
    ds_read_b64_tr_b16 v[84:85], v64 offset:96
    ds_read_b64_tr_b16 v[86:87], v65 offset:96
    s_mul_i32 s67, s90, 5120
    s_add_u32 s67, s67, s88
    s_lshl2_add_u32 s64, s91, 0
    s_mul_i32 s65, s64, 52429
    s_lshr_b32 s65, s65, 18
    s_mul_i32 s66, s65, 5
    s_sub_u32 s64, s64, s66
    s_mul_i32 s66, s66, s89
    s_add_u32 s64, s64, s66
    s_lshl_b32 s64, s64, 10
    s_add_u32 s64, s64, s67
    s_waitcnt lgkmcnt(6)
    buffer_store_dwordx4 v[72:75], v66, s[32:35], s64 offen sc1
    s_lshl2_add_u32 s64, s91, 1
    s_mul_i32 s65, s64, 52429
    s_lshr_b32 s65, s65, 18
    s_mul_i32 s66, s65, 5
    s_sub_u32 s64, s64, s66
    s_mul_i32 s66, s66, s89
    s_add_u32 s64, s64, s66
    s_lshl_b32 s64, s64, 10
    s_add_u32 s64, s64, s67
    s_waitcnt lgkmcnt(4)
    buffer_store_dwordx4 v[76:79], v66, s[32:35], s64 offen sc1
    s_lshl2_add_u32 s64, s91, 2
    s_mul_i32 s65, s64, 52429
    s_lshr_b32 s65, s65, 18
    s_mul_i32 s66, s65, 5
    s_sub_u32 s64, s64, s66
    s_mul_i32 s66, s66, s89
    s_add_u32 s64, s64, s66
    s_lshl_b32 s64, s64, 10
    s_add_u32 s64, s64, s67
    s_waitcnt lgkmcnt(2)
    buffer_store_dwordx4 v[80:83], v66, s[32:35], s64 offen sc1
    s_lshl2_add_u32 s64, s91, 3
    s_mul_i32 s65, s64, 52429
    s_lshr_b32 s65, s65, 18
    s_mul_i32 s66, s65, 5
    s_sub_u32 s64, s64, s66
    s_mul_i32 s66, s66, s89
    s_add_u32 s64, s64, s66
    s_lshl_b32 s64, s64, 10
    s_add_u32 s64, s64, s67
    s_waitcnt lgkmcnt(0)
    buffer_store_dwordx4 v[84:87], v66, s[32:35], s64 offen sc1
    s_add_u32 s86, s86, 256
    s_cmp_ge_u32 s86, 940
    s_cbranch_scc1 L_pk2_132
    s_cmp_lt_u32 s86, 200
    s_cselect_b32 s36, s14, s8
    s_cselect_b32 s37, s15, s9
    s_mov_b64 vcc, 0
    s_mov_b32 s64, 200
    s_cmov_b32 s64, 0
    s_mov_b32 s88, 25722880
    s_cmov_b32 s88, 24903680
    s_mov_b32 s67, 2048
    s_mov_b32 s38, 819200
    s_mov_b32 s39, 0x20000
    s_mov_b32 s89, 20
    s_cmp_ge_u32 s86, 400
    s_cselect_b32 s36, s18, s36
    s_cselect_b32 s37, s19, s37
    s_cmov_b32 s38, 2211840
    s_cmov_b32 s64, 400
    s_cmov_b32 s88, 26542080
    s_cmov_b32 s89, 54
    s_sub_u32 s64, s86, s64
    s_mul_i32 s90, s64, 52429
    s_lshr_b32 s90, s90, 19
    s_mul_i32 s91, s90, 10
    s_sub_u32 s91, s64, s91
    s_lshl_b32 s64, s90, 5
    s_mov_b32 s65, 0
    s_mov_b32 s66, 4
    s_cmp_lg_u32 s88, 25722880
    s_cbranch_scc1 L_pkn_133
    s_mul_i32 s68, s90, 52
    s_lshr_b32 s68, s68, 8
    s_mul_i32 s64, s68, 160
    s_mul_i32 s68, s68, 5
    s_sub_u32 s68, s90, s68
    s_cmp_eq_u32 s68, 4
    s_cbranch_scc1 L_pk4_134
    s_mul_i32 s68, s68, 40
    s_add_u32 s64, s64, s68
    s_mov_b32 s65, 4
    s_mov_b64 vcc, -1
    s_mov_b32 s67, 1024
    s_branch L_pkn_133
L_pk4_134:
    s_add_u32 s64, s64, 16
    s_mov_b32 s65, 16
    s_mov_b32 s66, 2
L_pkn_133:
    s_mov_b32 s68, 1280
    v_lshrrev_b32 v28, 3, v234
    v_add_u32 v28, 0, v28
    v_lshrrev_b32 v65, s66, v28
    v_mad_u32_u24 v28, v65, s65, v28
    v_mad_u32_u24 v28, v28, s68, v71
    v_lshrrev_b32 v29, 3, v234
    v_add_u32 v29, 8, v29
    v_lshrrev_b32 v65, s66, v29
    v_mad_u32_u24 v29, v65, s65, v29
    v_mad_u32_u24 v29, v29, s68, v71
    v_subrev_u32 v29, 1024, v29
    v_lshrrev_b32 v30, 3, v234
    v_add_u32 v30, 16, v30
    v_lshrrev_b32 v65, s66, v30
    v_mad_u32_u24 v30, v65, s65, v30
    v_mad_u32_u24 v30, v30, s68, v71
    v_subrev_u32 v30, 2048, v30
    v_lshrrev_b32 v31, 3, v234
    v_add_u32 v31, 24, v31
    v_lshrrev_b32 v65, s66, v31
    v_mad_u32_u24 v31, v65, s65, v31
    v_mad_u32_u24 v31, v31, s68, v71
    v_subrev_u32 v31, 3072, v31
    s_mul_i32 s64, s64, 1280
    s_lshl_b32 s65, s91, 7
    s_add_u32 s64, s64, s65
    s_mov_b32 m0, s87
    v_cndmask_b32 v64, v69, v70, vcc
    buffer_load_dwordx4 v28, s[36:39], s64 offen offset:0 lds
    buffer_load_dwordx4 v29, s[36:39], s64 offen offset:1024 lds
    buffer_load_dwordx4 v30, s[36:39], s64 offen offset:2048 lds
    buffer_load_dwordx4 v31, s[36:39], s64 offen offset:3072 lds
    v_add_u32 v65, s67, v64
    s_branch L_pk_131
L_pk2_132:
    v_mov_b32 v14, 51200
    v_mov_b32 v15, 0
    ds_write_b32 v14, v15
    s_lshl_b32 s71, s73, 7
    s_add_u32 s71, s71, 729088
    s_cmp_lg_u32 s46, 0
    s_cmov_b32 s71, 67108864
    s_waitcnt vmcnt(0) lgkmcnt(0)
    s_barrier
    v_mov_b32 v12, s44
    v_mov_b32 v13, s45
    s_mov_b64 exec, 0xffff
    buffer_store_dwordx2 v[12:13], v233, s[32:35], s71 offen sc1
    s_mov_b64 exec, -1
    s_mov_b32 s59, 0x40000
L_poll_135:
    buffer_load_dwordx2 v[2:3], v0, s[32:35], 0 offen sc1
    s_waitcnt vmcnt(0)
    v_cmp_ne_u64 vcc, s[44:45], v[2:3]
    s_cbranch_vccz L_pdone_136
    s_sleep 4
    s_sub_u32 s59, s59, 1
    s_cbranch_scc0 L_poll_135
    s_or_b32 s58, s58, 16
L_pdone_136:
    s_mov_b32 s59, 0x40000
L_poll_137:
    buffer_load_dwordx2 v[2:3], v26, s[32:35], 0 offen sc1
    s_waitcnt vmcnt(0)
    v_cmp_ne_u64 vcc, s[44:45], v[2:3]
    s_cbranch_vccz L_pdone_138
    s_sleep 4
    s_sub_u32 s59, s59, 1
    s_cbranch_scc0 L_poll_137
    s_or_b32 s58, s58, 64
L_pdone_138:
    v_lshlrev_b32 v4, 4, v234
    s_mul_i32 s64, s52, 102400
    s_mul_i32 s65, s47, 25600
    s_add_u32 s64, s64, s65
    s_add_u32 s64, s64, 25722880
    s_add_u32 s65, s65, 61440
    s_mov_b32 m0, s65
    s_nop 0
    buffer_load_dwordx4 v4, s[32:35], s64 offen offset:0 sc1 lds
    buffer_load_dwordx4 v4, s[32:35], s64 offen offset:1024 sc1 lds
    buffer_load_dwordx4 v4, s[32:35], s64 offen offset:2048 sc1 lds
    buffer_load_dwordx4 v4, s[32:35], s64 offen offset:3072 sc1 lds
    s_add_u32 s64, s64, 4096
    s_add_u32 s65, s65, 4096
    s_mov_b32 m0, s65
    s_nop 0
    buffer_load_dwordx4 v4, s[32:35], s64 offen offset:0 sc1 lds
    buffer_load_dwordx4 v4, s[32:35], s64 offen offset:1024 sc1 lds
    buffer_load_dwordx4 v4, s[32:35], s64 offen offset:2048 sc1 lds
    buffer_load_dwordx4 v4, s[32:35], s64 offen offset:3072 sc1 lds
    s_add_u32 s64, s64, 4096
    s_add_u32 s65, s65, 4096
    s_mov_b32 m0, s65
    s_nop 0
    buffer_load_dwordx4 v4, s[32:35], s64 offen offset:0 sc1 lds
    buffer_load_dwordx4 v4, s[32:35], s64 offen offset:1024 sc1 lds
    buffer_load_dwordx4 v4, s[32:35], s64 offen offset:2048 sc1 lds
    buffer_load_dwordx4 v4, s[32:35], s64 offen offset:3072 sc1 lds
    s_add_u32 s64, s64, 4096
    s_add_u32 s65, s65, 4096
    s_mov_b32 m0, s65
    s_nop 0
    buffer_load_dwordx4 v4, s[32:35], s64 offen offset:0 sc1 lds
    buffer_load_dwordx4 v4, s[32:35], s64 offen offset:1024 sc1 lds
    buffer_load_dwordx4 v4, s[32:35], s64 offen offset:2048 sc1 lds
    buffer_load_dwordx4 v4, s[32:35], s64 offen offset:3072 sc1 lds
    s_add_u32 s64, s64, 4096
    s_add_u32 s65, s65, 4096
    s_mov_b32 m0, s65
    s_nop 0
    buffer_load_dwordx4 v4, s[32:35], s64 offen offset:0 sc1 lds
    buffer_load_dwordx4 v4, s[32:35], s64 offen offset:1024 sc1 lds
    buffer_load_dwordx4 v4, s[32:35], s64 offen offset:2048 sc1 lds
    buffer_load_dwordx4 v4, s[32:35], s64 offen offset:3072 sc1 lds
    s_add_u32 s64, s64, 4096
    s_add_u32 s65, s65, 4096
    s_mov_b32 m0, s65
    s_nop 0
    buffer_load_dwordx4 v4, s[32:35], s64 offen offset:0 sc1 lds
    buffer_load_dwordx4 v4, s[32:35], s64 offen offset:1024 sc1 lds
    buffer_load_dwordx4 v4, s[32:35], s64 offen offset:2048 sc1 lds
    buffer_load_dwordx4 v4, s[32:35], s64 offen offset:3072 sc1 lds
    s_add_u32 s64, s64, 4096
    s_add_u32 s65, s65, 4096
    s_mov_b32 m0, s65
    s_nop 0
    buffer_load_dwordx4 v4, s[32:35], s64 offen offset:0 sc1 lds
    v_and_b32 v222, 15, v234
    v_lshrrev_b32 v221, 4, v234
    v_lshlrev_b32 v222, 3, v222
    v_lshl_add_u32 v222, v221, 7, v222
    v_lshlrev_b32 v223, 4, v234
    s_lshl2_add_u32 s94, s51, s47
    s_mul_i32 s94, s94, 20480
    s_mul_i32 s64, s56, 10240
    s_add_u32 s94, s94, s64
    s_add_u32 s94, s94, 15204352
    s_mul_i32 s64, s56, 4294926336
    s_add_u32 s64, s64, 20480
    s_add_u32 s95, s94, s64
L_tol_110:
    s_setprio 1
    s_add_u32 s64, s94, 0
    s_add_u32 s65, s95, 0
    buffer_load_dwordx4 v[104:107], v223, s[32:35], s64 offen sc1
    buffer_load_dwordx4 v[108:111], v223, s[32:35], s65 offen sc1
    s_add_u32 s64, s94, 1024
    s_add_u32 s65, s95, 1024
    buffer_load_dwordx4 v[112:115], v223, s[32:35], s64 offen sc1
    buffer_load_dwordx4 v[116:119], v223, s[32:35], s65 offen sc1
    s_add_u32 s64, s94, 2048
    s_add_u32 s65, s95, 2048
    buffer_load_dwordx4 v[120:123], v223, s[32:35], s64 offen sc1
    buffer_load_dwordx4 v[124:127], v223, s[32:35], s65 offen sc1
    s_add_u32 s64, s94, 3072
    s_add_u32 s65, s95, 3072
    buffer_load_dwordx4 v[128:131], v223, s[32:35], s64 offen sc1
    buffer_load_dwordx4 v[132:135], v223, s[32:35], s65 offen sc1
    s_add_u32 s64, s94, 4096
    s_add_u32 s65, s95, 4096
    buffer_load_dwordx2 v[136:137], v222, s[32:35], s64 offen offset:0 sc1
    buffer_load_dwordx2 v[138:139], v222, s[32:35], s64 offen offset:512 sc1
    buffer_load_dwordx2 v[140:141], v222, s[32:35], s65 offen offset:0 sc1
    buffer_load_dwordx2 v[142:143], v222, s[32:35], s65 offen offset:512 sc1
    s_add_u32 s64, s94, 5120
    s_add_u32 s65, s95, 5120
    buffer_load_dwordx4 v[144:147], v223, s[32:35], s64 offen sc1
    buffer_load_dwordx4 v[148:151], v223, s[32:35], s65 offen sc1
    s_mul_i32 s64, s56, 51200
    s_add_u32 s64, s64, 61440
    v_add_u32 v216, s64, v4
    s_add_u32 s64, s64, 14336
    s_cmp_eq_u32 s56, 1
    s_cmov_b32 s64, 126976
    v_add_u32 v217, s64, v4
    s_xor_b32 s64, s47, 1
    s_mul_i32 s64, s64, 5120
    s_add_u32 s64, s64, 30720
    v_add_u32 v218, s64, v4
    s_mul_i32 s64, s47, 5120
    s_add_u32 s64, s64, 30720
    v_add_u32 v219, s64, v4
    v_mov_b32 v224, -1
    ds_write_b32 v219, v224 offset:4108
    v_mov_b32 v221, v4
    s_mul_i32 s64, s56, 15360
    v_add_u32 v220, s64, v4
    s_lshl_b32 s64, s51, 12
    s_add_u32 s64, s64, 593920
    v_and_b32 v40, 31, v234
    v_min_u32 v40, 27, v40
    v_lshl_add_u32 v40, v40, 7, s64
    v_lshlrev_b32 v0, 16, v246
    v_and_b32 v1, 0xffff0000, v246
    v_lshlrev_b32 v2, 16, v247
    v_and_b32 v3, 0xffff0000, v247
    v_lshlrev_b32 v4, 16, v248
    v_and_b32 v5, 0xffff0000, v248
    v_lshlrev_b32 v6, 16, v249
    v_and_b32 v7, 0xffff0000, v249
    v_lshlrev_b32 v8, 16, v250
    v_and_b32 v9, 0xffff0000, v250
    v_lshlrev_b32 v10, 16, v251
    v_and_b32 v11, 0xffff0000, v251
    v_lshlrev_b32 v12, 16, v252
    v_and_b32 v13, 0xffff0000, v252
    v_lshlrev_b32 v14, 16, v253
    v_and_b32 v15, 0xffff0000, v253
    v_lshlrev_b32 v16, 16, v254
    v_and_b32 v17, 0xffff0000, v254
    v_lshlrev_b32 v18, 16, v255
    v_and_b32 v19, 0xffff0000, v255
    v_mov_b32 v20, 0
    v_mov_b32 v21, 0
    v_mov_b32 v22, 0
    v_mov_b32 v23, 0
    v_mov_b32 v24, 0
    v_mov_b32 v25, 0
    v_mov_b32 v26, 0
    v_mov_b32 v27, 0
    v_mov_b32 v28, 0
    v_mov_b32 v29, 0
    v_mov_b32 v30, 0
    v_mov_b32 v31, 0
    v_mov_b32 v32, 0
    v_mov_b32 v33, 0
    v_mov_b32 v34, 0
    v_mov_b32 v35, 0
    v_mov_b32 v36, 0
    v_mov_b32 v37, 0
    v_mov_b32 v38, 0
    v_mov_b32 v39, 0
    v_mov_b32 v224, 1
    v_mov_b32 v225, 51200
    s_waitcnt vmcnt(14) lgkmcnt(0)
    s_barrier
    ds_read_b128 v[184:187], v216 offset:0
    ds_read_b128 v[188:191], v216 offset:1024
    ds_read_b128 v[192:195], v216 offset:2048
    ds_read_b128 v[196:199], v216 offset:3072
    ds_read_b128 v[200:203], v216 offset:4096
    s_waitcnt vmcnt(12)
    s_waitcnt lgkmcnt(4)
    v_mfma_f32_16x16x32_bf16 v[84:87], v[184:187], v[108:111], 0
    v_mfma_f32_16x16x32_bf16 v[64:67], v[184:187], v[104:107], 0
    ds_read_b128 v[184:187], v216 offset:5120
    s_add_u32 s64, s94, 6144
    s_add_u32 s65, s95, 6144
    buffer_load_dwordx4 v[152:155], v223, s[32:35], s64 offen sc1
    s_waitcnt lgkmcnt(4)
    v_mfma_f32_16x16x32_bf16 v[88:91], v[188:191], v[108:111], 0
    v_mfma_f32_16x16x32_bf16 v[68:71], v[188:191], v[104:107], 0
    ds_read_b128 v[188:191], v216 offset:6144
    buffer_load_dwordx4 v[156:159], v223, s[32:35], s65 offen sc1
    s_waitcnt lgkmcnt(4)
    v_mfma_f32_16x16x32_bf16 v[92:95], v[192:195], v[108:111], 0
    v_mfma_f32_16x16x32_bf16 v[72:75], v[192:195], v[104:107], 0
    ds_read_b128 v[192:195], v216 offset:7168
    s_waitcnt lgkmcnt(4)
    v_mfma_f32_16x16x32_bf16 v[96:99], v[196:199], v[108:111], 0
    v_mfma_f32_16x16x32_bf16 v[76:79], v[196:199], v[104:107], 0
    ds_read_b128 v[196:199], v216 offset:8192
    s_waitcnt lgkmcnt(4)
    v_mfma_f32_16x16x32_bf16 v[100:103], v[200:203], v[108:111], 0
    v_mfma_f32_16x16x32_bf16 v[80:83], v[200:203], v[104:107], 0
    ds_read_b128 v[200:203], v216 offset:9216
    s_waitcnt vmcnt(12)
    s_waitcnt lgkmcnt(4)
    v_mfma_f32_16x16x32_bf16 v[84:87], v[184:187], v[116:119], v[84:87]
    v_mfma_f32_16x16x32_bf16 v[64:67], v[184:187], v[112:115], v[64:67]
    ds_read_b128 v[184:187], v216 offset:10240
    s_add_u32 s64, s94, 7168
    s_add_u32 s65, s95, 7168
    buffer_load_dwordx4 v[160:163], v223, s[32:35], s64 offen sc1
    s_waitcnt lgkmcnt(4)
    v_mfma_f32_16x16x32_bf16 v[88:91], v[188:191], v[116:119], v[88:91]
    v_mfma_f32_16x16x32_bf16 v[68:71], v[188:191], v[112:115], v[68:71]
    ds_read_b128 v[188:191], v216 offset:11264
    buffer_load_dwordx4 v[164:167], v223, s[32:35], s65 offen sc1
    s_waitcnt lgkmcnt(4)
    v_mfma_f32_16x16x32_bf16 v[92:95], v[192:195], v[116:119], v[92:95]
    v_mfma_f32_16x16x32_bf16 v[72:75], v[192:195], v[112:115], v[72:75]
    ds_read_b128 v[192:195], v216 offset:12288
    s_waitcnt lgkmcnt(4)
    v_mfma_f32_16x16x32_bf16 v[96:99], v[196:199], v[116:119], v[96:99]
    v_mfma_f32_16x16x32_bf16 v[76:79], v[196:199], v[112:115], v[76:79]
    ds_read_b128 v[196:199], v216 offset:13312
    s_waitcnt lgkmcnt(4)
    v_mfma_f32_16x16x32_bf16 v[100:103], v[200:203], v[116:119], v[100:103]
    v_mfma_f32_16x16x32_bf16 v[80:83], v[200:203], v[112:115], v[80:83]
    ds_read_b128 v[200:203], v217 offset:0
    s_waitcnt vmcnt(12)
    s_waitcnt lgkmcnt(4)
    v_mfma_f32_16x16x32_bf16 v[84:87], v[184:187], v[124:127], v[84:87]
    v_mfma_f32_16x16x32_bf16 v[64:67], v[184:187], v[120:123], v[64:67]
    ds_read_b128 v[184:187], v217 offset:1024
    s_add_u32 s64, s94, 8192
    s_add_u32 s65, s95, 8192
    buffer_load_dwordx4 v[168:171], v223, s[32:35], s64 offen sc1
    s_waitcnt lgkmcnt(4)
    v_mfma_f32_16x16x32_bf16 v[88:91], v[188:191], v[124:127], v[88:91]
    v_mfma_f32_16x16x32_bf16 v[68:71], v[188:191], v[120:123], v[68:71]
    ds_read_b128 v[188:191], v217 offset:2048
    buffer_load_dwordx4 v[172:175], v223, s[32:35], s65 offen sc1
    s_waitcnt lgkmcnt(4)
    v_mfma_f32_16x16x32_bf16 v[92:95], v[192:195], v[124:127], v[92:95]
    v_mfma_f32_16x16x32_bf16 v[72:75], v[192:195], v[120:123], v[72:75]
    ds_read_b128 v[192:195], v217 offset:3072
    s_waitcnt lgkmcnt(4)
    v_mfma_f32_16x16x32_bf16 v[96:99], v[196:199], v[124:127], v[96:99]
    v_mfma_f32_16x16x32_bf16 v[76:79], v[196:199], v[120:123], v[76:79]
    ds_read_b128 v[196:199], v217 offset:4096
    s_waitcnt lgkmcnt(4)
    v_mfma_f32_16x16x32_bf16 v[100:103], v[200:203], v[124:127], v[100:103]
    v_mfma_f32_16x16x32_bf16 v[80:83], v[200:203], v[120:123], v[80:83]
    ds_read_b128 v[200:203], v217 offset:5120
    s_waitcnt vmcnt(12)
    s_waitcnt lgkmcnt(4)
    v_mfma_f32_16x16x32_bf16 v[84:87], v[184:187], v[132:135], v[84:87]
    v_mfma_f32_16x16x32_bf16 v[64:67], v[184:187], v[128:131], v[64:67]
    ds_read_b128 v[184:187], v217 offset:6144
    s_add_u32 s64, s94, 9216
    s_add_u32 s65, s95, 9216
    buffer_load_dwordx2 v[176:177], v222, s[32:35], s64 offen offset:0 sc1
    s_waitcnt lgkmcnt(4)
    v_mfma_f32_16x16x32_bf16 v[88:91], v[188:191], v[132:135], v[88:91]
    v_mfma_f32_16x16x32_bf16 v[68:71], v[188:191], v[128:131], v[68:71]
    ds_read_b128 v[188:191], v217 offset:7168
    buffer_load_dwordx2 v[178:179], v222, s[32:35], s64 offen offset:512 sc1
    s_waitcnt lgkmcnt(4)
    v_mfma_f32_16x16x32_bf16 v[92:95], v[192:195], v[132:135], v[92:95]
    v_mfma_f32_16x16x32_bf16 v[72:75], v[192:195], v[128:131], v[72:75]
    ds_read_b128 v[192:195], v217 offset:8192
    buffer_load_dwordx2 v[180:181], v222, s[32:35], s65 offen offset:0 sc1
    s_waitcnt lgkmcnt(4)
    v_mfma_f32_16x16x32_bf16 v[96:99], v[196:199], v[132:135], v[96:99]
    v_mfma_f32_16x16x32_bf16 v[76:79], v[196:199], v[128:131], v[76:79]
    ds_read_b128 v[196:199], v217 offset:9216
    buffer_load_dwordx2 v[182:183], v222, s[32:35], s65 offen offset:512 sc1
    s_waitcnt lgkmcnt(4)
    v_mfma_f32_16x16x32_bf16 v[100:103], v[200:203], v[132:135], v[100:103]
    v_mfma_f32_16x16x32_bf16 v[80:83], v[200:203], v[128:131], v[80:83]
    ds_read_b128 v[200:203], v217 offset:10240
    s_waitcnt vmcnt(12)
    s_waitcnt lgkmcnt(4)
    v_mfma_f32_16x16x32_bf16 v[84:87], v[184:187], v[140:143], v[84:87]
    v_mfma_f32_16x16x32_bf16 v[64:67], v[184:187], v[136:139], v[64:67]
    ds_read_b128 v[184:187], v217 offset:11264
    s_waitcnt lgkmcnt(4)
    v_mfma_f32_16x16x32_bf16 v[88:91], v[188:191], v[140:143], v[88:91]
    v_mfma_f32_16x16x32_bf16 v[68:71], v[188:191], v[136:139], v[68:71]
    ds_read_b128 v[188:191], v217 offset:12288
    s_waitcnt lgkmcnt(4)
    v_mfma_f32_16x16x32_bf16 v[92:95], v[192:195], v[140:143], v[92:95]
    v_mfma_f32_16x16x32_bf16 v[72:75], v[192:195], v[136:139], v[72:75]
    ds_read_b128 v[192:195], v217 offset:13312
    s_waitcnt lgkmcnt(4)
    v_mfma_f32_16x16x32_bf16 v[96:99], v[196:199], v[140:143], v[96:99]
    v_mfma_f32_16x16x32_bf16 v[76:79], v[196:199], v[136:139], v[76:79]
    ds_read_b128 v[196:199], v217 offset:14336
    s_waitcnt lgkmcnt(4)
    v_mfma_f32_16x16x32_bf16 v[100:103], v[200:203], v[140:143], v[100:103]
    v_mfma_f32_16x16x32_bf16 v[80:83], v[200:203], v[136:139], v[80:83]
    ds_read_b128 v[200:203], v217 offset:15360
    s_waitcnt vmcnt(10)
    s_waitcnt lgkmcnt(4)
    v_mfma_f32_16x16x32_bf16 v[84:87], v[184:187], v[148:151], v[84:87]
    v_mfma_f32_16x16x32_bf16 v[64:67], v[184:187], v[144:147], v[64:67]
    ds_read_b128 v[184:187], v217 offset:16384
    s_waitcnt lgkmcnt(4)
    v_mfma_f32_16x16x32_bf16 v[88:91], v[188:191], v[148:151], v[88:91]
    v_mfma_f32_16x16x32_bf16 v[68:71], v[188:191], v[144:147], v[68:71]
    ds_read_b128 v[188:191], v217 offset:17408
    s_waitcnt lgkmcnt(4)
    v_mfma_f32_16x16x32_bf16 v[92:95], v[192:195], v[148:151], v[92:95]
    v_mfma_f32_16x16x32_bf16 v[72:75], v[192:195], v[144:147], v[72:75]
    ds_read_b128 v[192:195], v217 offset:18432
    s_waitcnt lgkmcnt(4)
    v_mfma_f32_16x16x32_bf16 v[96:99], v[196:199], v[148:151], v[96:99]
    v_mfma_f32_16x16x32_bf16 v[76:79], v[196:199], v[144:147], v[76:79]
    ds_read_b128 v[196:199], v217 offset:19456
    s_waitcnt lgkmcnt(4)
    v_mfma_f32_16x16x32_bf16 v[100:103], v[200:203], v[148:151], v[100:103]
    v_mfma_f32_16x16x32_bf16 v[80:83], v[200:203], v[144:147], v[80:83]
    ds_read_b128 v[200:203], v217 offset:20480
    s_waitcnt vmcnt(8)
    s_waitcnt lgkmcnt(4)
    v_mfma_f32_16x16x32_bf16 v[84:87], v[184:187], v[156:159], v[84:87]
    v_mfma_f32_16x16x32_bf16 v[64:67], v[184:187], v[152:155], v[64:67]
    ds_read_b128 v[184:187], v217 offset:21504
    s_waitcnt lgkmcnt(4)
    v_mfma_f32_16x16x32_bf16 v[88:91], v[188:191], v[156:159], v[88:91]
    v_mfma_f32_16x16x32_bf16 v[68:71], v[188:191], v[152:155], v[68:71]
    ds_read_b128 v[188:191], v217 offset:22528
    s_waitcnt lgkmcnt(4)
    v_mfma_f32_16x16x32_bf16 v[92:95], v[192:195], v[156:159], v[92:95]
    v_mfma_f32_16x16x32_bf16 v[72:75], v[192:195], v[152:155], v[72:75]
    ds_read_b128 v[192:195], v217 offset:23552
    s_waitcnt lgkmcnt(4)
    v_mfma_f32_16x16x32_bf16 v[96:99], v[196:199], v[156:159], v[96:99]
    v_mfma_f32_16x16x32_bf16 v[76:79], v[196:199], v[152:155], v[76:79]
    ds_read_b128 v[196:199], v217 offset:24576
    s_waitcnt lgkmcnt(4)
    v_mfma_f32_16x16x32_bf16 v[100:103], v[200:203], v[156:159], v[100:103]
    v_mfma_f32_16x16x32_bf16 v[80:83], v[200:203], v[152:155], v[80:83]
    ds_read_b128 v[200:203], v217 offset:25600
    s_waitcnt vmcnt(6)
    s_waitcnt lgkmcnt(4)
    v_mfma_f32_16x16x32_bf16 v[84:87], v[184:187], v[164:167], v[84:87]
    v_mfma_f32_16x16x32_bf16 v[64:67], v[184:187], v[160:163], v[64:67]
    ds_read_b128 v[184:187], v217 offset:26624
    s_waitcnt lgkmcnt(4)
    v_mfma_f32_16x16x32_bf16 v[88:91], v[188:191], v[164:167], v[88:91]
    v_mfma_f32_16x16x32_bf16 v[68:71], v[188:191], v[160:163], v[68:71]
    ds_read_b128 v[188:191], v217 offset:27648
    s_waitcnt lgkmcnt(4)
    v_mfma_f32_16x16x32_bf16 v[92:95], v[192:195], v[164:167], v[92:95]
    v_mfma_f32_16x16x32_bf16 v[72:75], v[192:195], v[160:163], v[72:75]
    ds_read_b128 v[192:195], v217 offset:28672
    s_waitcnt lgkmcnt(4)
    v_mfma_f32_16x16x32_bf16 v[96:99], v[196:199], v[164:167], v[96:99]
    v_mfma_f32_16x16x32_bf16 v[76:79], v[196:199], v[160:163], v[76:79]
    ds_read_b128 v[196:199], v217 offset:29696
    s_waitcnt lgkmcnt(4)
    v_mfma_f32_16x16x32_bf16 v[100:103], v[200:203], v[164:167], v[100:103]
    v_mfma_f32_16x16x32_bf16 v[80:83], v[200:203], v[160:163], v[80:83]
    ds_read_b128 v[200:203], v217 offset:30720
    s_waitcnt vmcnt(4)
    s_waitcnt lgkmcnt(4)
    v_mfma_f32_16x16x32_bf16 v[84:87], v[184:187], v[172:175], v[84:87]
    v_mfma_f32_16x16x32_bf16 v[64:67], v[184:187], v[168:171], v[64:67]
    ds_read_b128 v[184:187], v217 offset:31744
    s_waitcnt lgkmcnt(4)
    v_mfma_f32_16x16x32_bf16 v[88:91], v[188:191], v[172:175], v[88:91]
    v_mfma_f32_16x16x32_bf16 v[68:71], v[188:191], v[168:171], v[68:71]
    ds_read_b128 v[188:191], v217 offset:32768
    s_waitcnt lgkmcnt(4)
    v_mfma_f32_16x16x32_bf16 v[92:95], v[192:195], v[172:175], v[92:95]
    v_mfma_f32_16x16x32_bf16 v[72:75], v[192:195], v[168:171], v[72:75]
    ds_read_b128 v[192:195], v217 offset:33792
    s_waitcnt lgkmcnt(4)
    v_mfma_f32_16x16x32_bf16 v[96:99], v[196:199], v[172:175], v[96:99]
    v_mfma_f32_16x16x32_bf16 v[76:79], v[196:199], v[168:171], v[76:79]
    ds_read_b128 v[196:199], v217 offset:34816
    s_waitcnt lgkmcnt(4)
    v_mfma_f32_16x16x32_bf16 v[100:103], v[200:203], v[172:175], v[100:103]
    v_mfma_f32_16x16x32_bf16 v[80:83], v[200:203], v[168:171], v[80:83]
    ds_read_b128 v[200:203], v217 offset:35840
    s_waitcnt vmcnt(0)
    s_waitcnt lgkmcnt(4)
    v_mfma_f32_16x16x32_bf16 v[84:87], v[184:187], v[180:183], v[84:87]
    v_mfma_f32_16x16x32_bf16 v[64:67], v[184:187], v[176:179], v[64:67]
    s_waitcnt lgkmcnt(3)
    v_mfma_f32_16x16x32_bf16 v[88:91], v[188:191], v[180:183], v[88:91]
    v_mfma_f32_16x16x32_bf16 v[68:71], v[188:191], v[176:179], v[68:71]
    s_waitcnt lgkmcnt(2)
    v_mfma_f32_16x16x32_bf16 v[92:95], v[192:195], v[180:183], v[92:95]
    v_mfma_f32_16x16x32_bf16 v[72:75], v[192:195], v[176:179], v[72:75]
    s_waitcnt lgkmcnt(1)
    v_mfma_f32_16x16x32_bf16 v[96:99], v[196:199], v[180:183], v[96:99]
    v_mfma_f32_16x16x32_bf16 v[76:79], v[196:199], v[176:179], v[76:79]
    s_waitcnt lgkmcnt(0)
    v_mfma_f32_16x16x32_bf16 v[100:103], v[200:203], v[180:183], v[100:103]
    v_mfma_f32_16x16x32_bf16 v[80:83], v[200:203], v[176:179], v[80:83]
    s_nop 5
    ds_write_b128 v218, v[84:87] offset:0
    ds_write_b128 v218, v[88:91] offset:1024
    ds_write_b128 v218, v[92:95] offset:2048
    ds_write_b128 v218, v[96:99] offset:3072
    ds_write_b128 v218, v[100:103] offset:4096
    s_mov_b32 s59, 0x200000
L_xs_139:
    ds_read_b128 v[200:203], v219 offset:4096
    s_sub_u32 s59, s59, 1
    s_cbranch_scc1 L_xd_140
    s_waitcnt lgkmcnt(0)
    v_cmp_eq_u32 vcc, -1, v203
    s_cbranch_vccnz L_xs_139
L_xd_140:
    ds_read_b128 v[184:187], v219 offset:0
    ds_read_b128 v[188:191], v219 offset:1024
    ds_read_b128 v[192:195], v219 offset:2048
    ds_read_b128 v[196:199], v219 offset:3072
    s_waitcnt lgkmcnt(4)
    v_pk_add_f32 v[80:81], v[80:81], v[200:201]
    v_pk_add_f32 v[82:83], v[82:83], v[202:203]
    s_waitcnt lgkmcnt(3)
    v_pk_add_f32 v[64:65], v[64:65], v[184:185]
    v_pk_add_f32 v[66:67], v[66:67], v[186:187]
    s_waitcnt lgkmcnt(2)
    v_pk_add_f32 v[68:69], v[68:69], v[188:189]
    v_pk_add_f32 v[70:71], v[70:71], v[190:191]
    s_waitcnt lgkmcnt(1)
    v_pk_add_f32 v[72:73], v[72:73], v[192:193]
    v_pk_add_f32 v[74:75], v[74:75], v[194:195]
    s_waitcnt lgkmcnt(0)
    v_pk_add_f32 v[76:77], v[76:77], v[196:197]
    v_pk_add_f32 v[78:79], v[78:79], v[198:199]
    s_barrier
    s_lshl2_add_u32 s64, s51, s47
    s_mul_i32 s90, s64, 55296
    s_mul_i32 s65, s56, 3072
    s_add_u32 s65, s65, 17825792
    s_add_u32 s90, s90, s65
    s_xor_b32 s64, s64, 1
    s_mul_i32 s91, s64, 55296
    s_add_u32 s91, s91, s65
    s_mov_b32 s72, 0
    s_mul_i32 s64, s72, 6144
    s_add_u32 s90, s90, s64
    s_add_u32 s91, s91, s64
    v_mov_b32 v62, v40
    v_and_b32 v60, 15, v234
    v_lshrrev_b32 v61, 4, v234
    v_mul_u32_u24 v60, 1280, v60
    v_lshl_add_u32 v60, v61, 3, v60
    s_lshl2_add_u32 s64, s51, s47
    s_mul_i32 s64, s64, 20480
    s_mul_i32 s65, s52, 160
    s_add_u32 s92, s64, s65
    v_lshlrev_b32 v40, 16, v236
    v_and_b32 v41, 0xffff0000, v236
    v_lshlrev_b32 v42, 16, v237
    v_and_b32 v43, 0xffff0000, v237
    v_lshlrev_b32 v44, 16, v238
    v_and_b32 v45, 0xffff0000, v238
    v_lshlrev_b32 v46, 16, v239
    v_and_b32 v47, 0xffff0000, v239
    v_lshlrev_b32 v48, 16, v240
    v_and_b32 v49, 0xffff0000, v240
    v_lshlrev_b32 v50, 16, v241
    v_and_b32 v51, 0xffff0000, v241
    v_lshlrev_b32 v52, 16, v242
    v_and_b32 v53, 0xffff0000, v242
    v_lshlrev_b32 v54, 16, v243
    v_and_b32 v55, 0xffff0000, v243
    v_lshlrev_b32 v56, 16, v244
    v_and_b32 v57, 0xffff0000, v244
    v_lshlrev_b32 v58, 16, v245
    v_and_b32 v59, 0xffff0000, v245
    s_mov_b32 s59, 0x40000
L_poll_141:
    buffer_load_dwordx2 v[84:85], v62, s[32:35], 0 offen sc1
    s_waitcnt vmcnt(0)
    v_cmp_ne_u64 vcc, s[44:45], v[84:85]
    s_cbranch_vccz L_pdone_142
    s_sleep 4
    s_sub_u32 s59, s59, 1
    s_cbranch_scc0 L_poll_141
    s_or_b32 s58, s58, 32
L_pdone_142:
    buffer_load_dwordx4 v[104:107], v221, s[32:35], s90 offen offset:0 sc1
    buffer_load_dwordx4 v[108:111], v221, s[32:35], s91 offen offset:0 sc1
    buffer_load_dwordx4 v[112:115], v221, s[32:35], s90 offen offset:1024 sc1
    buffer_load_dwordx4 v[116:119], v221, s[32:35], s91 offen offset:1024 sc1
    buffer_load_dwordx4 v[120:123], v221, s[32:35], s90 offen offset:2048 sc1
    buffer_load_dwordx4 v[124:127], v221, s[32:35], s91 offen offset:2048 sc1
    s_add_u32 s72, s72, 1
    s_cmp_eq_u32 s72, 9
    s_mov_b32 s73, 6144
    s_cmov_b32 s73, 4294918144
    s_add_u32 s90, s90, s73
    s_add_u32 s91, s91, s73
    buffer_load_dwordx4 v[128:131], v221, s[32:35], s90 offen offset:0 sc1
    buffer_load_dwordx4 v[132:135], v221, s[32:35], s91 offen offset:0 sc1
    s_barrier
    ds_read_b128 v[184:187], v220 offset:0
    ds_read_b128 v[188:191], v220 offset:1024
    ds_read_b128 v[192:195], v220 offset:2048
    ds_read_b128 v[196:199], v220 offset:3072
    ds_read_b128 v[200:203], v220 offset:4096
    buffer_load_dwordx4 v[136:139], v221, s[32:35], s90 offen offset:1024 sc1
    buffer_load_dwordx4 v[140:143], v221, s[32:35], s91 offen offset:1024 sc1
    buffer_load_dwordx4 v[144:147], v221, s[32:35], s90 offen offset:2048 sc1
    buffer_load_dwordx4 v[148:151], v221, s[32:35], s91 offen offset:2048 sc1
    s_add_u32 s72, s72, 1
    s_cmp_eq_u32 s72, 9
    s_mov_b32 s73, 6144
    s_cmov_b32 s73, 4294918144
    s_add_u32 s90, s90, s73
    s_add_u32 s91, s91, s73
    buffer_load_dwordx4 v[152:155], v221, s[32:35], s90 offen offset:0 sc1
    buffer_load_dwordx4 v[156:159], v221, s[32:35], s91 offen offset:0 sc1
    buffer_load_dwordx4 v[160:163], v221, s[32:35], s90 offen offset:1024 sc1
    buffer_load_dwordx4 v[164:167], v221, s[32:35], s91 offen offset:1024 sc1
    buffer_load_dwordx4 v[168:171], v221, s[32:35], s90 offen offset:2048 sc1
    buffer_load_dwordx4 v[172:175], v221, s[32:35], s91 offen offset:2048 sc1
    s_mov_b32 s57, 0
    s_mov_b32 s77, 0
L_t4_143:
    s_add_u32 s72, s72, 1
    s_cmp_eq_u32 s72, 9
    s_mov_b32 s73, 6144
    s_cmov_b32 s73, 4294918144
    s_add_u32 s90, s90, s73
    s_add_u32 s91, s91, s73
    s_waitcnt vmcnt(16)
    s_waitcnt lgkmcnt(4)
    v_mfma_f32_16x16x32_bf16 v[20:23], v[184:187], v[108:111], v[20:23]
    v_mfma_f32_16x16x32_bf16 v[0:3], v[184:187], v[104:107], v[0:3]
    ds_read_b128 v[184:187], v220 offset:5120
    s_waitcnt lgkmcnt(4)
    v_mfma_f32_16x16x32_bf16 v[24:27], v[188:191], v[108:111], v[24:27]
    v_mfma_f32_16x16x32_bf16 v[4:7], v[188:191], v[104:107], v[4:7]
    ds_read_b128 v[188:191], v220 offset:6144
    s_waitcnt lgkmcnt(4)
    v_mfma_f32_16x16x32_bf16 v[28:31], v[192:195], v[108:111], v[28:31]
    v_mfma_f32_16x16x32_bf16 v[8:11], v[192:195], v[104:107], v[8:11]
    ds_read_b128 v[192:195], v220 offset:7168
    s_waitcnt lgkmcnt(4)
    v_mfma_f32_16x16x32_bf16 v[32:35], v[196:199], v[108:111], v[32:35]
    v_mfma_f32_16x16x32_bf16 v[12:15], v[196:199], v[104:107], v[12:15]
    ds_read_b128 v[196:199], v220 offset:8192
    s_waitcnt lgkmcnt(4)
    v_mfma_f32_16x16x32_bf16 v[36:39], v[200:203], v[108:111], v[36:39]
    v_mfma_f32_16x16x32_bf16 v[16:19], v[200:203], v[104:107], v[16:19]
    ds_read_b128 v[200:203], v220 offset:9216
    buffer_load_dwordx4 v[104:107], v221, s[32:35], s90 offen offset:0 sc1
    buffer_load_dwordx4 v[108:111], v221, s[32:35], s91 offen offset:0 sc1
    s_add_u32 s77, s77, 1
    s_cmp_eq_u32 s77, 5
    s_mov_b32 s79, 30720
    s_cmov_b32 s79, 4294844416
    s_cmov_b32 s77, 0
    s_waitcnt vmcnt(16)
    s_waitcnt lgkmcnt(4)
    v_mfma_f32_16x16x32_bf16 v[20:23], v[184:187], v[116:119], v[20:23]
    v_mfma_f32_16x16x32_bf16 v[0:3], v[184:187], v[112:115], v[0:3]
    ds_read_b128 v[184:187], v220 offset:10240
    s_waitcnt lgkmcnt(4)
    v_mfma_f32_16x16x32_bf16 v[24:27], v[188:191], v[116:119], v[24:27]
    v_mfma_f32_16x16x32_bf16 v[4:7], v[188:191], v[112:115], v[4:7]
    ds_read_b128 v[188:191], v220 offset:11264
    s_waitcnt lgkmcnt(4)
    v_mfma_f32_16x16x32_bf16 v[28:31], v[192:195], v[116:119], v[28:31]
    v_mfma_f32_16x16x32_bf16 v[8:11], v[192:195], v[112:115], v[8:11]
    ds_read_b128 v[192:195], v220 offset:12288
    s_waitcnt lgkmcnt(4)
    v_mfma_f32_16x16x32_bf16 v[32:35], v[196:199], v[116:119], v[32:35]
    v_mfma_f32_16x16x32_bf16 v[12:15], v[196:199], v[112:115], v[12:15]
    ds_read_b128 v[196:199], v220 offset:13312
    s_waitcnt lgkmcnt(4)
    v_mfma_f32_16x16x32_bf16 v[36:39], v[200:203], v[116:119], v[36:39]
    v_mfma_f32_16x16x32_bf16 v[16:19], v[200:203], v[112:115], v[16:19]
    ds_read_b128 v[200:203], v220 offset:14336
    buffer_load_dwordx4 v[112:115], v221, s[32:35], s90 offen offset:1024 sc1
    buffer_load_dwordx4 v[116:119], v221, s[32:35], s91 offen offset:1024 sc1
    s_barrier
    v_add_u32 v220, s79, v220
    s_waitcnt vmcnt(16)
    s_waitcnt lgkmcnt(4)
    v_mfma_f32_16x16x32_bf16 v[20:23], v[184:187], v[124:127], v[20:23]
    v_mfma_f32_16x16x32_bf16 v[0:3], v[184:187], v[120:123], v[0:3]
    ds_read_b128 v[184:187], v220 offset:0
    s_waitcnt lgkmcnt(4)
    v_mfma_f32_16x16x32_bf16 v[24:27], v[188:191], v[124:127], v[24:27]
    v_mfma_f32_16x16x32_bf16 v[4:7], v[188:191], v[120:123], v[4:7]
    ds_read_b128 v[188:191], v220 offset:1024
    s_waitcnt lgkmcnt(4)
    v_mfma_f32_16x16x32_bf16 v[28:31], v[192:195], v[124:127], v[28:31]
    v_mfma_f32_16x16x32_bf16 v[8:11], v[192:195], v[120:123], v[8:11]
    ds_read_b128 v[192:195], v220 offset:2048
    s_waitcnt lgkmcnt(4)
    v_mfma_f32_16x16x32_bf16 v[32:35], v[196:199], v[124:127], v[32:35]
    v_mfma_f32_16x16x32_bf16 v[12:15], v[196:199], v[120:123], v[12:15]
    ds_read_b128 v[196:199], v220 offset:3072
    s_waitcnt lgkmcnt(4)
    v_mfma_f32_16x16x32_bf16 v[36:39], v[200:203], v[124:127], v[36:39]
    v_mfma_f32_16x16x32_bf16 v[16:19], v[200:203], v[120:123], v[16:19]
    ds_read_b128 v[200:203], v220 offset:4096
    buffer_load_dwordx4 v[120:123], v221, s[32:35], s90 offen offset:2048 sc1
    buffer_load_dwordx4 v[124:127], v221, s[32:35], s91 offen offset:2048 sc1
    s_waitcnt vmcnt(16)
    s_waitcnt lgkmcnt(4)
    v_mfma_f32_16x16x32_bf16 v[20:23], v[184:187], v[132:135], v[20:23]
    v_mfma_f32_16x16x32_bf16 v[0:3], v[184:187], v[128:131], v[0:3]
    ds_read_b128 v[184:187], v220 offset:5120
    s_waitcnt lgkmcnt(4)
    v_mfma_f32_16x16x32_bf16 v[24:27], v[188:191], v[132:135], v[24:27]
    v_mfma_f32_16x16x32_bf16 v[4:7], v[188:191], v[128:131], v[4:7]
    ds_read_b128 v[188:191], v220 offset:6144
    s_waitcnt lgkmcnt(4)
    v_mfma_f32_16x16x32_bf16 v[28:31], v[192:195], v[132:135], v[28:31]
    v_mfma_f32_16x16x32_bf16 v[8:11], v[192:195], v[128:131], v[8:11]
    ds_read_b128 v[192:195], v220 offset:7168
    s_waitcnt lgkmcnt(4)
    v_mfma_f32_16x16x32_bf16 v[32:35], v[196:199], v[132:135], v[32:35]
    v_mfma_f32_16x16x32_bf16 v[12:15], v[196:199], v[128:131], v[12:15]
    ds_read_b128 v[196:199], v220 offset:8192
    s_waitcnt lgkmcnt(4)
    v_mfma_f32_16x16x32_bf16 v[36:39], v[200:203], v[132:135], v[36:39]
    v_mfma_f32_16x16x32_bf16 v[16:19], v[200:203], v[128:131], v[16:19]
    ds_read_b128 v[200:203], v220 offset:9216
    s_add_u32 s72, s72, 1
    s_cmp_eq_u32 s72, 9
    s_mov_b32 s73, 6144
    s_cmov_b32 s73, 4294918144
    s_add_u32 s90, s90, s73
    s_add_u32 s91, s91, s73
    buffer_load_dwordx4 v[128:131], v221, s[32:35], s90 offen offset:0 sc1
    buffer_load_dwordx4 v[132:135], v221, s[32:35], s91 offen offset:0 sc1
    s_add_u32 s77, s77, 1
    s_cmp_eq_u32 s77, 5
    s_mov_b32 s79, 30720
    s_cmov_b32 s79, 4294844416
    s_cmov_b32 s77, 0
    s_waitcnt vmcnt(16)
    s_waitcnt lgkmcnt(4)
    v_mfma_f32_16x16x32_bf16 v[20:23], v[184:187], v[140:143], v[20:23]
    v_mfma_f32_16x16x32_bf16 v[0:3], v[184:187], v[136:139], v[0:3]
    ds_read_b128 v[184:187], v220 offset:10240
    s_waitcnt lgkmcnt(4)
    v_mfma_f32_16x16x32_bf16 v[24:27], v[188:191], v[140:143], v[24:27]
    v_mfma_f32_16x16x32_bf16 v[4:7], v[188:191], v[136:139], v[4:7]
    ds_read_b128 v[188:191], v220 offset:11264
    s_waitcnt lgkmcnt(4)
    v_mfma_f32_16x16x32_bf16 v[28:31], v[192:195], v[140:143], v[28:31]
    v_mfma_f32_16x16x32_bf16 v[8:11], v[192:195], v[136:139], v[8:11]
    ds_read_b128 v[192:195], v220 offset:12288
    s_waitcnt lgkmcnt(4)
    v_mfma_f32_16x16x32_bf16 v[32:35], v[196:199], v[140:143], v[32:35]
    v_mfma_f32_16x16x32_bf16 v[12:15], v[196:199], v[136:139], v[12:15]
    ds_read_b128 v[196:199], v220 offset:13312
    s_waitcnt lgkmcnt(4)
    v_mfma_f32_16x16x32_bf16 v[36:39], v[200:203], v[140:143], v[36:39]
    v_mfma_f32_16x16x32_bf16 v[16:19], v[200:203], v[136:139], v[16:19]
    ds_read_b128 v[200:203], v220 offset:14336
    buffer_load_dwordx4 v[136:139], v221, s[32:35], s90 offen offset:1024 sc1
    buffer_load_dwordx4 v[140:143], v221, s[32:35], s91 offen offset:1024 sc1
    s_barrier
    v_add_u32 v220, s79, v220
    s_waitcnt vmcnt(16)
    s_waitcnt lgkmcnt(4)
    v_mfma_f32_16x16x32_bf16 v[20:23], v[184:187], v[148:151], v[20:23]
    v_mfma_f32_16x16x32_bf16 v[0:3], v[184:187], v[144:147], v[0:3]
    ds_read_b128 v[184:187], v220 offset:0
    s_waitcnt lgkmcnt(4)
    v_mfma_f32_16x16x32_bf16 v[24:27], v[188:191], v[148:151], v[24:27]
    v_mfma_f32_16x16x32_bf16 v[4:7], v[188:191], v[144:147], v[4:7]
    ds_read_b128 v[188:191], v220 offset:1024
    s_waitcnt lgkmcnt(4)
    v_mfma_f32_16x16x32_bf16 v[28:31], v[192:195], v[148:151], v[28:31]
    v_mfma_f32_16x16x32_bf16 v[8:11], v[192:195], v[144:147], v[8:11]
    ds_read_b128 v[192:195], v220 offset:2048
    s_waitcnt lgkmcnt(4)
    v_mfma_f32_16x16x32_bf16 v[32:35], v[196:199], v[148:151], v[32:35]
    v_mfma_f32_16x16x32_bf16 v[12:15], v[196:199], v[144:147], v[12:15]
    ds_read_b128 v[196:199], v220 offset:3072
    s_waitcnt lgkmcnt(4)
    v_mfma_f32_16x16x32_bf16 v[36:39], v[200:203], v[148:151], v[36:39]
    v_mfma_f32_16x16x32_bf16 v[16:19], v[200:203], v[144:147], v[16:19]
    ds_read_b128 v[200:203], v220 offset:4096
    buffer_load_dwordx4 v[144:147], v221, s[32:35], s90 offen offset:2048 sc1
    buffer_load_dwordx4 v[148:151], v221, s[32:35], s91 offen offset:2048 sc1
    s_waitcnt vmcnt(16)
    s_waitcnt lgkmcnt(4)
    v_mfma_f32_16x16x32_bf16 v[20:23], v[184:187], v[156:159], v[20:23]
    v_mfma_f32_16x16x32_bf16 v[0:3], v[184:187], v[152:155], v[0:3]
    ds_read_b128 v[184:187], v220 offset:5120
    s_waitcnt lgkmcnt(4)
    v_mfma_f32_16x16x32_bf16 v[24:27], v[188:191], v[156:159], v[24:27]
    v_mfma_f32_16x16x32_bf16 v[4:7], v[188:191], v[152:155], v[4:7]
    ds_read_b128 v[188:191], v220 offset:6144
    s_waitcnt lgkmcnt(4)
    v_mfma_f32_16x16x32_bf16 v[28:31], v[192:195], v[156:159], v[28:31]
    v_mfma_f32_16x16x32_bf16 v[8:11], v[192:195], v[152:155], v[8:11]
    ds_read_b128 v[192:195], v220 offset:7168
    s_waitcnt lgkmcnt(4)
    v_mfma_f32_16x16x32_bf16 v[32:35], v[196:199], v[156:159], v[32:35]
    v_mfma_f32_16x16x32_bf16 v[12:15], v[196:199], v[152:155], v[12:15]
    ds_read_b128 v[196:199], v220 offset:8192
    s_waitcnt lgkmcnt(4)
    v_mfma_f32_16x16x32_bf16 v[36:39], v[200:203], v[156:159], v[36:39]
    v_mfma_f32_16x16x32_bf16 v[16:19], v[200:203], v[152:155], v[16:19]
    ds_read_b128 v[200:203], v220 offset:9216
    s_add_u32 s72, s72, 1
    s_cmp_eq_u32 s72, 9
    s_mov_b32 s73, 6144
    s_cmov_b32 s73, 4294918144
    s_add_u32 s90, s90, s73
    s_add_u32 s91, s91, s73
    buffer_load_dwordx4 v[152:155], v221, s[32:35], s90 offen offset:0 sc1
    buffer_load_dwordx4 v[156:159], v221, s[32:35], s91 offen offset:0 sc1
    s_add_u32 s77, s77, 1
    s_cmp_eq_u32 s77, 5
    s_mov_b32 s79, 30720
    s_cmov_b32 s79, 4294844416
    s_cmov_b32 s77, 0
    s_waitcnt vmcnt(16)
    s_waitcnt lgkmcnt(4)
    v_mfma_f32_16x16x32_bf16 v[20:23], v[184:187], v[164:167], v[20:23]
    v_mfma_f32_16x16x32_bf16 v[0:3], v[184:187], v[160:163], v[0:3]
    ds_read_b128 v[184:187], v220 offset:10240
    s_waitcnt lgkmcnt(4)
    v_mfma_f32_16x16x32_bf16 v[24:27], v[188:191], v[164:167], v[24:27]
    v_mfma_f32_16x16x32_bf16 v[4:7], v[188:191], v[160:163], v[4:7]
    ds_read_b128 v[188:191], v220 offset:11264
    s_waitcnt lgkmcnt(4)
    v_mfma_f32_16x16x32_bf16 v[28:31], v[192:195], v[164:167], v[28:31]
    v_mfma_f32_16x16x32_bf16 v[8:11], v[192:195], v[160:163], v[8:11]
    ds_read_b128 v[192:195], v220 offset:12288
    s_waitcnt lgkmcnt(4)
    v_mfma_f32_16x16x32_bf16 v[32:35], v[196:199], v[164:167], v[32:35]
    v_mfma_f32_16x16x32_bf16 v[12:15], v[196:199], v[160:163], v[12:15]
    ds_read_b128 v[196:199], v220 offset:13312
    s_waitcnt lgkmcnt(4)
    v_mfma_f32_16x16x32_bf16 v[36:39], v[200:203], v[164:167], v[36:39]
    v_mfma_f32_16x16x32_bf16 v[16:19], v[200:203], v[160:163], v[16:19]
    ds_read_b128 v[200:203], v220 offset:14336
    buffer_load_dwordx4 v[160:163], v221, s[32:35], s90 offen offset:1024 sc1
    buffer_load_dwordx4 v[164:167], v221, s[32:35], s91 offen offset:1024 sc1
    s_barrier
    v_add_u32 v220, s79, v220
    s_waitcnt vmcnt(16)
    s_waitcnt lgkmcnt(4)
    v_mfma_f32_16x16x32_bf16 v[20:23], v[184:187], v[172:175], v[20:23]
    v_mfma_f32_16x16x32_bf16 v[0:3], v[184:187], v[168:171], v[0:3]
    ds_read_b128 v[184:187], v220 offset:0
    s_waitcnt lgkmcnt(4)
    v_mfma_f32_16x16x32_bf16 v[24:27], v[188:191], v[172:175], v[24:27]
    v_mfma_f32_16x16x32_bf16 v[4:7], v[188:191], v[168:171], v[4:7]
    ds_read_b128 v[188:191], v220 offset:1024
    s_waitcnt lgkmcnt(4)
    v_mfma_f32_16x16x32_bf16 v[28:31], v[192:195], v[172:175], v[28:31]
    v_mfma_f32_16x16x32_bf16 v[8:11], v[192:195], v[168:171], v[8:11]
    ds_read_b128 v[192:195], v220 offset:2048
    s_waitcnt lgkmcnt(4)
    v_mfma_f32_16x16x32_bf16 v[32:35], v[196:199], v[172:175], v[32:35]
    v_mfma_f32_16x16x32_bf16 v[12:15], v[196:199], v[168:171], v[12:15]
    ds_read_b128 v[196:199], v220 offset:3072
    s_waitcnt lgkmcnt(4)
    v_mfma_f32_16x16x32_bf16 v[36:39], v[200:203], v[172:175], v[36:39]
    v_mfma_f32_16x16x32_bf16 v[16:19], v[200:203], v[168:171], v[16:19]
    ds_read_b128 v[200:203], v220 offset:4096
    buffer_load_dwordx4 v[168:171], v221, s[32:35], s90 offen offset:2048 sc1
    buffer_load_dwordx4 v[172:175], v221, s[32:35], s91 offen offset:2048 sc1
    s_add_u32 s57, s57, 1
    s_cmp_lt_u32 s57, 2
    s_cbranch_scc1 L_t4_143
    s_waitcnt vmcnt(16)
    s_waitcnt lgkmcnt(4)
    v_mfma_f32_16x16x32_bf16 v[20:23], v[184:187], v[108:111], v[20:23]
    v_mfma_f32_16x16x32_bf16 v[0:3], v[184:187], v[104:107], v[0:3]
    ds_read_b128 v[184:187], v220 offset:5120
    s_waitcnt lgkmcnt(4)
    v_mfma_f32_16x16x32_bf16 v[24:27], v[188:191], v[108:111], v[24:27]
    v_mfma_f32_16x16x32_bf16 v[4:7], v[188:191], v[104:107], v[4:7]
    ds_read_b128 v[188:191], v220 offset:6144
    s_waitcnt lgkmcnt(4)
    v_mfma_f32_16x16x32_bf16 v[28:31], v[192:195], v[108:111], v[28:31]
    v_mfma_f32_16x16x32_bf16 v[8:11], v[192:195], v[104:107], v[8:11]
    ds_read_b128 v[192:195], v220 offset:7168
    s_waitcnt lgkmcnt(4)
    v_mfma_f32_16x16x32_bf16 v[32:35], v[196:199], v[108:111], v[32:35]
    v_mfma_f32_16x16x32_bf16 v[12:15], v[196:199], v[104:107], v[12:15]
    ds_read_b128 v[196:199], v220 offset:8192
    s_waitcnt lgkmcnt(4)
    v_mfma_f32_16x16x32_bf16 v[36:39], v[200:203], v[108:111], v[36:39]
    v_mfma_f32_16x16x32_bf16 v[16:19], v[200:203], v[104:107], v[16:19]
    ds_read_b128 v[200:203], v220 offset:9216
    s_add_u32 s77, s77, 1
    s_cmp_eq_u32 s77, 5
    s_mov_b32 s79, 30720
    s_cmov_b32 s79, 4294844416
    s_cmov_b32 s77, 0
    s_waitcnt vmcnt(14)
    s_waitcnt lgkmcnt(4)
    v_mfma_f32_16x16x32_bf16 v[20:23], v[184:187], v[116:119], v[20:23]
    v_mfma_f32_16x16x32_bf16 v[0:3], v[184:187], v[112:115], v[0:3]
    ds_read_b128 v[184:187], v220 offset:10240
    s_waitcnt lgkmcnt(4)
    v_mfma_f32_16x16x32_bf16 v[24:27], v[188:191], v[116:119], v[24:27]
    v_mfma_f32_16x16x32_bf16 v[4:7], v[188:191], v[112:115], v[4:7]
    ds_read_b128 v[188:191], v220 offset:11264
    s_waitcnt lgkmcnt(4)
    v_mfma_f32_16x16x32_bf16 v[28:31], v[192:195], v[116:119], v[28:31]
    v_mfma_f32_16x16x32_bf16 v[8:11], v[192:195], v[112:115], v[8:11]
    ds_read_b128 v[192:195], v220 offset:12288
    s_waitcnt lgkmcnt(4)
    v_mfma_f32_16x16x32_bf16 v[32:35], v[196:199], v[116:119], v[32:35]
    v_mfma_f32_16x16x32_bf16 v[12:15], v[196:199], v[112:115], v[12:15]
    ds_read_b128 v[196:199], v220 offset:13312
    s_waitcnt lgkmcnt(4)
    v_mfma_f32_16x16x32_bf16 v[36:39], v[200:203], v[116:119], v[36:39]
    v_mfma_f32_16x16x32_bf16 v[16:19], v[200:203], v[112:115], v[16:19]
    ds_read_b128 v[200:203], v220 offset:14336
    s_barrier
    v_add_u32 v220, s79, v220
    s_waitcnt vmcnt(12)
    s_waitcnt lgkmcnt(4)
    v_mfma_f32_16x16x32_bf16 v[20:23], v[184:187], v[124:127], v[20:23]
    v_mfma_f32_16x16x32_bf16 v[0:3], v[184:187], v[120:123], v[0:3]
    ds_read_b128 v[184:187], v220 offset:0
    s_waitcnt lgkmcnt(4)
    v_mfma_f32_16x16x32_bf16 v[24:27], v[188:191], v[124:127], v[24:27]
    v_mfma_f32_16x16x32_bf16 v[4:7], v[188:191], v[120:123], v[4:7]
    ds_read_b128 v[188:191], v220 offset:1024
    s_waitcnt lgkmcnt(4)
    v_mfma_f32_16x16x32_bf16 v[28:31], v[192:195], v[124:127], v[28:31]
    v_mfma_f32_16x16x32_bf16 v[8:11], v[192:195], v[120:123], v[8:11]
    ds_read_b128 v[192:195], v220 offset:2048
    s_waitcnt lgkmcnt(4)
    v_mfma_f32_16x16x32_bf16 v[32:35], v[196:199], v[124:127], v[32:35]
    v_mfma_f32_16x16x32_bf16 v[12:15], v[196:199], v[120:123], v[12:15]
    ds_read_b128 v[196:199], v220 offset:3072
    s_waitcnt lgkmcnt(4)
    v_mfma_f32_16x16x32_bf16 v[36:39], v[200:203], v[124:127], v[36:39]
    v_mfma_f32_16x16x32_bf16 v[16:19], v[200:203], v[120:123], v[16:19]
    ds_read_b128 v[200:203], v220 offset:4096
    s_waitcnt vmcnt(10)
    s_waitcnt lgkmcnt(4)
    v_mfma_f32_16x16x32_bf16 v[20:23], v[184:187], v[132:135], v[20:23]
    v_mfma_f32_16x16x32_bf16 v[0:3], v[184:187], v[128:131], v[0:3]
    ds_read_b128 v[184:187], v220 offset:5120
    s_waitcnt lgkmcnt(4)
    v_mfma_f32_16x16x32_bf16 v[24:27], v[188:191], v[132:135], v[24:27]
    v_mfma_f32_16x16x32_bf16 v[4:7], v[188:191], v[128:131], v[4:7]
    ds_read_b128 v[188:191], v220 offset:6144
    s_waitcnt lgkmcnt(4)
    v_mfma_f32_16x16x32_bf16 v[28:31], v[192:195], v[132:135], v[28:31]
    v_mfma_f32_16x16x32_bf16 v[8:11], v[192:195], v[128:131], v[8:11]
    ds_read_b128 v[192:195], v220 offset:7168
    s_waitcnt lgkmcnt(4)
    v_mfma_f32_16x16x32_bf16 v[32:35], v[196:199], v[132:135], v[32:35]
    v_mfma_f32_16x16x32_bf16 v[12:15], v[196:199], v[128:131], v[12:15]
    ds_read_b128 v[196:199], v220 offset:8192
    s_waitcnt lgkmcnt(4)
    v_mfma_f32_16x16x32_bf16 v[36:39], v[200:203], v[132:135], v[36:39]
    v_mfma_f32_16x16x32_bf16 v[16:19], v[200:203], v[128:131], v[16:19]
    ds_read_b128 v[200:203], v220 offset:9216
    s_add_u32 s77, s77, 1
    s_cmp_eq_u32 s77, 5
    s_mov_b32 s79, 30720
    s_cmov_b32 s79, 4294844416
    s_cmov_b32 s77, 0
    s_waitcnt vmcnt(8)
    s_waitcnt lgkmcnt(4)
    v_mfma_f32_16x16x32_bf16 v[20:23], v[184:187], v[140:143], v[20:23]
    v_mfma_f32_16x16x32_bf16 v[0:3], v[184:187], v[136:139], v[0:3]
    ds_read_b128 v[184:187], v220 offset:10240
    s_waitcnt lgkmcnt(4)
    v_mfma_f32_16x16x32_bf16 v[24:27], v[188:191], v[140:143], v[24:27]
    v_mfma_f32_16x16x32_bf16 v[4:7], v[188:191], v[136:139], v[4:7]
    ds_read_b128 v[188:191], v220 offset:11264
    s_waitcnt lgkmcnt(4)
    v_mfma_f32_16x16x32_bf16 v[28:31], v[192:195], v[140:143], v[28:31]
    v_mfma_f32_16x16x32_bf16 v[8:11], v[192:195], v[136:139], v[8:11]
    ds_read_b128 v[192:195], v220 offset:12288
    s_waitcnt lgkmcnt(4)
    v_mfma_f32_16x16x32_bf16 v[32:35], v[196:199], v[140:143], v[32:35]
    v_mfma_f32_16x16x32_bf16 v[12:15], v[196:199], v[136:139], v[12:15]
    ds_read_b128 v[196:199], v220 offset:13312
    s_waitcnt lgkmcnt(4)
    v_mfma_f32_16x16x32_bf16 v[36:39], v[200:203], v[140:143], v[36:39]
    v_mfma_f32_16x16x32_bf16 v[16:19], v[200:203], v[136:139], v[16:19]
    ds_read_b128 v[200:203], v220 offset:14336
    s_barrier
    v_add_u32 v220, s79, v220
    s_waitcnt vmcnt(6)
    s_waitcnt lgkmcnt(4)
    v_mfma_f32_16x16x32_bf16 v[20:23], v[184:187], v[148:151], v[20:23]
    v_mfma_f32_16x16x32_bf16 v[0:3], v[184:187], v[144:147], v[0:3]
    ds_read_b128 v[184:187], v220 offset:0
    s_waitcnt lgkmcnt(4)
    v_mfma_f32_16x16x32_bf16 v[24:27], v[188:191], v[148:151], v[24:27]
    v_mfma_f32_16x16x32_bf16 v[4:7], v[188:191], v[144:147], v[4:7]
    ds_read_b128 v[188:191], v220 offset:1024
    s_waitcnt lgkmcnt(4)
    v_mfma_f32_16x16x32_bf16 v[28:31], v[192:195], v[148:151], v[28:31]
    v_mfma_f32_16x16x32_bf16 v[8:11], v[192:195], v[144:147], v[8:11]
    ds_read_b128 v[192:195], v220 offset:2048
    s_waitcnt lgkmcnt(4)
    v_mfma_f32_16x16x32_bf16 v[32:35], v[196:199], v[148:151], v[32:35]
    v_mfma_f32_16x16x32_bf16 v[12:15], v[196:199], v[144:147], v[12:15]
    ds_read_b128 v[196:199], v220 offset:3072
    s_waitcnt lgkmcnt(4)
    v_mfma_f32_16x16x32_bf16 v[36:39], v[200:203], v[148:151], v[36:39]
    v_mfma_f32_16x16x32_bf16 v[16:19], v[200:203], v[144:147], v[16:19]
    ds_read_b128 v[200:203], v220 offset:4096
    s_waitcnt vmcnt(4)
    s_waitcnt lgkmcnt(4)
    v_mfma_f32_16x16x32_bf16 v[20:23], v[184:187], v[156:159], v[20:23]
    v_mfma_f32_16x16x32_bf16 v[0:3], v[184:187], v[152:155], v[0:3]
    ds_read_b128 v[184:187], v220 offset:5120
    s_waitcnt lgkmcnt(4)
    v_mfma_f32_16x16x32_bf16 v[24:27], v[188:191], v[156:159], v[24:27]
    v_mfma_f32_16x16x32_bf16 v[4:7], v[188:191], v[152:155], v[4:7]
    ds_read_b128 v[188:191], v220 offset:6144
    s_waitcnt lgkmcnt(4)
    v_mfma_f32_16x16x32_bf16 v[28:31], v[192:195], v[156:159], v[28:31]
    v_mfma_f32_16x16x32_bf16 v[8:11], v[192:195], v[152:155], v[8:11]
    ds_read_b128 v[192:195], v220 offset:7168
    s_waitcnt lgkmcnt(4)
    v_mfma_f32_16x16x32_bf16 v[32:35], v[196:199], v[156:159], v[32:35]
    v_mfma_f32_16x16x32_bf16 v[12:15], v[196:199], v[152:155], v[12:15]
    ds_read_b128 v[196:199], v220 offset:8192
    s_waitcnt lgkmcnt(4)
    v_mfma_f32_16x16x32_bf16 v[36:39], v[200:203], v[156:159], v[36:39]
    v_mfma_f32_16x16x32_bf16 v[16:19], v[200:203], v[152:155], v[16:19]
    ds_read_b128 v[200:203], v220 offset:9216
    s_add_u32 s77, s77, 1
    s_cmp_eq_u32 s77, 5
    s_mov_b32 s79, 30720
    s_cmov_b32 s79, 4294844416
    s_cmov_b32 s77, 0
    s_waitcnt vmcnt(2)
    s_waitcnt lgkmcnt(4)
    v_mfma_f32_16x16x32_bf16 v[20:23], v[184:187], v[164:167], v[20:23]
    v_mfma_f32_16x16x32_bf16 v[0:3], v[184:187], v[160:163], v[0:3]
    ds_read_b128 v[184:187], v220 offset:10240
    s_waitcnt lgkmcnt(4)
    v_mfma_f32_16x16x32_bf16 v[24:27], v[188:191], v[164:167], v[24:27]
    v_mfma_f32_16x16x32_bf16 v[4:7], v[188:191], v[160:163], v[4:7]
    ds_read_b128 v[188:191], v220 offset:11264
    s_waitcnt lgkmcnt(4)
    v_mfma_f32_16x16x32_bf16 v[28:31], v[192:195], v[164:167], v[28:31]
    v_mfma_f32_16x16x32_bf16 v[8:11], v[192:195], v[160:163], v[8:11]
    ds_read_b128 v[192:195], v220 offset:12288
    s_waitcnt lgkmcnt(4)
    v_mfma_f32_16x16x32_bf16 v[32:35], v[196:199], v[164:167], v[32:35]
    v_mfma_f32_16x16x32_bf16 v[12:15], v[196:199], v[160:163], v[12:15]
    ds_read_b128 v[196:199], v220 offset:13312
    s_waitcnt lgkmcnt(4)
    v_mfma_f32_16x16x32_bf16 v[36:39], v[200:203], v[164:167], v[36:39]
    v_mfma_f32_16x16x32_bf16 v[16:19], v[200:203], v[160:163], v[16:19]
    ds_read_b128 v[200:203], v220 offset:14336
    s_barrier
    v_add_u32 v220, s79, v220
    s_waitcnt vmcnt(0)
    s_waitcnt lgkmcnt(4)
    v_mfma_f32_16x16x32_bf16 v[20:23], v[184:187], v[172:175], v[20:23]
    v_mfma_f32_16x16x32_bf16 v[0:3], v[184:187], v[168:171], v[0:3]
    s_waitcnt lgkmcnt(3)
    v_mfma_f32_16x16x32_bf16 v[24:27], v[188:191], v[172:175], v[24:27]
    v_mfma_f32_16x16x32_bf16 v[4:7], v[188:191], v[168:171], v[4:7]
    s_waitcnt lgkmcnt(2)
    v_mfma_f32_16x16x32_bf16 v[28:31], v[192:195], v[172:175], v[28:31]
    v_mfma_f32_16x16x32_bf16 v[8:11], v[192:195], v[168:171], v[8:11]
    s_waitcnt lgkmcnt(1)
    v_mfma_f32_16x16x32_bf16 v[32:35], v[196:199], v[172:175], v[32:35]
    v_mfma_f32_16x16x32_bf16 v[12:15], v[196:199], v[168:171], v[12:15]
    s_waitcnt lgkmcnt(0)
    v_mfma_f32_16x16x32_bf16 v[36:39], v[200:203], v[172:175], v[36:39]
    v_mfma_f32_16x16x32_bf16 v[16:19], v[200:203], v[168:171], v[16:19]
    v_subrev_u32 v218, 30720, v218
    v_subrev_u32 v219, 30720, v219
    s_nop 3
    ds_write_b128 v218, v[20:23] offset:0
    ds_write_b128 v218, v[24:27] offset:1024
    ds_write_b128 v218, v[28:31] offset:2048
    ds_write_b128 v218, v[32:35] offset:3072
    ds_write_b128 v218, v[36:39] offset:4096
    s_waitcnt lgkmcnt(0)
    s_barrier
    ds_read_b128 v[184:187], v219 offset:0
    ds_read_b128 v[188:191], v219 offset:1024
    ds_read_b128 v[192:195], v219 offset:2048
    ds_read_b128 v[196:199], v219 offset:3072
    ds_read_b128 v[200:203], v219 offset:4096
    s_waitcnt lgkmcnt(4)
    v_pk_add_f32 v[0:1], v[0:1], v[184:185]
    v_pk_add_f32 v[2:3], v[2:3], v[186:187]
    s_waitcnt lgkmcnt(3)
    v_pk_add_f32 v[4:5], v[4:5], v[188:189]
    v_pk_add_f32 v[6:7], v[6:7], v[190:191]
    s_waitcnt lgkmcnt(2)
    v_pk_add_f32 v[8:9], v[8:9], v[192:193]
    v_pk_add_f32 v[10:11], v[10:11], v[194:195]
    s_waitcnt lgkmcnt(1)
    v_pk_add_f32 v[12:13], v[12:13], v[196:197]
    v_pk_add_f32 v[14:15], v[14:15], v[198:199]
    s_waitcnt lgkmcnt(0)
    v_pk_add_f32 v[16:17], v[16:17], v[200:201]
    v_pk_add_f32 v[18:19], v[18:19], v[202:203]
    v_mul_f32 v20, 0xbfb8aa3b, v0
    v_mul_f32 v21, 0xbfb8aa3b, v1
    v_mul_f32 v22, 0xbfb8aa3b, v2
    v_mul_f32 v23, 0xbfb8aa3b, v3
    v_exp_f32 v20, v20
    v_exp_f32 v21, v21
    v_exp_f32 v22, v22
    v_exp_f32 v23, v23
    v_mul_f32 v0, v0, v64
    v_mul_f32 v1, v1, v65
    v_mul_f32 v2, v2, v66
    v_mul_f32 v3, v3, v67
    v_add_f32 v20, 1.0, v20
    v_add_f32 v21, 1.0, v21
    v_add_f32 v22, 1.0, v22
    v_add_f32 v23, 1.0, v23
    v_rcp_f32 v20, v20
    v_rcp_f32 v21, v21
    v_rcp_f32 v22, v22
    v_rcp_f32 v23, v23
    s_nop 0
    v_fmac_f32 v40, v0, v20
    v_fmac_f32 v41, v1, v21
    v_fmac_f32 v42, v2, v22
    v_fmac_f32 v43, v3, v23
    v_cvt_pk_bf16_f32 v20, v40, v41
    v_cvt_pk_bf16_f32 v21, v42, v43
    buffer_store_dwordx2 v[20:21], v60, s[40:43], s92 offen offset:0
    v_mul_f32 v24, 0xbfb8aa3b, v4
    v_mul_f32 v25, 0xbfb8aa3b, v5
    v_mul_f32 v26, 0xbfb8aa3b, v6
    v_mul_f32 v27, 0xbfb8aa3b, v7
    v_exp_f32 v24, v24
    v_exp_f32 v25, v25
    v_exp_f32 v26, v26
    v_exp_f32 v27, v27
    v_mul_f32 v4, v4, v68
    v_mul_f32 v5, v5, v69
    v_mul_f32 v6, v6, v70
    v_mul_f32 v7, v7, v71
    v_add_f32 v24, 1.0, v24
    v_add_f32 v25, 1.0, v25
    v_add_f32 v26, 1.0, v26
    v_add_f32 v27, 1.0, v27
    v_rcp_f32 v24, v24
    v_rcp_f32 v25, v25
    v_rcp_f32 v26, v26
    v_rcp_f32 v27, v27
    s_nop 0
    v_fmac_f32 v44, v4, v24
    v_fmac_f32 v45, v5, v25
    v_fmac_f32 v46, v6, v26
    v_fmac_f32 v47, v7, v27
    v_cvt_pk_bf16_f32 v24, v44, v45
    v_cvt_pk_bf16_f32 v25, v46, v47
    buffer_store_dwordx2 v[24:25], v60, s[40:43], s92 offen offset:32
    v_mul_f32 v28, 0xbfb8aa3b, v8
    v_mul_f32 v29, 0xbfb8aa3b, v9
    v_mul_f32 v30, 0xbfb8aa3b, v10
    v_mul_f32 v31, 0xbfb8aa3b, v11
    v_exp_f32 v28, v28
    v_exp_f32 v29, v29
    v_exp_f32 v30, v30
    v_exp_f32 v31, v31
    v_mul_f32 v8, v8, v72
    v_mul_f32 v9, v9, v73
    v_mul_f32 v10, v10, v74
    v_mul_f32 v11, v11, v75
    v_add_f32 v28, 1.0, v28
    v_add_f32 v29, 1.0, v29
    v_add_f32 v30, 1.0, v30
    v_add_f32 v31, 1.0, v31
    v_rcp_f32 v28, v28
    v_rcp_f32 v29, v29
    v_rcp_f32 v30, v30
    v_rcp_f32 v31, v31
    s_nop 0
    v_fmac_f32 v48, v8, v28
    v_fmac_f32 v49, v9, v29
    v_fmac_f32 v50, v10, v30
    v_fmac_f32 v51, v11, v31
    v_cvt_pk_bf16_f32 v28, v48, v49
    v_cvt_pk_bf16_f32 v29, v50, v51
    buffer_store_dwordx2 v[28:29], v60, s[40:43], s92 offen offset:64
    v_mul_f32 v32, 0xbfb8aa3b, v12
    v_mul_f32 v33, 0xbfb8aa3b, v13
    v_mul_f32 v34, 0xbfb8aa3b, v14
    v_mul_f32 v35, 0xbfb8aa3b, v15
    v_exp_f32 v32, v32
    v_exp_f32 v33, v33
    v_exp_f32 v34, v34
    v_exp_f32 v35, v35
    v_mul_f32 v12, v12, v76
    v_mul_f32 v13, v13, v77
    v_mul_f32 v14, v14, v78
    v_mul_f32 v15, v15, v79
    v_add_f32 v32, 1.0, v32
    v_add_f32 v33, 1.0, v33
    v_add_f32 v34, 1.0, v34
    v_add_f32 v35, 1.0, v35
    v_rcp_f32 v32, v32
    v_rcp_f32 v33, v33
    v_rcp_f32 v34, v34
    v_rcp_f32 v35, v35
    s_nop 0
    v_fmac_f32 v52, v12, v32
    v_fmac_f32 v53, v13, v33
    v_fmac_f32 v54, v14, v34
    v_fmac_f32 v55, v15, v35
    v_cvt_pk_bf16_f32 v32, v52, v53
    v_cvt_pk_bf16_f32 v33, v54, v55
    buffer_store_dwordx2 v[32:33], v60, s[40:43], s92 offen offset:96
    v_mul_f32 v36, 0xbfb8aa3b, v16
    v_mul_f32 v37, 0xbfb8aa3b, v17
    v_mul_f32 v38, 0xbfb8aa3b, v18
    v_mul_f32 v39, 0xbfb8aa3b, v19
    v_exp_f32 v36, v36
    v_exp_f32 v37, v37
    v_exp_f32 v38, v38
    v_exp_f32 v39, v39
    v_mul_f32 v16, v16, v80
    v_mul_f32 v17, v17, v81
    v_mul_f32 v18, v18, v82
    v_mul_f32 v19, v19, v83
    v_add_f32 v36, 1.0, v36
    v_add_f32 v37, 1.0, v37
    v_add_f32 v38, 1.0, v38
    v_add_f32 v39, 1.0, v39
    v_rcp_f32 v36, v36
    v_rcp_f32 v37, v37
    v_rcp_f32 v38, v38
    v_rcp_f32 v39, v39
    s_nop 0
    v_fmac_f32 v56, v16, v36
    v_fmac_f32 v57, v17, v37
    v_fmac_f32 v58, v18, v38
    v_fmac_f32 v59, v19, v39
    v_cvt_pk_bf16_f32 v36, v56, v57
    v_cvt_pk_bf16_f32 v37, v58, v59
    buffer_store_dwordx2 v[36:37], v60, s[40:43], s92 offen offset:128
    s_branch L_FIN
L_TA_EXACT:
    s_mov_b32 s60, 2
    v_mov_b32 v30, 0xf149f2ca
    s_mov_b32 vcc_lo, 0x0
    s_mov_b32 vcc_hi, 0xf
    v_cndmask_b32 v48, 0, v30, vcc
    v_cndmask_b32_e64 v32, v30, 0, vcc
    s_mov_b32 vcc_lo, 0x1
    s_mov_b32 vcc_hi, 0x1f
    v_cndmask_b32 v49, 0, v30, vcc
    v_cndmask_b32_e64 v33, v30, 0, vcc
    s_mov_b32 vcc_lo, 0x3
    s_mov_b32 vcc_hi, 0x3f
    v_cndmask_b32 v50, 0, v30, vcc
    v_cndmask_b32_e64 v34, v30, 0, vcc
    s_mov_b32 vcc_lo, 0x7
    s_mov_b32 vcc_hi, 0x7f
    v_cndmask_b32 v51, 0, v30, vcc
    v_cndmask_b32_e64 v35, v30, 0, vcc
    s_mov_b32 vcc_lo, 0xff
    s_mov_b32 vcc_hi, 0xfff
    v_cndmask_b32 v52, 0, v30, vcc
    v_cndmask_b32_e64 v36, v30, 0, vcc
    s_mov_b32 vcc_lo, 0x1ff
    s_mov_b32 vcc_hi, 0x1fff
    v_cndmask_b32 v53, 0, v30, vcc
    v_cndmask_b32_e64 v37, v30, 0, vcc
    s_mov_b32 vcc_lo, 0x3ff
    s_mov_b32 vcc_hi, 0x3fff
    v_cndmask_b32 v54, 0, v30, vcc
    v_cndmask_b32_e64 v38, v30, 0, vcc
    s_mov_b32 vcc_lo, 0x7ff
    s_mov_b32 vcc_hi, 0x7fff
    v_cndmask_b32 v55, 0, v30, vcc
    v_cndmask_b32_e64 v39, v30, 0, vcc
    s_mov_b32 vcc_lo, 0xffff
    s_mov_b32 vcc_hi, 0xfffff
    v_cndmask_b32 v56, 0, v30, vcc
    v_cndmask_b32_e64 v40, v30, 0, vcc
    s_mov_b32 vcc_lo, 0x1ffff
    s_mov_b32 vcc_hi, 0x1fffff
    v_cndmask_b32 v57, 0, v30, vcc
    v_cndmask_b32_e64 v41, v30, 0, vcc
    s_mov_b32 vcc_lo, 0x3ffff
    s_mov_b32 vcc_hi, 0x3fffff
    v_cndmask_b32 v58, 0, v30, vcc
    v_cndmask_b32_e64 v42, v30, 0, vcc
    s_mov_b32 vcc_lo, 0x7ffff
    s_mov_b32 vcc_hi, 0x7fffff
    v_cndmask_b32 v59, 0, v30, vcc
    v_cndmask_b32_e64 v43, v30, 0, vcc
    s_mov_b32 vcc_lo, 0xffffff
    s_mov_b32 vcc_hi, 0xfffffff
    v_cndmask_b32 v60, 0, v30, vcc
    v_cndmask_b32_e64 v44, v30, 0, vcc
    s_mov_b32 vcc_lo, 0x1ffffff
    s_mov_b32 vcc_hi, 0x1fffffff
    v_cndmask_b32 v61, 0, v30, vcc
    v_cndmask_b32_e64 v45, v30, 0, vcc
    s_mov_b32 vcc_lo, 0x3ffffff
    s_mov_b32 vcc_hi, 0x3fffffff
    v_cndmask_b32 v62, 0, v30, vcc
    v_cndmask_b32_e64 v46, v30, 0, vcc
    s_mov_b32 vcc_lo, 0x7ffffff
    s_mov_b32 vcc_hi, 0x7fffffff
    v_cndmask_b32 v63, 0, v30, vcc
    v_cndmask_b32_e64 v47, v30, 0, vcc
    ds_read_b64 v[176:177], v24 offset:0
    ds_read_b64 v[178:179], v24 offset:4096
    ds_read_b64 v[180:181], v25 offset:16384
    s_cmp_gt_u32 s96, 0
    s_cselect_b32 s64, 0xf149, 0
    v_mov_b32 v182, s64
    ds_read_b64 v[184:185], v24 offset:256
    ds_read_b64 v[186:187], v24 offset:4352
    ds_read_b64 v[188:189], v25 offset:16640
    s_cmp_gt_u32 s96, 1
    s_cselect_b32 s64, 0xf149, 0
    v_mov_b32 v190, s64
    s_waitcnt lgkmcnt(3)
    v_mfma_f32_32x32x16_bf16 v[32:47], v[176:179], v[16:19], v[32:47]
    v_mfma_f32_32x32x16_bf16 v[32:47], v[180:183], v[20:23], v[32:47]
    ds_read_b64 v[176:177], v24 offset:512
    ds_read_b64 v[178:179], v24 offset:4608
    ds_read_b64 v[180:181], v25 offset:16896
    s_cmp_gt_u32 s96, 2
    s_cselect_b32 s64, 0xf149, 0
    v_mov_b32 v182, s64
    s_waitcnt lgkmcnt(3)
    v_mfma_f32_32x32x16_bf16 v[64:79], v[184:187], v[16:19], 0
    v_mfma_f32_32x32x16_bf16 v[64:79], v[188:191], v[20:23], v[64:79]
    ds_read_b64 v[184:185], v24 offset:768
    ds_read_b64 v[186:187], v24 offset:4864
    ds_read_b64 v[188:189], v25 offset:17152
    s_cmp_gt_u32 s96, 3
    s_cselect_b32 s64, 0xf149, 0
    v_mov_b32 v190, s64
    s_waitcnt lgkmcnt(3)
    v_mfma_f32_32x32x16_bf16 v[80:95], v[176:179], v[16:19], 0
    v_max3_f32 v28, v32, v33, v34
    v_max3_f32 v29, v35, v36, v37
    v_max3_f32 v28, v28, v38, v39
    v_max3_f32 v29, v29, v40, v41
    v_mfma_f32_32x32x16_bf16 v[80:95], v[180:183], v[20:23], v[80:95]
    v_max3_f32 v28, v28, v42, v43
    v_max3_f32 v29, v29, v44, v45
    v_max3_f32 v28, v28, v46, v47
    ds_read_b64 v[176:177], v24 offset:1024
    ds_read_b64 v[178:179], v24 offset:5120
    ds_read_b64 v[180:181], v25 offset:17408
    s_cmp_gt_u32 s96, 4
    s_cselect_b32 s64, 0xf149, 0
    v_mov_b32 v182, s64
    s_waitcnt lgkmcnt(3)
    v_mfma_f32_32x32x16_bf16 v[96:111], v[184:187], v[16:19], 0
    v_max3_f32 v28, v28, v64, v65
    v_max3_f32 v29, v29, v66, v67
    v_max3_f32 v28, v28, v68, v69
    v_max3_f32 v29, v29, v70, v71
    v_mfma_f32_32x32x16_bf16 v[96:111], v[188:191], v[20:23], v[96:111]
    v_max3_f32 v28, v28, v72, v73
    v_max3_f32 v29, v29, v74, v75
    v_max3_f32 v28, v28, v76, v77
    v_max3_f32 v29, v29, v78, v79
    ds_read_b64 v[184:185], v24 offset:1280
    ds_read_b64 v[186:187], v24 offset:5376
    ds_read_b64 v[188:189], v25 offset:17664
    s_cmp_gt_u32 s96, 5
    s_cselect_b32 s64, 0xf149, 0
    v_mov_b32 v190, s64
    s_waitcnt lgkmcnt(3)
    v_mfma_f32_32x32x16_bf16 v[112:127], v[176:179], v[16:19], 0
    v_max3_f32 v28, v28, v80, v81
    v_max3_f32 v29, v29, v82, v83
    v_max3_f32 v28, v28, v84, v85
    v_max3_f32 v29, v29, v86, v87
    v_mfma_f32_32x32x16_bf16 v[112:127], v[180:183], v[20:23], v[112:127]
    v_max3_f32 v28, v28, v88, v89
    v_max3_f32 v29, v29, v90, v91
    v_max3_f32 v28, v28, v92, v93
    v_max3_f32 v29, v29, v94, v95
    ds_read_b64 v[176:177], v24 offset:1536
    ds_read_b64 v[178:179], v24 offset:5632
    ds_read_b64 v[180:181], v25 offset:17920
    s_cmp_gt_u32 s96, 6
    s_cselect_b32 s64, 0xf149, 0
    v_mov_b32 v182, s64
    s_waitcnt lgkmcnt(3)
    v_mfma_f32_32x32x16_bf16 v[128:143], v[184:187], v[16:19], 0
    v_max3_f32 v28, v28, v96, v97
    v_max3_f32 v29, v29, v98, v99
    v_max3_f32 v28, v28, v100, v101
    v_max3_f32 v29, v29, v102, v103
    v_mfma_f32_32x32x16_bf16 v[128:143], v[188:191], v[20:23], v[128:143]
    v_max3_f32 v28, v28, v104, v105
    v_max3_f32 v29, v29, v106, v107
    v_max3_f32 v28, v28, v108, v109
    v_max3_f32 v29, v29, v110, v111
    ds_read_b64 v[184:185], v24 offset:1792
    ds_read_b64 v[186:187], v24 offset:5888
    ds_read_b64 v[188:189], v25 offset:18176
    s_cmp_gt_u32 s96, 7
    s_cselect_b32 s64, 0xf149, 0
    v_mov_b32 v190, s64
    s_waitcnt lgkmcnt(3)
    v_mfma_f32_32x32x16_bf16 v[144:159], v[176:179], v[16:19], 0
    v_max3_f32 v28, v28, v112, v113
    v_max3_f32 v29, v29, v114, v115
    v_max3_f32 v28, v28, v116, v117
    v_max3_f32 v29, v29, v118, v119
    v_mfma_f32_32x32x16_bf16 v[144:159], v[180:183], v[20:23], v[144:159]
    v_max3_f32 v28, v28, v120, v121
    v_max3_f32 v29, v29, v122, v123
    v_max3_f32 v28, v28, v124, v125
    v_max3_f32 v29, v29, v126, v127
    ds_read_b64 v[176:177], v24 offset:2048
    ds_read_b64 v[178:179], v24 offset:6144
    ds_read_b64 v[180:181], v25 offset:18432
    s_cmp_gt_u32 s96, 8
    s_cselect_b32 s64, 0xf149, 0
    v_mov_b32 v182, s64
    s_waitcnt lgkmcnt(3)
    v_mfma_f32_32x32x16_bf16 v[160:175], v[184:187], v[16:19], 0
    v_max3_f32 v28, v28, v128, v129
    v_max3_f32 v29, v29, v130, v131
    v_max3_f32 v28, v28, v132, v133
    v_max3_f32 v29, v29, v134, v135
    v_mfma_f32_32x32x16_bf16 v[160:175], v[188:191], v[20:23], v[160:175]
    v_max3_f32 v28, v28, v136, v137
    v_max3_f32 v29, v29, v138, v139
    v_max3_f32 v28, v28, v140, v141
    v_max3_f32 v29, v29, v142, v143
    s_mov_b32 exec_lo, 0xfffff
    s_mov_b32 exec_hi, 0xfffff
    ds_read_b128 v[192:195], v26 offset:0
    ds_read_b128 v[196:199], v26 offset:640
    s_mov_b64 exec, -1
    s_waitcnt lgkmcnt(2)
    v_mfma_f32_32x32x16_bf16 v[48:63], v[176:179], v[16:19], v[48:63]
    v_max3_f32 v28, v28, v144, v145
    v_max3_f32 v29, v29, v146, v147
    v_max3_f32 v28, v28, v148, v149
    v_max3_f32 v29, v29, v150, v151
    v_mfma_f32_32x32x16_bf16 v[48:63], v[180:183], v[20:23], v[48:63]
    v_max3_f32 v28, v28, v152, v153
    v_max3_f32 v29, v29, v154, v155
    v_max3_f32 v28, v28, v156, v157
    v_max3_f32 v29, v29, v158, v159
    s_mov_b32 exec_lo, 0xfffff
    s_mov_b32 exec_hi, 0xfffff
    ds_read_b128 v[200:203], v26 offset:1280
    ds_read_b128 v[204:207], v26 offset:1920
    s_mov_b64 exec, -1
    v_max3_f32 v28, v28, v160, v161
    v_max3_f32 v29, v29, v162, v163
    v_max3_f32 v28, v28, v164, v165
    v_max3_f32 v29, v29, v166, v167
    v_max3_f32 v28, v28, v168, v169
    v_max3_f32 v29, v29, v170, v171
    v_max3_f32 v28, v28, v172, v173
    v_max3_f32 v29, v29, v174, v175
    s_nop 1
    v_max3_f32 v28, v28, v48, v49
    v_max3_f32 v29, v29, v50, v51
    v_max3_f32 v28, v28, v52, v53
    v_max3_f32 v29, v29, v54, v55
    v_max3_f32 v28, v28, v56, v57
    v_max3_f32 v29, v29, v58, v59
    v_max3_f32 v28, v28, v60, v61
    v_max3_f32 v29, v29, v62, v63
    v_max_f32 v28, v28, v29
    v_mov_b32 v29, v28
    s_nop 1
    v_permlane32_swap_b32 v28, v29
    v_max_f32 v28, v28, v29
    v_pk_add_f32 v[32:33], v[32:33], v[28:29] op_sel_hi:[1,0] neg_lo:[0,1] neg_hi:[0,1]
    v_pk_add_f32 v[34:35], v[34:35], v[28:29] op_sel_hi:[1,0] neg_lo:[0,1] neg_hi:[0,1]
    v_pk_add_f32 v[36:37], v[36:37], v[28:29] op_sel_hi:[1,0] neg_lo:[0,1] neg_hi:[0,1]
    v_pk_add_f32 v[38:39], v[38:39], v[28:29] op_sel_hi:[1,0] neg_lo:[0,1] neg_hi:[0,1]
    v_pk_add_f32 v[40:41], v[40:41], v[28:29] op_sel_hi:[1,0] neg_lo:[0,1] neg_hi:[0,1]
    v_pk_add_f32 v[42:43], v[42:43], v[28:29] op_sel_hi:[1,0] neg_lo:[0,1] neg_hi:[0,1]
    v_pk_add_f32 v[44:45], v[44:45], v[28:29] op_sel_hi:[1,0] neg_lo:[0,1] neg_hi:[0,1]
    v_pk_add_f32 v[46:47], v[46:47], v[28:29] op_sel_hi:[1,0] neg_lo:[0,1] neg_hi:[0,1]
    v_exp_f32 v32, v32
    v_exp_f32 v33, v33
    v_exp_f32 v34, v34
    v_exp_f32 v35, v35
    v_exp_f32 v36, v36
    v_exp_f32 v37, v37
    v_exp_f32 v38, v38
    v_exp_f32 v39, v39
    v_exp_f32 v40, v40
    v_exp_f32 v41, v41
    v_exp_f32 v42, v42
    v_exp_f32 v43, v43
    v_exp_f32 v44, v44
    v_exp_f32 v45, v45
    v_exp_f32 v46, v46
    v_exp_f32 v47, v47
    v_cvt_pk_bf16_f32 v32, v32, v33
    v_cvt_pk_bf16_f32 v33, v34, v35
    v_cvt_pk_bf16_f32 v34, v36, v37
    v_cvt_pk_bf16_f32 v35, v38, v39
    v_cvt_pk_bf16_f32 v36, v40, v41
    v_cvt_pk_bf16_f32 v37, v42, v43
    v_cvt_pk_bf16_f32 v38, v44, v45
    v_cvt_pk_bf16_f32 v39, v46, v47
    v_pk_add_f32 v[64:65], v[64:65], v[28:29] op_sel_hi:[1,0] neg_lo:[0,1] neg_hi:[0,1]
    v_pk_add_f32 v[66:67], v[66:67], v[28:29] op_sel_hi:[1,0] neg_lo:[0,1] neg_hi:[0,1]
    v_pk_add_f32 v[68:69], v[68:69], v[28:29] op_sel_hi:[1,0] neg_lo:[0,1] neg_hi:[0,1]
    v_pk_add_f32 v[70:71], v[70:71], v[28:29] op_sel_hi:[1,0] neg_lo:[0,1] neg_hi:[0,1]
    v_pk_add_f32 v[72:73], v[72:73], v[28:29] op_sel_hi:[1,0] neg_lo:[0,1] neg_hi:[0,1]
    v_pk_add_f32 v[74:75], v[74:75], v[28:29] op_sel_hi:[1,0] neg_lo:[0,1] neg_hi:[0,1]
    v_pk_add_f32 v[76:77], v[76:77], v[28:29] op_sel_hi:[1,0] neg_lo:[0,1] neg_hi:[0,1]
    v_pk_add_f32 v[78:79], v[78:79], v[28:29] op_sel_hi:[1,0] neg_lo:[0,1] neg_hi:[0,1]
    s_waitcnt lgkmcnt(2)
    v_mfma_f32_32x32x16_bf16 v[0:15], v[192:195], v[32:35], 0
    v_exp_f32 v64, v64
    v_exp_f32 v65, v65
    v_exp_f32 v66, v66
    v_exp_f32 v67, v67
    v_exp_f32 v68, v68
    v_exp_f32 v69, v69
    v_exp_f32 v70, v70
    v_exp_f32 v71, v71
    v_mfma_f32_32x32x16_bf16 v[0:15], v[196:199], v[36:39], v[0:15]
    s_mov_b32 exec_lo, 0xfffff
    s_mov_b32 exec_hi, 0xfffff
    ds_read_b128 v[192:195], v26 offset:2560
    ds_read_b128 v[196:199], v26 offset:3200
    s_mov_b64 exec, -1
    v_exp_f32 v72, v72
    v_exp_f32 v73, v73
    v_exp_f32 v74, v74
    v_exp_f32 v75, v75
    v_exp_f32 v76, v76
    v_exp_f32 v77, v77
    v_exp_f32 v78, v78
    v_exp_f32 v79, v79
    v_cvt_pk_bf16_f32 v64, v64, v65
    v_cvt_pk_bf16_f32 v65, v66, v67
    v_cvt_pk_bf16_f32 v66, v68, v69
    v_cvt_pk_bf16_f32 v67, v70, v71
    v_cvt_pk_bf16_f32 v68, v72, v73
    v_cvt_pk_bf16_f32 v69, v74, v75
    v_cvt_pk_bf16_f32 v70, v76, v77
    v_cvt_pk_bf16_f32 v71, v78, v79
    v_pk_add_f32 v[80:81], v[80:81], v[28:29] op_sel_hi:[1,0] neg_lo:[0,1] neg_hi:[0,1]
    v_pk_add_f32 v[82:83], v[82:83], v[28:29] op_sel_hi:[1,0] neg_lo:[0,1] neg_hi:[0,1]
    v_pk_add_f32 v[84:85], v[84:85], v[28:29] op_sel_hi:[1,0] neg_lo:[0,1] neg_hi:[0,1]
    v_pk_add_f32 v[86:87], v[86:87], v[28:29] op_sel_hi:[1,0] neg_lo:[0,1] neg_hi:[0,1]
    v_pk_add_f32 v[88:89], v[88:89], v[28:29] op_sel_hi:[1,0] neg_lo:[0,1] neg_hi:[0,1]
    v_pk_add_f32 v[90:91], v[90:91], v[28:29] op_sel_hi:[1,0] neg_lo:[0,1] neg_hi:[0,1]
    v_pk_add_f32 v[92:93], v[92:93], v[28:29] op_sel_hi:[1,0] neg_lo:[0,1] neg_hi:[0,1]
    v_pk_add_f32 v[94:95], v[94:95], v[28:29] op_sel_hi:[1,0] neg_lo:[0,1] neg_hi:[0,1]
    s_waitcnt lgkmcnt(2)
    v_mfma_f32_32x32x16_bf16 v[0:15], v[200:203], v[64:67], v[0:15]
    v_exp_f32 v80, v80
    v_exp_f32 v81, v81
    v_exp_f32 v82, v82
    v_exp_f32 v83, v83
    v_exp_f32 v84, v84
    v_exp_f32 v85, v85
    v_exp_f32 v86, v86
    v_exp_f32 v87, v87
    v_mfma_f32_32x32x16_bf16 v[0:15], v[204:207], v[68:71], v[0:15]
    s_mov_b32 exec_lo, 0xfffff
    s_mov_b32 exec_hi, 0xfffff
    ds_read_b128 v[200:203], v26 offset:3840
    ds_read_b128 v[204:207], v26 offset:4480
    s_mov_b64 exec, -1
    v_exp_f32 v88, v88
    v_exp_f32 v89, v89
    v_exp_f32 v90, v90
    v_exp_f32 v91, v91
    v_exp_f32 v92, v92
    v_exp_f32 v93, v93
    v_exp_f32 v94, v94
    v_exp_f32 v95, v95
    v_cvt_pk_bf16_f32 v80, v80, v81
    v_cvt_pk_bf16_f32 v81, v82, v83
    v_cvt_pk_bf16_f32 v82, v84, v85
    v_cvt_pk_bf16_f32 v83, v86, v87
    v_cvt_pk_bf16_f32 v84, v88, v89
    v_cvt_pk_bf16_f32 v85, v90, v91
    v_cvt_pk_bf16_f32 v86, v92, v93
    v_cvt_pk_bf16_f32 v87, v94, v95
    v_pk_add_f32 v[96:97], v[96:97], v[28:29] op_sel_hi:[1,0] neg_lo:[0,1] neg_hi:[0,1]
    v_pk_add_f32 v[98:99], v[98:99], v[28:29] op_sel_hi:[1,0] neg_lo:[0,1] neg_hi:[0,1]
    v_pk_add_f32 v[100:101], v[100:101], v[28:29] op_sel_hi:[1,0] neg_lo:[0,1] neg_hi:[0,1]
    v_pk_add_f32 v[102:103], v[102:103], v[28:29] op_sel_hi:[1,0] neg_lo:[0,1] neg_hi:[0,1]
    v_pk_add_f32 v[104:105], v[104:105], v[28:29] op_sel_hi:[1,0] neg_lo:[0,1] neg_hi:[0,1]
    v_pk_add_f32 v[106:107], v[106:107], v[28:29] op_sel_hi:[1,0] neg_lo:[0,1] neg_hi:[0,1]
    v_pk_add_f32 v[108:109], v[108:109], v[28:29] op_sel_hi:[1,0] neg_lo:[0,1] neg_hi:[0,1]
    v_pk_add_f32 v[110:111], v[110:111], v[28:29] op_sel_hi:[1,0] neg_lo:[0,1] neg_hi:[0,1]
    s_waitcnt lgkmcnt(2)
    v_mfma_f32_32x32x16_bf16 v[0:15], v[192:195], v[80:83], v[0:15]
    v_exp_f32 v96, v96
    v_exp_f32 v97, v97
    v_exp_f32 v98, v98
    v_exp_f32 v99, v99
    v_exp_f32 v100, v100
    v_exp_f32 v101, v101
    v_exp_f32 v102, v102
    v_exp_f32 v103, v103
    v_mfma_f32_32x32x16_bf16 v[0:15], v[196:199], v[84:87], v[0:15]
    s_mov_b32 exec_lo, 0xfffff
    s_mov_b32 exec_hi, 0xfffff
    ds_read_b128 v[192:195], v26 offset:5120
    ds_read_b128 v[196:199], v26 offset:5760
    s_mov_b64 exec, -1
    v_exp_f32 v104, v104
    v_exp_f32 v105, v105
    v_exp_f32 v106, v106
    v_exp_f32 v107, v107
    v_exp_f32 v108, v108
    v_exp_f32 v109, v109
    v_exp_f32 v110, v110
    v_exp_f32 v111, v111
    v_cvt_pk_bf16_f32 v96, v96, v97
    v_cvt_pk_bf16_f32 v97, v98, v99
    v_cvt_pk_bf16_f32 v98, v100, v101
    v_cvt_pk_bf16_f32 v99, v102, v103
    v_cvt_pk_bf16_f32 v100, v104, v105
    v_cvt_pk_bf16_f32 v101, v106, v107
    v_cvt_pk_bf16_f32 v102, v108, v109
    v_cvt_pk_bf16_f32 v103, v110, v111
    v_pk_add_f32 v[112:113], v[112:113], v[28:29] op_sel_hi:[1,0] neg_lo:[0,1] neg_hi:[0,1]
    v_pk_add_f32 v[114:115], v[114:115], v[28:29] op_sel_hi:[1,0] neg_lo:[0,1] neg_hi:[0,1]
    v_pk_add_f32 v[116:117], v[116:117], v[28:29] op_sel_hi:[1,0] neg_lo:[0,1] neg_hi:[0,1]
    v_pk_add_f32 v[118:119], v[118:119], v[28:29] op_sel_hi:[1,0] neg_lo:[0,1] neg_hi:[0,1]
    v_pk_add_f32 v[120:121], v[120:121], v[28:29] op_sel_hi:[1,0] neg_lo:[0,1] neg_hi:[0,1]
    v_pk_add_f32 v[122:123], v[122:123], v[28:29] op_sel_hi:[1,0] neg_lo:[0,1] neg_hi:[0,1]
    v_pk_add_f32 v[124:125], v[124:125], v[28:29] op_sel_hi:[1,0] neg_lo:[0,1] neg_hi:[0,1]
    v_pk_add_f32 v[126:127], v[126:127], v[28:29] op_sel_hi:[1,0] neg_lo:[0,1] neg_hi:[0,1]
    s_waitcnt lgkmcnt(2)
    v_mfma_f32_32x32x16_bf16 v[0:15], v[200:203], v[96:99], v[0:15]
    v_exp_f32 v112, v112
    v_exp_f32 v113, v113
    v_exp_f32 v114, v114
    v_exp_f32 v115, v115
    v_exp_f32 v116, v116
    v_exp_f32 v117, v117
    v_exp_f32 v118, v118
    v_exp_f32 v119, v119
    v_mfma_f32_32x32x16_bf16 v[0:15], v[204:207], v[100:103], v[0:15]
    s_mov_b32 exec_lo, 0xfffff
    s_mov_b32 exec_hi, 0xfffff
    ds_read_b128 v[200:203], v26 offset:6400
    ds_read_b128 v[204:207], v26 offset:7040
    s_mov_b64 exec, -1
    v_exp_f32 v120, v120
    v_exp_f32 v121, v121
    v_exp_f32 v122, v122
    v_exp_f32 v123, v123
    v_exp_f32 v124, v124
    v_exp_f32 v125, v125
    v_exp_f32 v126, v126
    v_exp_f32 v127, v127
    v_cvt_pk_bf16_f32 v112, v112, v113
    v_cvt_pk_bf16_f32 v113, v114, v115
    v_cvt_pk_bf16_f32 v114, v116, v117
    v_cvt_pk_bf16_f32 v115, v118, v119
    v_cvt_pk_bf16_f32 v116, v120, v121
    v_cvt_pk_bf16_f32 v117, v122, v123
    v_cvt_pk_bf16_f32 v118, v124, v125
    v_cvt_pk_bf16_f32 v119, v126, v127
    v_pk_add_f32 v[128:129], v[128:129], v[28:29] op_sel_hi:[1,0] neg_lo:[0,1] neg_hi:[0,1]
    v_pk_add_f32 v[130:131], v[130:131], v[28:29] op_sel_hi:[1,0] neg_lo:[0,1] neg_hi:[0,1]
    v_pk_add_f32 v[132:133], v[132:133], v[28:29] op_sel_hi:[1,0] neg_lo:[0,1] neg_hi:[0,1]
    v_pk_add_f32 v[134:135], v[134:135], v[28:29] op_sel_hi:[1,0] neg_lo:[0,1] neg_hi:[0,1]
    v_pk_add_f32 v[136:137], v[136:137], v[28:29] op_sel_hi:[1,0] neg_lo:[0,1] neg_hi:[0,1]
    v_pk_add_f32 v[138:139], v[138:139], v[28:29] op_sel_hi:[1,0] neg_lo:[0,1] neg_hi:[0,1]
    v_pk_add_f32 v[140:141], v[140:141], v[28:29] op_sel_hi:[1,0] neg_lo:[0,1] neg_hi:[0,1]
    v_pk_add_f32 v[142:143], v[142:143], v[28:29] op_sel_hi:[1,0] neg_lo:[0,1] neg_hi:[0,1]
    s_waitcnt lgkmcnt(2)
    v_mfma_f32_32x32x16_bf16 v[0:15], v[192:195], v[112:115], v[0:15]
    v_exp_f32 v128, v128
    v_exp_f32 v129, v129
    v_exp_f32 v130, v130
    v_exp_f32 v131, v131
    v_exp_f32 v132, v132
    v_exp_f32 v133, v133
    v_exp_f32 v134, v134
    v_exp_f32 v135, v135
    v_mfma_f32_32x32x16_bf16 v[0:15], v[196:199], v[116:119], v[0:15]
    s_mov_b32 exec_lo, 0xfffff
    s_mov_b32 exec_hi, 0xfffff
    ds_read_b128 v[192:195], v26 offset:7680
    ds_read_b128 v[196:199], v26 offset:8320
    s_mov_b64 exec, -1
    v_exp_f32 v136, v136
    v_exp_f32 v137, v137
    v_exp_f32 v138, v138
    v_exp_f32 v139, v139
    v_exp_f32 v140, v140
    v_exp_f32 v141, v141
    v_exp_f32 v142, v142
    v_exp_f32 v143, v143
    v_cvt_pk_bf16_f32 v128, v128, v129
    v_cvt_pk_bf16_f32 v129, v130, v131
    v_cvt_pk_bf16_f32 v130, v132, v133
    v_cvt_pk_bf16_f32 v131, v134, v135
    v_cvt_pk_bf16_f32 v132, v136, v137
    v_cvt_pk_bf16_f32 v133, v138, v139
    v_cvt_pk_bf16_f32 v134, v140, v141
    v_cvt_pk_bf16_f32 v135, v142, v143
    v_pk_add_f32 v[144:145], v[144:145], v[28:29] op_sel_hi:[1,0] neg_lo:[0,1] neg_hi:[0,1]
    v_pk_add_f32 v[146:147], v[146:147], v[28:29] op_sel_hi:[1,0] neg_lo:[0,1] neg_hi:[0,1]
    v_pk_add_f32 v[148:149], v[148:149], v[28:29] op_sel_hi:[1,0] neg_lo:[0,1] neg_hi:[0,1]
    v_pk_add_f32 v[150:151], v[150:151], v[28:29] op_sel_hi:[1,0] neg_lo:[0,1] neg_hi:[0,1]
    v_pk_add_f32 v[152:153], v[152:153], v[28:29] op_sel_hi:[1,0] neg_lo:[0,1] neg_hi:[0,1]
    v_pk_add_f32 v[154:155], v[154:155], v[28:29] op_sel_hi:[1,0] neg_lo:[0,1] neg_hi:[0,1]
    v_pk_add_f32 v[156:157], v[156:157], v[28:29] op_sel_hi:[1,0] neg_lo:[0,1] neg_hi:[0,1]
    v_pk_add_f32 v[158:159], v[158:159], v[28:29] op_sel_hi:[1,0] neg_lo:[0,1] neg_hi:[0,1]
    s_waitcnt lgkmcnt(2)
    v_mfma_f32_32x32x16_bf16 v[0:15], v[200:203], v[128:131], v[0:15]
    v_exp_f32 v144, v144
    v_exp_f32 v145, v145
    v_exp_f32 v146, v146
    v_exp_f32 v147, v147
    v_exp_f32 v148, v148
    v_exp_f32 v149, v149
    v_exp_f32 v150, v150
    v_exp_f32 v151, v151
    v_mfma_f32_32x32x16_bf16 v[0:15], v[204:207], v[132:135], v[0:15]
    s_mov_b32 exec_lo, 0xfffff
    s_mov_b32 exec_hi, 0xfffff
    ds_read_b128 v[200:203], v26 offset:8960
    ds_read_b128 v[204:207], v26 offset:9600
    s_mov_b64 exec, -1
    v_exp_f32 v152, v152
    v_exp_f32 v153, v153
    v_exp_f32 v154, v154
    v_exp_f32 v155, v155
    v_exp_f32 v156, v156
    v_exp_f32 v157, v157
    v_exp_f32 v158, v158
    v_exp_f32 v159, v159
    v_cvt_pk_bf16_f32 v144, v144, v145
    v_cvt_pk_bf16_f32 v145, v146, v147
    v_cvt_pk_bf16_f32 v146, v148, v149
    v_cvt_pk_bf16_f32 v147, v150, v151
    v_cvt_pk_bf16_f32 v148, v152, v153
    v_cvt_pk_bf16_f32 v149, v154, v155
    v_cvt_pk_bf16_f32 v150, v156, v157
    v_cvt_pk_bf16_f32 v151, v158, v159
    v_pk_add_f32 v[160:161], v[160:161], v[28:29] op_sel_hi:[1,0] neg_lo:[0,1] neg_hi:[0,1]
    v_pk_add_f32 v[162:163], v[162:163], v[28:29] op_sel_hi:[1,0] neg_lo:[0,1] neg_hi:[0,1]
    v_pk_add_f32 v[164:165], v[164:165], v[28:29] op_sel_hi:[1,0] neg_lo:[0,1] neg_hi:[0,1]
    v_pk_add_f32 v[166:167], v[166:167], v[28:29] op_sel_hi:[1,0] neg_lo:[0,1] neg_hi:[0,1]
    v_pk_add_f32 v[168:169], v[168:169], v[28:29] op_sel_hi:[1,0] neg_lo:[0,1] neg_hi:[0,1]
    v_pk_add_f32 v[170:171], v[170:171], v[28:29] op_sel_hi:[1,0] neg_lo:[0,1] neg_hi:[0,1]
    v_pk_add_f32 v[172:173], v[172:173], v[28:29] op_sel_hi:[1,0] neg_lo:[0,1] neg_hi:[0,1]
    v_pk_add_f32 v[174:175], v[174:175], v[28:29] op_sel_hi:[1,0] neg_lo:[0,1] neg_hi:[0,1]
    s_waitcnt lgkmcnt(2)
    v_mfma_f32_32x32x16_bf16 v[0:15], v[192:195], v[144:147], v[0:15]
    v_exp_f32 v160, v160
    v_exp_f32 v161, v161
    v_exp_f32 v162, v162
    v_exp_f32 v163, v163
    v_exp_f32 v164, v164
    v_exp_f32 v165, v165
    v_exp_f32 v166, v166
    v_exp_f32 v167, v167
    v_mfma_f32_32x32x16_bf16 v[0:15], v[196:199], v[148:151], v[0:15]
    s_mov_b32 exec_lo, 0xfffff
    s_mov_b32 exec_hi, 0xfffff
    ds_read_b128 v[192:195], v26 offset:10240
    ds_read_b128 v[196:199], v26 offset:10880
    s_mov_b64 exec, -1
    v_exp_f32 v168, v168
    v_exp_f32 v169, v169
    v_exp_f32 v170, v170
    v_exp_f32 v171, v171
    v_exp_f32 v172, v172
    v_exp_f32 v173, v173
    v_exp_f32 v174, v174
    v_exp_f32 v175, v175
    v_cvt_pk_bf16_f32 v160, v160, v161
    v_cvt_pk_bf16_f32 v161, v162, v163
    v_cvt_pk_bf16_f32 v162, v164, v165
    v_cvt_pk_bf16_f32 v163, v166, v167
    v_cvt_pk_bf16_f32 v164, v168, v169
    v_cvt_pk_bf16_f32 v165, v170, v171
    v_cvt_pk_bf16_f32 v166, v172, v173
    v_cvt_pk_bf16_f32 v167, v174, v175
    v_pk_add_f32 v[48:49], v[48:49], v[28:29] op_sel_hi:[1,0] neg_lo:[0,1] neg_hi:[0,1]
    v_pk_add_f32 v[50:51], v[50:51], v[28:29] op_sel_hi:[1,0] neg_lo:[0,1] neg_hi:[0,1]
    v_pk_add_f32 v[52:53], v[52:53], v[28:29] op_sel_hi:[1,0] neg_lo:[0,1] neg_hi:[0,1]
    v_pk_add_f32 v[54:55], v[54:55], v[28:29] op_sel_hi:[1,0] neg_lo:[0,1] neg_hi:[0,1]
    v_pk_add_f32 v[56:57], v[56:57], v[28:29] op_sel_hi:[1,0] neg_lo:[0,1] neg_hi:[0,1]
    v_pk_add_f32 v[58:59], v[58:59], v[28:29] op_sel_hi:[1,0] neg_lo:[0,1] neg_hi:[0,1]
    v_pk_add_f32 v[60:61], v[60:61], v[28:29] op_sel_hi:[1,0] neg_lo:[0,1] neg_hi:[0,1]
    v_pk_add_f32 v[62:63], v[62:63], v[28:29] op_sel_hi:[1,0] neg_lo:[0,1] neg_hi:[0,1]
    s_waitcnt lgkmcnt(2)
    v_mfma_f32_32x32x16_bf16 v[0:15], v[200:203], v[160:163], v[0:15]
    v_exp_f32 v48, v48
    v_exp_f32 v49, v49
    v_exp_f32 v50, v50
    v_exp_f32 v51, v51
    v_exp_f32 v52, v52
    v_exp_f32 v53, v53
    v_exp_f32 v54, v54
    v_exp_f32 v55, v55
    v_mfma_f32_32x32x16_bf16 v[0:15], v[204:207], v[164:167], v[0:15]
    v_exp_f32 v56, v56
    v_exp_f32 v57, v57
    v_exp_f32 v58, v58
    v_exp_f32 v59, v59
    v_exp_f32 v60, v60
    v_exp_f32 v61, v61
    v_exp_f32 v62, v62
    v_exp_f32 v63, v63
    v_cvt_pk_bf16_f32 v48, v48, v49
    v_cvt_pk_bf16_f32 v49, v50, v51
    v_cvt_pk_bf16_f32 v50, v52, v53
    v_cvt_pk_bf16_f32 v51, v54, v55
    v_cvt_pk_bf16_f32 v52, v56, v57
    v_cvt_pk_bf16_f32 v53, v58, v59
    v_cvt_pk_bf16_f32 v54, v60, v61
    v_cvt_pk_bf16_f32 v55, v62, v63
    s_waitcnt lgkmcnt(0)
    v_mfma_f32_32x32x16_bf16 v[0:15], v[192:195], v[48:51], v[0:15]
    v_mfma_f32_32x32x16_bf16 v[0:15], v[196:199], v[52:55], v[0:15]
    s_nop 7
    s_nop 3
    s_branch L_TA_OUT
L_T3_REDO:
    v_and_b32 v164, 15, v234
    v_lshrrev_b32 v165, 4, v234
    s_lshl_b32 s64, s55, 13
    s_add_u32 s64, s64, 131072
    v_lshl_add_u32 v160, v164, 3, s64
    v_lshl_add_u32 v160, v165, 7, v160
    v_bfe_u32 v166, v234, 2, 2
    v_lshl_add_u32 v162, v165, 2, v166
    v_lshrrev_b32 v163, 1, v165
    v_xor_b32 v163, v163, v165
    v_and_b32 v163, 1, v163
    v_lshlrev_b32 v162, 7, v162
    v_lshl_add_u32 v162, v163, 5, v162
    v_lshrrev_b32 v166, 1, v166
    v_xor_b32 v166, s56, v166
    v_lshl_add_u32 v162, v166, 6, v162
    v_and_b32 v166, 3, v234
    v_lshl_add_u32 v162, v166, 3, v162
    v_xor_b32 v163, 32, v162
    v_add_u32 v162, 40960, v162
    v_add_u32 v163, 40960, v163
    s_lshl_b32 s64, s55, 8
    s_add_u32 s64, s64, 108544
    v_lshl_add_u32 v166, v165, 4, s64
    s_lshl_b32 s64, s56, 8
    s_add_u32 s64, s64, 109056
    v_lshl_add_u32 v165, v164, 3, s64
    s_lshl_b32 s64, s55, 10
    s_add_u32 s64, s64, 106496
    v_lshl_add_u32 v164, v164, 4, s64
    v_mov_b32 v66, 0
    v_mov_b32 v67, 0
    v_mov_b32 v70, 0
    v_mov_b32 v71, 0
    v_mov_b32 v74, 0
    v_mov_b32 v75, 0
    v_mov_b32 v78, 0
    v_mov_b32 v79, 0
    v_mov_b32 v82, 0
    v_mov_b32 v83, 0
    v_mov_b32 v86, 0
    v_mov_b32 v87, 0
    v_mov_b32 v90, 0
    v_mov_b32 v91, 0
    v_mov_b32 v94, 0
    v_mov_b32 v95, 0
    s_branch L_T3_GO
L_FIN:
    s_cmp_eq_u32 s58, 0
    s_cbranch_scc1 L_END
    v_mov_b32 v0, 0
    v_mov_b32 v1, s58
    global_atomic_or v0, v1, s[22:23]
L_END:
    s_endpgm
.section .rodata,"a"
.p2align 6
.amdhsa_kernel recurrent_scan__sliding_block__mixer_s_mlp__prompt_kernel
  .amdhsa_next_free_vgpr 256
  .amdhsa_next_free_sgpr 102
  .amdhsa_accum_offset 256
  .amdhsa_group_segment_fixed_size 0
  .amdhsa_kernarg_size 88
  .amdhsa_user_sgpr_count 2
  .amdhsa_user_sgpr_kernarg_segment_ptr 1
  .amdhsa_system_sgpr_workgroup_id_x 1
.end_amdhsa_kernel
```
